```python
import torch

def _softmax(x, axis=-1):
    return torch.softmax(x, dim=axis)

def _gelu(x):
    return torch.nn.functional.gelu(x, approximate='tanh')

def _silu(x):
    return torch.nn.functional.silu(x)

def _sigmoid(x):
    return torch.sigmoid(x)

def _layernorm(x, axis=-1, eps=1e-05):
    m = x.mean(dim=axis, keepdim=True)
    v = x.var(dim=axis, keepdim=True, unbiased=False)
    return (x - m) / torch.sqrt(v + eps)

def _scatter_add(tgt, idx, src, axis=0):
    return tgt.clone().index_add_(axis, idx, src)

def _segment_sum(src, seg, n):
    out = torch.zeros((n,) + src.shape[1:], dtype=src.dtype)
    return out.index_add_(0, seg, src)

def _pad(x, pw):
    flat = tuple((v for pair in reversed(pw) for v in pair))
    return torch.nn.functional.pad(x, flat)
kernel_name = 'adaLN_cond__spectral_gfnet__glu_gated_bilinear__prompt'

def setup_inputs():

    _w = lambda a: (lambda t: t.to(torch.bfloat16) if t.is_floating_point() else t)(torch.as_tensor(a))

    def _A_setup():
        B, S, D = (1, 2048, 512)
        Df = D // 2 + 1
        return {'x': _w((lambda *s: torch.randn(*s, dtype=torch.bfloat16) * 0.05)(B, S, D)), 'w_r': _w((lambda *s: torch.randn(*s, dtype=torch.bfloat16) * 3.2)(S, Df) * 0.02), 'w_i': _w((lambda *s: torch.randn(*s, dtype=torch.bfloat16) * 3.2)(S, Df) * 0.02)}
    _A_in = _A_setup()

    def _B_setup():
        B, S, D, F = (1, 2048, 512, 1376)
        return {'x': _w((lambda *s: torch.randn(*s, dtype=torch.bfloat16) * 0.05)(B, S, D)), 'w_gate': _w((lambda *s: torch.randn(*s, dtype=torch.bfloat16) * 0.4)(D, F) * D ** (-0.5)), 'w_up': _w((lambda *s: torch.randn(*s, dtype=torch.bfloat16) * 0.4)(D, F) * D ** (-0.5)), 'w_down': _w((lambda *s: torch.randn(*s, dtype=torch.bfloat16) * 0.4)(F, D) * F ** (-0.5))}
    _B_in = _B_setup()
    return {'A_x': _A_in['x'], 'A_w_r': _A_in['w_r'], 'A_w_i': _A_in['w_i'], 'B_x': _B_in['x'], 'B_w_gate': _B_in['w_gate'], 'B_w_up': _B_in['w_up'], 'B_w_down': _B_in['w_down'], 'c': _w((lambda *s: torch.randn(*s, dtype=torch.bfloat16) * 0.1)(1, 512) * 8.0), 'w_mod': _w((lambda *s: torch.randn(*s, dtype=torch.bfloat16) * 0.1)(512, 6 * 512) * 512 ** (-0.5) * 8.0)}

def reference(A_x, A_w_r, A_w_i, B_x, B_w_gate, B_w_up, B_w_down, c, w_mod):

    def _A_ref(x, w_r, w_i):
        B, S, D = x.shape
        X = (lambda x, axes=(-2, -1): torch.fft.rfft2(x.float(), dim=axes))(x, axes=(-2, -1))
        W = w_r + 1j * w_i
        X = X * W
        y = (lambda x, s, axes=(-2, -1): torch.fft.irfft2(x, s=s, dim=axes).to(torch.bfloat16))(X, (S, D), axes=(-2, -1))
        return y

    def _B_ref(x, w_gate, w_up, w_down):
        g = torch.einsum('bsd,df->bsf', x, w_gate)
        u = torch.einsum('bsd,df->bsf', x, w_up)
        h = g * u
        return torch.einsum('bsf,fd->bsd', h, w_down)
    x = A_x
    mod = (_silu(c) @ w_mod).reshape(c.shape[0], 6, 1, -1)
    sa, ca, ga, sb, cb, gb = (mod[:, 0].clone(), mod[:, 1].clone(), mod[:, 2].clone(), mod[:, 3].clone(), mod[:, 4].clone(), mod[:, 5].clone())
    h = _layernorm(x, axis=-1) * (1 + ca) + sa
    x = x + ga * _A_ref(h, A_w_r, A_w_i)
    h = _layernorm(x, axis=-1) * (1 + cb) + sb
    x = x + gb * _B_ref(h, B_w_gate, B_w_up, B_w_down)
    return x
```

```asm
; @launch kernel=k1_kernel grid=(408,1,1) block=(256,1,1) lds=20992
; @launch kernel=k2_kernel grid=(224,1,1) block=(512,1,1) lds=67072
; @launch kernel=k34_kernel grid=(256,1,1) block=(256,1,1) lds=131584
.amdgcn_target "amdgcn-amd-amdhsa--gfx950"
.text
.globl k1_kernel
.p2align 8
.type k1_kernel,@function
k1_kernel:
    s_getpc_b64 s[40:41]
    v_lshlrev_b32 v1, 5, v0
    global_load_dword v200, v1, s[40:41]
    s_cmp_ge_u32 s2, 128
    s_cbranch_scc1 L_k1_side
    s_load_dwordx2 s[4:5], s[0:1], 0
    s_load_dwordx2 s[6:7], s[0:1], 88
    s_and_b32 s20, s2, 31
    s_lshr_b32 s21, s2, 5
    v_and_b32 v1, 15, v0
    v_bfe_u32 v2, v0, 4, 2
    v_lshrrev_b32 v3, 6, v0
    v_lshlrev_b32 v4, 18, v2
    v_lshl_add_u32 v4, v3, 8, v4
    v_lshl_add_u32 v4, v1, 4, v4
    s_lshl_b32 s22, s20, 10
    s_waitcnt lgkmcnt(0)
    s_mov_b32 s8, s4
    s_mov_b32 s9, s5
    s_mov_b32 s10, 2097152
    s_mov_b32 s11, 0x00020000
    s_add_u32 s28, s21, 0
    s_and_b32 s30, s28, 3
    s_lshr_b32 s29, s30, 1
    s_lshl_b32 s29, s29, 20
    s_and_b32 s28, s28, 1
    s_lshl_b32 s28, s28, 17
    s_add_u32 s28, s28, s29
    s_add_u32 s28, s28, s22
    buffer_load_dwordx4 v[16:19], v4, s[8:11], s28 offen
    s_add_u32 s28, s28, 32768
    buffer_load_dwordx4 v[20:23], v4, s[8:11], s28 offen
    s_add_u32 s28, s28, 32768
    buffer_load_dwordx4 v[24:27], v4, s[8:11], s28 offen
    s_add_u32 s28, s28, 32768
    buffer_load_dwordx4 v[28:31], v4, s[8:11], s28 offen
    s_add_u32 s28, s21, 1
    s_and_b32 s31, s28, 3
    s_lshr_b32 s29, s31, 1
    s_lshl_b32 s29, s29, 20
    s_and_b32 s28, s28, 1
    s_lshl_b32 s28, s28, 17
    s_add_u32 s28, s28, s29
    s_add_u32 s28, s28, s22
    buffer_load_dwordx4 v[32:35], v4, s[8:11], s28 offen
    s_add_u32 s28, s28, 32768
    buffer_load_dwordx4 v[36:39], v4, s[8:11], s28 offen
    s_add_u32 s28, s28, 32768
    buffer_load_dwordx4 v[40:43], v4, s[8:11], s28 offen
    s_add_u32 s28, s28, 32768
    buffer_load_dwordx4 v[44:47], v4, s[8:11], s28 offen
    s_add_u32 s12, s6, 131072
    s_addc_u32 s13, s7, 0
    s_mov_b32 s14, 2097152
    s_mov_b32 s15, 0x00020000
    v_cvt_f32_u32 v5, v1
    v_mul_f32 v5, 0x3c800000, v5
    v_lshlrev_b32 v6, 3, v2
    v_cvt_f32_u32 v6, v6
    v_mul_f32 v6, v5, v6
    s_lshr_b32 s28, s30, 1
    s_lshl_b32 s28, s28, 5
    s_and_b32 s29, s30, 1
    s_lshl_b32 s29, s29, 2
    s_add_u32 s28, s28, s29
    v_cvt_f32_u32 v7, s28
    v_fma_f32 v7, v7, v5, v6
    v_cos_f32 v160, v7
    v_sin_f32 v168, v7
    v_add_f32 v7, v7, v5
    v_cos_f32 v161, v7
    v_sin_f32 v169, v7
    v_add_f32 v7, v7, v5
    v_cos_f32 v162, v7
    v_sin_f32 v170, v7
    v_add_f32 v7, v7, v5
    v_cos_f32 v163, v7
    v_sin_f32 v171, v7
    s_lshr_b32 s28, s31, 1
    s_lshl_b32 s28, s28, 5
    s_and_b32 s29, s31, 1
    s_lshl_b32 s29, s29, 2
    s_add_u32 s28, s28, s29
    v_cvt_f32_u32 v7, s28
    v_fma_f32 v7, v7, v5, v6
    v_cos_f32 v164, v7
    v_sin_f32 v172, v7
    v_add_f32 v7, v7, v5
    v_cos_f32 v165, v7
    v_sin_f32 v173, v7
    v_add_f32 v7, v7, v5
    v_cos_f32 v166, v7
    v_sin_f32 v174, v7
    v_add_f32 v7, v7, v5
    v_cos_f32 v167, v7
    v_sin_f32 v175, v7
    v_cvt_pk_bf16_f32 v128, v160, v161
    v_cvt_pk_bf16_f32 v129, v162, v163
    v_cvt_pk_bf16_f32 v130, v164, v165
    v_cvt_pk_bf16_f32 v131, v166, v167
    v_cvt_pk_bf16_f32 v136, -v168, -v169
    v_cvt_pk_bf16_f32 v137, -v170, -v171
    v_cvt_pk_bf16_f32 v138, -v172, -v173
    v_cvt_pk_bf16_f32 v139, -v174, -v175
    v_cvt_pk_bf16_f32 v144, v160, -v169
    v_cvt_pk_bf16_f32 v145, -v162, v171
    v_cvt_pk_bf16_f32 v146, v164, -v173
    v_cvt_pk_bf16_f32 v147, -v166, v175
    v_cvt_pk_bf16_f32 v152, -v168, -v161
    v_cvt_pk_bf16_f32 v153, v170, v163
    v_cvt_pk_bf16_f32 v154, -v172, -v165
    v_cvt_pk_bf16_f32 v155, v174, v167
    v_cmp_eq_u32 vcc, 0, v1
    v_mov_b32 v8, 0xbf803f80
    v_and_b32 v9, 1, v1
    v_sub_u32 v9, 0, v9
    v_and_b32 v9, 0x80008000, v9
    v_cndmask_b32 v136, v136, v8, vcc
    v_cndmask_b32 v137, v137, v8, vcc
    v_cndmask_b32 v138, v138, v8, vcc
    v_cndmask_b32 v139, v139, v8, vcc
    v_xor_b32 v132, v9, v128
    v_xor_b32 v133, v9, v129
    v_xor_b32 v134, v9, v130
    v_xor_b32 v135, v9, v131
    v_xor_b32 v140, v9, v136
    v_xor_b32 v141, v9, v137
    v_xor_b32 v142, v9, v138
    v_xor_b32 v143, v9, v139
    v_xor_b32 v148, v9, v144
    v_xor_b32 v149, v9, v145
    v_xor_b32 v150, v9, v146
    v_xor_b32 v151, v9, v147
    v_xor_b32 v156, v9, v152
    v_xor_b32 v157, v9, v153
    v_xor_b32 v158, v9, v154
    v_xor_b32 v159, v9, v155
    v_mov_b64 v[80:81], 0
    v_mov_b64 v[82:83], 0
    v_mov_b64 v[84:85], 0
    v_mov_b64 v[86:87], 0
    v_mov_b64 v[88:89], 0
    v_mov_b64 v[90:91], 0
    v_mov_b64 v[92:93], 0
    v_mov_b64 v[94:95], 0
    v_mov_b64 v[96:97], 0
    v_mov_b64 v[98:99], 0
    v_mov_b64 v[100:101], 0
    v_mov_b64 v[102:103], 0
    v_mov_b64 v[104:105], 0
    v_mov_b64 v[106:107], 0
    v_mov_b64 v[108:109], 0
    v_mov_b64 v[110:111], 0
    s_mov_b32 s24, 0x3f803f80
    s_mov_b32 s25, 0xffff0000
    v_bfe_u32 v10, v0, 3, 1
    v_bfe_u32 v11, v0, 2, 1
    v_lshlrev_b32 v10, 8, v10
    v_lshl_add_u32 v10, v3, 9, v10
    v_lshl_add_u32 v10, v11, 7, v10
    v_lshl_add_u32 v10, v2, 5, v10
    v_and_b32 v11, 63, v0
    v_lshlrev_b32 v11, 2, v11
    v_lshl_add_u32 v12, v3, 9, v11
    v_lshlrev_b32 v13, 9, v3
    v_lshl_add_u32 v13, v2, 5, v13
    v_mul_u32_u24 v14, 528, v1
    v_lshl_add_u32 v15, v3, 2, v2
    v_lshl_add_u32 v14, v15, 4, v14
    v_bfe_u32 v112, v0, 5, 1
    v_lshl_add_u32 v112, v3, 3, v112
    v_and_b32 v113, 31, v0
    v_mul_u32_u24 v15, 528, v112
    v_lshl_add_u32 v15, v113, 4, v15
    v_lshlrev_b32 v112, 16, v112
    v_lshl_add_u32 v112, v113, 4, v112
    s_lshl_b32 s26, s20, 11
    s_lshl_b32 s27, s21, 9
    s_add_u32 s26, s26, s27
    s_add_u32 s27, s26, 0x100000
    s_add_u32 s28, s21, 2
    s_and_b32 s32, s28, 3
    s_lshr_b32 s29, s32, 1
    s_lshl_b32 s29, s29, 20
    s_and_b32 s28, s28, 1
    s_lshl_b32 s28, s28, 17
    s_add_u32 s28, s28, s29
    s_add_u32 s28, s28, s22
    buffer_load_dwordx4 v[48:51], v4, s[8:11], s28 offen
    s_add_u32 s28, s28, 32768
    buffer_load_dwordx4 v[52:55], v4, s[8:11], s28 offen
    s_add_u32 s28, s28, 32768
    buffer_load_dwordx4 v[56:59], v4, s[8:11], s28 offen
    s_add_u32 s28, s28, 32768
    buffer_load_dwordx4 v[60:63], v4, s[8:11], s28 offen
    s_waitcnt vmcnt(11)
    v_dot2c_f32_bf16 v80, s24, v16
    v_dot2c_f32_bf16 v96, v16, v16
    v_dot2c_f32_bf16 v80, s24, v17
    v_dot2c_f32_bf16 v96, v17, v17
    v_dot2c_f32_bf16 v80, s24, v18
    v_dot2c_f32_bf16 v96, v18, v18
    v_dot2c_f32_bf16 v80, s24, v19
    v_dot2c_f32_bf16 v96, v19, v19
    s_waitcnt vmcnt(10)
    v_dot2c_f32_bf16 v81, s24, v20
    v_dot2c_f32_bf16 v97, v20, v20
    v_dot2c_f32_bf16 v81, s24, v21
    v_dot2c_f32_bf16 v97, v21, v21
    v_dot2c_f32_bf16 v81, s24, v22
    v_dot2c_f32_bf16 v97, v22, v22
    v_dot2c_f32_bf16 v81, s24, v23
    v_dot2c_f32_bf16 v97, v23, v23
    v_add_f32_dpp v80, v80, v80 row_ror:8 row_mask:0xf bank_mask:0x3
    s_waitcnt vmcnt(9)
    v_dot2c_f32_bf16 v82, s24, v24
    v_dot2c_f32_bf16 v98, v24, v24
    v_dot2c_f32_bf16 v82, s24, v25
    v_dot2c_f32_bf16 v98, v25, v25
    v_dot2c_f32_bf16 v82, s24, v26
    v_dot2c_f32_bf16 v98, v26, v26
    v_dot2c_f32_bf16 v82, s24, v27
    v_dot2c_f32_bf16 v98, v27, v27
    v_add_f32_dpp v81, v81, v81 row_ror:8 row_mask:0xf bank_mask:0x3
    v_add_f32_dpp v80, v96, v96 row_ror:8 row_mask:0xf bank_mask:0xc
    s_waitcnt vmcnt(8)
    v_dot2c_f32_bf16 v83, s24, v28
    v_dot2c_f32_bf16 v99, v28, v28
    v_dot2c_f32_bf16 v83, s24, v29
    v_dot2c_f32_bf16 v99, v29, v29
    v_dot2c_f32_bf16 v83, s24, v30
    v_dot2c_f32_bf16 v99, v30, v30
    v_dot2c_f32_bf16 v83, s24, v31
    v_dot2c_f32_bf16 v99, v31, v31
    v_add_f32_dpp v82, v82, v82 row_ror:8 row_mask:0xf bank_mask:0x3
    v_add_f32_dpp v81, v97, v97 row_ror:8 row_mask:0xf bank_mask:0xc
    v_add_f32_dpp v80, v80, v80 row_shl:4 row_mask:0xf bank_mask:0x5
    s_add_u32 s28, s21, 3
    s_and_b32 s33, s28, 3
    s_lshr_b32 s29, s33, 1
    s_lshl_b32 s29, s29, 20
    s_and_b32 s28, s28, 1
    s_lshl_b32 s28, s28, 17
    s_add_u32 s28, s28, s29
    s_add_u32 s28, s28, s22
    buffer_load_dwordx4 v[64:67], v4, s[8:11], s28 offen
    s_add_u32 s28, s28, 32768
    buffer_load_dwordx4 v[68:71], v4, s[8:11], s28 offen
    s_add_u32 s28, s28, 32768
    buffer_load_dwordx4 v[72:75], v4, s[8:11], s28 offen
    s_add_u32 s28, s28, 32768
    buffer_load_dwordx4 v[76:79], v4, s[8:11], s28 offen
    s_waitcnt vmcnt(11)
    v_dot2c_f32_bf16 v84, s24, v32
    v_dot2c_f32_bf16 v100, v32, v32
    v_dot2c_f32_bf16 v84, s24, v33
    v_dot2c_f32_bf16 v100, v33, v33
    v_dot2c_f32_bf16 v84, s24, v34
    v_dot2c_f32_bf16 v100, v34, v34
    v_dot2c_f32_bf16 v84, s24, v35
    v_dot2c_f32_bf16 v100, v35, v35
    v_add_f32_dpp v83, v83, v83 row_ror:8 row_mask:0xf bank_mask:0x3
    v_add_f32_dpp v82, v98, v98 row_ror:8 row_mask:0xf bank_mask:0xc
    v_add_f32_dpp v81, v81, v81 row_shl:4 row_mask:0xf bank_mask:0x5
    s_waitcnt vmcnt(10)
    v_dot2c_f32_bf16 v85, s24, v36
    v_dot2c_f32_bf16 v101, v36, v36
    v_dot2c_f32_bf16 v85, s24, v37
    v_dot2c_f32_bf16 v101, v37, v37
    v_dot2c_f32_bf16 v85, s24, v38
    v_dot2c_f32_bf16 v101, v38, v38
    v_dot2c_f32_bf16 v85, s24, v39
    v_dot2c_f32_bf16 v101, v39, v39
    v_add_f32_dpp v84, v84, v84 row_ror:8 row_mask:0xf bank_mask:0x3
    v_add_f32_dpp v83, v99, v99 row_ror:8 row_mask:0xf bank_mask:0xc
    v_add_f32_dpp v82, v82, v82 row_shl:4 row_mask:0xf bank_mask:0x5
    s_waitcnt vmcnt(9)
    v_dot2c_f32_bf16 v86, s24, v40
    v_dot2c_f32_bf16 v102, v40, v40
    v_dot2c_f32_bf16 v86, s24, v41
    v_dot2c_f32_bf16 v102, v41, v41
    v_dot2c_f32_bf16 v86, s24, v42
    v_dot2c_f32_bf16 v102, v42, v42
    v_dot2c_f32_bf16 v86, s24, v43
    v_dot2c_f32_bf16 v102, v43, v43
    v_add_f32_dpp v85, v85, v85 row_ror:8 row_mask:0xf bank_mask:0x3
    v_add_f32_dpp v84, v100, v100 row_ror:8 row_mask:0xf bank_mask:0xc
    v_add_f32_dpp v83, v83, v83 row_shl:4 row_mask:0xf bank_mask:0x5
    s_waitcnt vmcnt(8)
    v_dot2c_f32_bf16 v87, s24, v44
    v_dot2c_f32_bf16 v103, v44, v44
    v_dot2c_f32_bf16 v87, s24, v45
    v_dot2c_f32_bf16 v103, v45, v45
    v_dot2c_f32_bf16 v87, s24, v46
    v_dot2c_f32_bf16 v103, v46, v46
    v_dot2c_f32_bf16 v87, s24, v47
    v_dot2c_f32_bf16 v103, v47, v47
    v_add_f32_dpp v86, v86, v86 row_ror:8 row_mask:0xf bank_mask:0x3
    v_add_f32_dpp v85, v101, v101 row_ror:8 row_mask:0xf bank_mask:0xc
    v_add_f32_dpp v84, v84, v84 row_shl:4 row_mask:0xf bank_mask:0x5
    s_waitcnt vmcnt(7)
    v_dot2c_f32_bf16 v88, s24, v48
    v_dot2c_f32_bf16 v104, v48, v48
    v_dot2c_f32_bf16 v88, s24, v49
    v_dot2c_f32_bf16 v104, v49, v49
    v_dot2c_f32_bf16 v88, s24, v50
    v_dot2c_f32_bf16 v104, v50, v50
    v_dot2c_f32_bf16 v88, s24, v51
    v_dot2c_f32_bf16 v104, v51, v51
    v_add_f32_dpp v87, v87, v87 row_ror:8 row_mask:0xf bank_mask:0x3
    v_add_f32_dpp v86, v102, v102 row_ror:8 row_mask:0xf bank_mask:0xc
    v_add_f32_dpp v85, v85, v85 row_shl:4 row_mask:0xf bank_mask:0x5
    s_waitcnt vmcnt(6)
    v_dot2c_f32_bf16 v89, s24, v52
    v_dot2c_f32_bf16 v105, v52, v52
    v_dot2c_f32_bf16 v89, s24, v53
    v_dot2c_f32_bf16 v105, v53, v53
    v_dot2c_f32_bf16 v89, s24, v54
    v_dot2c_f32_bf16 v105, v54, v54
    v_dot2c_f32_bf16 v89, s24, v55
    v_dot2c_f32_bf16 v105, v55, v55
    v_add_f32_dpp v88, v88, v88 row_ror:8 row_mask:0xf bank_mask:0x3
    v_add_f32_dpp v87, v103, v103 row_ror:8 row_mask:0xf bank_mask:0xc
    v_add_f32_dpp v86, v86, v86 row_shl:4 row_mask:0xf bank_mask:0x5
    s_waitcnt vmcnt(5)
    v_dot2c_f32_bf16 v90, s24, v56
    v_dot2c_f32_bf16 v106, v56, v56
    v_dot2c_f32_bf16 v90, s24, v57
    v_dot2c_f32_bf16 v106, v57, v57
    v_dot2c_f32_bf16 v90, s24, v58
    v_dot2c_f32_bf16 v106, v58, v58
    v_dot2c_f32_bf16 v90, s24, v59
    v_dot2c_f32_bf16 v106, v59, v59
    v_add_f32_dpp v89, v89, v89 row_ror:8 row_mask:0xf bank_mask:0x3
    v_add_f32_dpp v88, v104, v104 row_ror:8 row_mask:0xf bank_mask:0xc
    v_add_f32_dpp v87, v87, v87 row_shl:4 row_mask:0xf bank_mask:0x5
    s_waitcnt vmcnt(4)
    v_dot2c_f32_bf16 v91, s24, v60
    v_dot2c_f32_bf16 v107, v60, v60
    v_dot2c_f32_bf16 v91, s24, v61
    v_dot2c_f32_bf16 v107, v61, v61
    v_dot2c_f32_bf16 v91, s24, v62
    v_dot2c_f32_bf16 v107, v62, v62
    v_dot2c_f32_bf16 v91, s24, v63
    v_dot2c_f32_bf16 v107, v63, v63
    v_add_f32_dpp v90, v90, v90 row_ror:8 row_mask:0xf bank_mask:0x3
    v_add_f32_dpp v89, v105, v105 row_ror:8 row_mask:0xf bank_mask:0xc
    v_add_f32_dpp v80, v88, v88 row_shr:4 row_mask:0xf bank_mask:0xa
    s_waitcnt vmcnt(3)
    v_dot2c_f32_bf16 v92, s24, v64
    v_dot2c_f32_bf16 v108, v64, v64
    v_dot2c_f32_bf16 v92, s24, v65
    v_dot2c_f32_bf16 v108, v65, v65
    v_dot2c_f32_bf16 v92, s24, v66
    v_dot2c_f32_bf16 v108, v66, v66
    v_dot2c_f32_bf16 v92, s24, v67
    v_dot2c_f32_bf16 v108, v67, v67
    v_add_f32_dpp v91, v91, v91 row_ror:8 row_mask:0xf bank_mask:0x3
    v_add_f32_dpp v90, v106, v106 row_ror:8 row_mask:0xf bank_mask:0xc
    v_add_f32_dpp v81, v89, v89 row_shr:4 row_mask:0xf bank_mask:0xa
    v_add_f32_dpp v80, v80, v80 quad_perm:[1,0,3,2] row_mask:0xf bank_mask:0xf
    s_waitcnt vmcnt(2)
    v_dot2c_f32_bf16 v93, s24, v68
    v_dot2c_f32_bf16 v109, v68, v68
    v_dot2c_f32_bf16 v93, s24, v69
    v_dot2c_f32_bf16 v109, v69, v69
    v_dot2c_f32_bf16 v93, s24, v70
    v_dot2c_f32_bf16 v109, v70, v70
    v_dot2c_f32_bf16 v93, s24, v71
    v_dot2c_f32_bf16 v109, v71, v71
    v_add_f32_dpp v92, v92, v92 row_ror:8 row_mask:0xf bank_mask:0x3
    v_add_f32_dpp v91, v107, v107 row_ror:8 row_mask:0xf bank_mask:0xc
    v_add_f32_dpp v82, v90, v90 row_shr:4 row_mask:0xf bank_mask:0xa
    v_add_f32_dpp v81, v81, v81 quad_perm:[1,0,3,2] row_mask:0xf bank_mask:0xf
    v_add_f32_dpp v80, v80, v80 quad_perm:[2,3,0,1] row_mask:0xf bank_mask:0xf
    s_waitcnt vmcnt(1)
    v_dot2c_f32_bf16 v94, s24, v72
    v_dot2c_f32_bf16 v110, v72, v72
    v_dot2c_f32_bf16 v94, s24, v73
    v_dot2c_f32_bf16 v110, v73, v73
    v_dot2c_f32_bf16 v94, s24, v74
    v_dot2c_f32_bf16 v110, v74, v74
    v_dot2c_f32_bf16 v94, s24, v75
    v_dot2c_f32_bf16 v110, v75, v75
    v_add_f32_dpp v93, v93, v93 row_ror:8 row_mask:0xf bank_mask:0x3
    v_add_f32_dpp v92, v108, v108 row_ror:8 row_mask:0xf bank_mask:0xc
    v_add_f32_dpp v83, v91, v91 row_shr:4 row_mask:0xf bank_mask:0xa
    v_add_f32_dpp v82, v82, v82 quad_perm:[1,0,3,2] row_mask:0xf bank_mask:0xf
    v_add_f32_dpp v81, v81, v81 quad_perm:[2,3,0,1] row_mask:0xf bank_mask:0xf
    s_waitcnt vmcnt(0)
    v_dot2c_f32_bf16 v95, s24, v76
    v_dot2c_f32_bf16 v111, v76, v76
    v_dot2c_f32_bf16 v95, s24, v77
    v_dot2c_f32_bf16 v111, v77, v77
    v_dot2c_f32_bf16 v95, s24, v78
    v_dot2c_f32_bf16 v111, v78, v78
    v_dot2c_f32_bf16 v95, s24, v79
    v_dot2c_f32_bf16 v111, v79, v79
    v_add_f32_dpp v94, v94, v94 row_ror:8 row_mask:0xf bank_mask:0x3
    v_add_f32_dpp v93, v109, v109 row_ror:8 row_mask:0xf bank_mask:0xc
    v_add_f32_dpp v84, v92, v92 row_shr:4 row_mask:0xf bank_mask:0xa
    v_add_f32_dpp v83, v83, v83 quad_perm:[1,0,3,2] row_mask:0xf bank_mask:0xf
    v_add_f32_dpp v82, v82, v82 quad_perm:[2,3,0,1] row_mask:0xf bank_mask:0xf
    v_add_f32_dpp v95, v95, v95 row_ror:8 row_mask:0xf bank_mask:0x3
    v_add_f32_dpp v94, v110, v110 row_ror:8 row_mask:0xf bank_mask:0xc
    v_add_f32_dpp v85, v93, v93 row_shr:4 row_mask:0xf bank_mask:0xa
    v_add_f32_dpp v84, v84, v84 quad_perm:[1,0,3,2] row_mask:0xf bank_mask:0xf
    v_add_f32_dpp v83, v83, v83 quad_perm:[2,3,0,1] row_mask:0xf bank_mask:0xf
    v_add_f32_dpp v95, v111, v111 row_ror:8 row_mask:0xf bank_mask:0xc
    v_add_f32_dpp v86, v94, v94 row_shr:4 row_mask:0xf bank_mask:0xa
    v_add_f32_dpp v85, v85, v85 quad_perm:[1,0,3,2] row_mask:0xf bank_mask:0xf
    v_add_f32_dpp v84, v84, v84 quad_perm:[2,3,0,1] row_mask:0xf bank_mask:0xf
    v_add_f32_dpp v87, v95, v95 row_shr:4 row_mask:0xf bank_mask:0xa
    v_add_f32_dpp v86, v86, v86 quad_perm:[1,0,3,2] row_mask:0xf bank_mask:0xf
    v_add_f32_dpp v85, v85, v85 quad_perm:[2,3,0,1] row_mask:0xf bank_mask:0xf
    v_add_f32_dpp v87, v87, v87 quad_perm:[1,0,3,2] row_mask:0xf bank_mask:0xf
    v_add_f32_dpp v86, v86, v86 quad_perm:[2,3,0,1] row_mask:0xf bank_mask:0xf
    s_nop 0
    v_add_f32_dpp v87, v87, v87 quad_perm:[2,3,0,1] row_mask:0xf bank_mask:0xf
    ds_write_b128 v10, v[80:83]
    ds_write_b128 v10, v[84:87] offset:16
    s_waitcnt lgkmcnt(0)
    s_barrier
    ds_read2st64_b32 v[96:97], v11 offset0:0 offset1:1
    ds_read2st64_b32 v[98:99], v11 offset0:2 offset1:3
    ds_read2st64_b32 v[100:101], v11 offset0:4 offset1:5
    ds_read2st64_b32 v[102:103], v11 offset0:6 offset1:7
    s_cmp_lg_u32 s21, 0
    s_cbranch_scc1 L_k1_p1
    v_lshlrev_b32 v176, 16, v16
    v_and_b32 v192, s25, v16
    v_lshlrev_b32 v177, 16, v20
    v_and_b32 v193, s25, v20
    v_lshlrev_b32 v178, 16, v24
    v_and_b32 v194, s25, v24
    v_lshlrev_b32 v179, 16, v28
    v_and_b32 v195, s25, v28
    v_lshlrev_b32 v180, 16, v32
    v_and_b32 v196, s25, v32
    v_lshlrev_b32 v181, 16, v36
    v_and_b32 v197, s25, v36
    v_lshlrev_b32 v182, 16, v40
    v_and_b32 v198, s25, v40
    v_lshlrev_b32 v183, 16, v44
    v_and_b32 v199, s25, v44
    v_lshlrev_b32 v184, 16, v48
    v_and_b32 v200, s25, v48
    v_lshlrev_b32 v185, 16, v52
    v_and_b32 v201, s25, v52
    v_lshlrev_b32 v186, 16, v56
    v_and_b32 v202, s25, v56
    v_lshlrev_b32 v187, 16, v60
    v_and_b32 v203, s25, v60
    v_lshlrev_b32 v188, 16, v64
    v_and_b32 v204, s25, v64
    v_lshlrev_b32 v189, 16, v68
    v_and_b32 v205, s25, v68
    v_lshlrev_b32 v190, 16, v72
    v_and_b32 v206, s25, v72
    v_lshlrev_b32 v191, 16, v76
    v_and_b32 v207, s25, v76
    s_branch L_k1_pdone
L_k1_p1:
    s_cmp_lg_u32 s21, 1
    s_cbranch_scc1 L_k1_p2
    v_lshlrev_b32 v176, 16, v17
    v_and_b32 v192, s25, v17
    v_lshlrev_b32 v177, 16, v21
    v_and_b32 v193, s25, v21
    v_lshlrev_b32 v178, 16, v25
    v_and_b32 v194, s25, v25
    v_lshlrev_b32 v179, 16, v29
    v_and_b32 v195, s25, v29
    v_lshlrev_b32 v180, 16, v33
    v_and_b32 v196, s25, v33
    v_lshlrev_b32 v181, 16, v37
    v_and_b32 v197, s25, v37
    v_lshlrev_b32 v182, 16, v41
    v_and_b32 v198, s25, v41
    v_lshlrev_b32 v183, 16, v45
    v_and_b32 v199, s25, v45
    v_lshlrev_b32 v184, 16, v49
    v_and_b32 v200, s25, v49
    v_lshlrev_b32 v185, 16, v53
    v_and_b32 v201, s25, v53
    v_lshlrev_b32 v186, 16, v57
    v_and_b32 v202, s25, v57
    v_lshlrev_b32 v187, 16, v61
    v_and_b32 v203, s25, v61
    v_lshlrev_b32 v188, 16, v65
    v_and_b32 v204, s25, v65
    v_lshlrev_b32 v189, 16, v69
    v_and_b32 v205, s25, v69
    v_lshlrev_b32 v190, 16, v73
    v_and_b32 v206, s25, v73
    v_lshlrev_b32 v191, 16, v77
    v_and_b32 v207, s25, v77
    s_branch L_k1_pdone
L_k1_p2:
    s_cmp_lg_u32 s21, 2
    s_cbranch_scc1 L_k1_p3
    v_lshlrev_b32 v176, 16, v18
    v_and_b32 v192, s25, v18
    v_lshlrev_b32 v177, 16, v22
    v_and_b32 v193, s25, v22
    v_lshlrev_b32 v178, 16, v26
    v_and_b32 v194, s25, v26
    v_lshlrev_b32 v179, 16, v30
    v_and_b32 v195, s25, v30
    v_lshlrev_b32 v180, 16, v34
    v_and_b32 v196, s25, v34
    v_lshlrev_b32 v181, 16, v38
    v_and_b32 v197, s25, v38
    v_lshlrev_b32 v182, 16, v42
    v_and_b32 v198, s25, v42
    v_lshlrev_b32 v183, 16, v46
    v_and_b32 v199, s25, v46
    v_lshlrev_b32 v184, 16, v50
    v_and_b32 v200, s25, v50
    v_lshlrev_b32 v185, 16, v54
    v_and_b32 v201, s25, v54
    v_lshlrev_b32 v186, 16, v58
    v_and_b32 v202, s25, v58
    v_lshlrev_b32 v187, 16, v62
    v_and_b32 v203, s25, v62
    v_lshlrev_b32 v188, 16, v66
    v_and_b32 v204, s25, v66
    v_lshlrev_b32 v189, 16, v70
    v_and_b32 v205, s25, v70
    v_lshlrev_b32 v190, 16, v74
    v_and_b32 v206, s25, v74
    v_lshlrev_b32 v191, 16, v78
    v_and_b32 v207, s25, v78
    s_branch L_k1_pdone
L_k1_p3:
    v_lshlrev_b32 v176, 16, v19
    v_and_b32 v192, s25, v19
    v_lshlrev_b32 v177, 16, v23
    v_and_b32 v193, s25, v23
    v_lshlrev_b32 v178, 16, v27
    v_and_b32 v194, s25, v27
    v_lshlrev_b32 v179, 16, v31
    v_and_b32 v195, s25, v31
    v_lshlrev_b32 v180, 16, v35
    v_and_b32 v196, s25, v35
    v_lshlrev_b32 v181, 16, v39
    v_and_b32 v197, s25, v39
    v_lshlrev_b32 v182, 16, v43
    v_and_b32 v198, s25, v43
    v_lshlrev_b32 v183, 16, v47
    v_and_b32 v199, s25, v47
    v_lshlrev_b32 v184, 16, v51
    v_and_b32 v200, s25, v51
    v_lshlrev_b32 v185, 16, v55
    v_and_b32 v201, s25, v55
    v_lshlrev_b32 v186, 16, v59
    v_and_b32 v202, s25, v59
    v_lshlrev_b32 v187, 16, v63
    v_and_b32 v203, s25, v63
    v_lshlrev_b32 v188, 16, v67
    v_and_b32 v204, s25, v67
    v_lshlrev_b32 v189, 16, v71
    v_and_b32 v205, s25, v71
    v_lshlrev_b32 v190, 16, v75
    v_and_b32 v206, s25, v75
    v_lshlrev_b32 v191, 16, v79
    v_and_b32 v207, s25, v79
L_k1_pdone:
    s_waitcnt lgkmcnt(0)
    v_pk_add_f32 v[96:97], v[96:97], v[98:99]
    v_pk_add_f32 v[100:101], v[100:101], v[102:103]
    v_pk_add_f32 v[96:97], v[96:97], v[100:101]
    v_mul_f32 v96, 0x3b000000, v96
    v_mul_f32 v97, 0x3b000000, v97
    v_fma_f32 v97, -v96, v96, v97
    v_max_f32 v97, 0, v97
    v_add_f32 v97, 0x3727c5ac, v97
    v_rsq_f32 v97, v97
    v_mul_f32 v96, -1.0, v96
    v_mul_f32 v96, v96, v97
    ds_write2st64_b32 v12, v97, v96 offset0:8 offset1:9
    s_waitcnt lgkmcnt(0)
    ds_read_b128 v[80:83], v13 offset:2048
    ds_read_b128 v[96:99], v13 offset:2304
    ds_read_b128 v[84:87], v13 offset:2064
    ds_read_b128 v[100:103], v13 offset:2320
    ds_read_b128 v[88:91], v13 offset:2176
    ds_read_b128 v[104:107], v13 offset:2432
    ds_read_b128 v[92:95], v13 offset:2192
    ds_read_b128 v[108:111], v13 offset:2448
    s_waitcnt lgkmcnt(4)
    v_pk_fma_f32 v[176:177], v[176:177], v[80:81], v[96:97]
    v_pk_fma_f32 v[178:179], v[178:179], v[82:83], v[98:99]
    v_pk_fma_f32 v[180:181], v[180:181], v[84:85], v[100:101]
    v_pk_fma_f32 v[182:183], v[182:183], v[86:87], v[102:103]
    v_pk_fma_f32 v[192:193], v[192:193], v[80:81], v[96:97]
    v_pk_fma_f32 v[194:195], v[194:195], v[82:83], v[98:99]
    v_pk_fma_f32 v[196:197], v[196:197], v[84:85], v[100:101]
    v_pk_fma_f32 v[198:199], v[198:199], v[86:87], v[102:103]
    s_waitcnt lgkmcnt(0)
    v_pk_fma_f32 v[184:185], v[184:185], v[88:89], v[104:105]
    v_pk_fma_f32 v[186:187], v[186:187], v[90:91], v[106:107]
    v_pk_fma_f32 v[188:189], v[188:189], v[92:93], v[108:109]
    v_pk_fma_f32 v[190:191], v[190:191], v[94:95], v[110:111]
    v_pk_fma_f32 v[200:201], v[200:201], v[88:89], v[104:105]
    v_pk_fma_f32 v[202:203], v[202:203], v[90:91], v[106:107]
    v_pk_fma_f32 v[204:205], v[204:205], v[92:93], v[108:109]
    v_pk_fma_f32 v[206:207], v[206:207], v[94:95], v[110:111]
    v_cvt_pk_bf16_f32 v16, v176, v177
    v_cvt_pk_bf16_f32 v17, v178, v179
    v_cvt_pk_bf16_f32 v18, v180, v181
    v_cvt_pk_bf16_f32 v19, v182, v183
    v_cvt_pk_bf16_f32 v20, v184, v185
    v_cvt_pk_bf16_f32 v21, v186, v187
    v_mfma_f32_16x16x32_bf16 v[32:35], v[16:19], v[128:131], 0
    v_cvt_pk_bf16_f32 v22, v188, v189
    v_cvt_pk_bf16_f32 v23, v190, v191
    v_mfma_f32_16x16x32_bf16 v[36:39], v[16:19], v[136:139], 0
    v_cvt_pk_bf16_f32 v24, v192, v193
    v_cvt_pk_bf16_f32 v25, v194, v195
    v_mfma_f32_16x16x32_bf16 v[32:35], v[20:23], v[132:135], v[32:35]
    v_cvt_pk_bf16_f32 v26, v196, v197
    v_cvt_pk_bf16_f32 v27, v198, v199
    v_mfma_f32_16x16x32_bf16 v[36:39], v[20:23], v[140:143], v[36:39]
    v_cvt_pk_bf16_f32 v28, v200, v201
    v_cvt_pk_bf16_f32 v29, v202, v203
    v_mfma_f32_16x16x32_bf16 v[40:43], v[16:19], v[144:147], 0
    v_cvt_pk_bf16_f32 v30, v204, v205
    v_cvt_pk_bf16_f32 v31, v206, v207
    v_mfma_f32_16x16x32_bf16 v[44:47], v[16:19], v[152:155], 0
    s_nop 1
    v_cvt_pk_bf16_f32 v64, v32, v36
    v_cvt_pk_bf16_f32 v65, v33, v37
    v_mfma_f32_16x16x32_bf16 v[40:43], v[20:23], v[148:151], v[40:43]
    v_cvt_pk_bf16_f32 v66, v34, v38
    v_cvt_pk_bf16_f32 v67, v35, v39
    v_mfma_f32_16x16x32_bf16 v[44:47], v[20:23], v[156:159], v[44:47]
    ds_write_b128 v14, v[64:67] offset:4096
    v_mfma_f32_16x16x32_bf16 v[48:51], v[24:27], v[128:131], 0
    v_mfma_f32_16x16x32_bf16 v[52:55], v[24:27], v[136:139], 0
    s_nop 4
    v_cvt_pk_bf16_f32 v68, v40, v44
    v_cvt_pk_bf16_f32 v69, v41, v45
    v_mfma_f32_16x16x32_bf16 v[48:51], v[28:31], v[132:135], v[48:51]
    v_cvt_pk_bf16_f32 v70, v42, v46
    v_cvt_pk_bf16_f32 v71, v43, v47
    v_mfma_f32_16x16x32_bf16 v[52:55], v[28:31], v[140:143], v[52:55]
    ds_write_b128 v14, v[68:71] offset:12544
    v_mfma_f32_16x16x32_bf16 v[56:59], v[24:27], v[144:147], 0
    v_mfma_f32_16x16x32_bf16 v[60:63], v[24:27], v[152:155], 0
    s_nop 4
    v_cvt_pk_bf16_f32 v72, v48, v52
    v_cvt_pk_bf16_f32 v73, v49, v53
    v_mfma_f32_16x16x32_bf16 v[56:59], v[28:31], v[148:151], v[56:59]
    v_cvt_pk_bf16_f32 v74, v50, v54
    v_cvt_pk_bf16_f32 v75, v51, v55
    v_mfma_f32_16x16x32_bf16 v[60:63], v[28:31], v[156:159], v[60:63]
    ds_write_b128 v14, v[72:75] offset:4352
    s_nop 6
    v_cvt_pk_bf16_f32 v76, v56, v60
    v_cvt_pk_bf16_f32 v77, v57, v61
    v_cvt_pk_bf16_f32 v78, v58, v62
    v_cvt_pk_bf16_f32 v79, v59, v63
    ds_write_b128 v14, v[76:79] offset:12800
    s_waitcnt lgkmcnt(0)
    s_barrier
    ds_read_b128 v[64:67], v15 offset:4096
    ds_read_b128 v[68:71], v15 offset:5152
    ds_read_b128 v[72:75], v15 offset:6208
    ds_read_b128 v[76:79], v15 offset:7264
    s_waitcnt lgkmcnt(3)
    buffer_store_dwordx4 v[64:67], v112, s[12:15], s26 offen sc1
    s_add_u32 s26, s26, 0x20000
    s_waitcnt lgkmcnt(2)
    buffer_store_dwordx4 v[68:71], v112, s[12:15], s26 offen sc1
    s_add_u32 s26, s26, 0x20000
    s_waitcnt lgkmcnt(1)
    buffer_store_dwordx4 v[72:75], v112, s[12:15], s26 offen sc1
    s_add_u32 s26, s26, 0x20000
    s_waitcnt lgkmcnt(0)
    buffer_store_dwordx4 v[76:79], v112, s[12:15], s26 offen sc1
    s_endpgm
L_k1_side:
    s_cmp_ge_u32 s2, 224
    s_cbranch_scc1 L_k1_pf
    s_load_dwordx4 s[4:7], s[0:1], 56
    s_load_dwordx2 s[16:17], s[0:1], 88
    s_sub_u32 s20, s2, 128
    s_and_b32 s21, s20, 7
    s_lshr_b32 s22, s20, 4
    s_lshl_b32 s22, s22, 3
    s_add_u32 s21, s21, s22
    s_lshl_b32 s21, s21, 1
    s_bfe_u32 s22, s20, 0x10003
    s_add_u32 s21, s21, s22
    v_and_b32 v1, 3, v0
    v_lshrrev_b32 v2, 2, v0
    v_mul_u32_u24 v3, 6144, v2
    v_lshl_add_u32 v3, v1, 4, v3
    v_lshlrev_b32 v4, 1, v2
    s_lshl_b32 s22, s21, 6
    s_waitcnt lgkmcnt(0)
    s_mov_b32 s8, s6
    s_mov_b32 s9, s7
    s_mov_b32 s10, 3145728
    s_mov_b32 s11, 0x00020000
    s_mov_b32 s12, s4
    s_mov_b32 s13, s5
    s_mov_b32 s14, 1024
    s_mov_b32 s15, 0x00020000
    buffer_load_ushort v8, v4, s[12:15], 0 offen offset:0
    buffer_load_ushort v9, v4, s[12:15], 0 offen offset:128
    buffer_load_ushort v10, v4, s[12:15], 0 offen offset:256
    buffer_load_ushort v11, v4, s[12:15], 0 offen offset:384
    buffer_load_ushort v12, v4, s[12:15], 0 offen offset:512
    buffer_load_ushort v13, v4, s[12:15], 0 offen offset:640
    buffer_load_ushort v14, v4, s[12:15], 0 offen offset:768
    buffer_load_ushort v15, v4, s[12:15], 0 offen offset:896
    s_add_u32 s23, s22, 0
    buffer_load_dwordx4 v[16:19], v3, s[8:11], s23 offen
    s_add_u32 s23, s22, 393216
    buffer_load_dwordx4 v[20:23], v3, s[8:11], s23 offen
    s_add_u32 s23, s22, 786432
    buffer_load_dwordx4 v[24:27], v3, s[8:11], s23 offen
    s_add_u32 s23, s22, 1179648
    buffer_load_dwordx4 v[28:31], v3, s[8:11], s23 offen
    s_add_u32 s23, s22, 1572864
    buffer_load_dwordx4 v[32:35], v3, s[8:11], s23 offen
    s_add_u32 s23, s22, 1966080
    buffer_load_dwordx4 v[36:39], v3, s[8:11], s23 offen
    s_add_u32 s23, s22, 2359296
    buffer_load_dwordx4 v[40:43], v3, s[8:11], s23 offen
    s_add_u32 s23, s22, 2752512
    buffer_load_dwordx4 v[44:47], v3, s[8:11], s23 offen
    s_mov_b32 s12, s16
    s_mov_b32 s13, s17
    s_mov_b32 s14, 12288
    s_mov_b32 s15, 0x00020000
    s_mov_b32 s25, 0xffff0000
    s_waitcnt vmcnt(8)
    v_lshlrev_b32 v8, 16, v8
    v_mul_f32 v48, 0xbfb8aa3b, v8
    v_exp_f32 v48, v48
    v_lshlrev_b32 v9, 16, v9
    v_mul_f32 v49, 0xbfb8aa3b, v9
    v_exp_f32 v49, v49
    v_lshlrev_b32 v10, 16, v10
    v_mul_f32 v50, 0xbfb8aa3b, v10
    v_exp_f32 v50, v50
    v_lshlrev_b32 v11, 16, v11
    v_mul_f32 v51, 0xbfb8aa3b, v11
    v_exp_f32 v51, v51
    v_lshlrev_b32 v12, 16, v12
    v_mul_f32 v52, 0xbfb8aa3b, v12
    v_exp_f32 v52, v52
    v_lshlrev_b32 v13, 16, v13
    v_mul_f32 v53, 0xbfb8aa3b, v13
    v_exp_f32 v53, v53
    v_lshlrev_b32 v14, 16, v14
    v_mul_f32 v54, 0xbfb8aa3b, v14
    v_exp_f32 v54, v54
    v_lshlrev_b32 v15, 16, v15
    v_mul_f32 v55, 0xbfb8aa3b, v15
    v_exp_f32 v55, v55
    v_add_f32 v48, 1.0, v48
    v_rcp_f32 v48, v48
    v_add_f32 v49, 1.0, v49
    v_rcp_f32 v49, v49
    v_add_f32 v50, 1.0, v50
    v_rcp_f32 v50, v50
    v_add_f32 v51, 1.0, v51
    v_rcp_f32 v51, v51
    v_add_f32 v52, 1.0, v52
    v_rcp_f32 v52, v52
    v_add_f32 v53, 1.0, v53
    v_rcp_f32 v53, v53
    v_add_f32 v54, 1.0, v54
    v_rcp_f32 v54, v54
    v_add_f32 v55, 1.0, v55
    v_rcp_f32 v55, v55
    v_mul_f32 v8, v8, v48
    v_cvt_pk_bf16_f32 v8, v8, v8
    v_and_b32 v8, s25, v8
    v_mul_f32 v9, v9, v49
    v_cvt_pk_bf16_f32 v9, v9, v9
    v_and_b32 v9, s25, v9
    v_mul_f32 v10, v10, v50
    v_cvt_pk_bf16_f32 v10, v10, v10
    v_and_b32 v10, s25, v10
    v_mul_f32 v11, v11, v51
    v_cvt_pk_bf16_f32 v11, v11, v11
    v_and_b32 v11, s25, v11
    v_mul_f32 v12, v12, v52
    v_cvt_pk_bf16_f32 v12, v12, v12
    v_and_b32 v12, s25, v12
    v_mul_f32 v13, v13, v53
    v_cvt_pk_bf16_f32 v13, v13, v13
    v_and_b32 v13, s25, v13
    v_mul_f32 v14, v14, v54
    v_cvt_pk_bf16_f32 v14, v14, v14
    v_and_b32 v14, s25, v14
    v_mul_f32 v15, v15, v55
    v_cvt_pk_bf16_f32 v15, v15, v15
    v_and_b32 v15, s25, v15
    s_waitcnt vmcnt(7)
    v_lshlrev_b32 v56, 16, v16
    v_and_b32 v57, s25, v16
    v_mul_f32 v48, v56, v8
    v_mul_f32 v49, v57, v8
    v_lshlrev_b32 v56, 16, v17
    v_and_b32 v57, s25, v17
    v_mul_f32 v50, v56, v8
    v_mul_f32 v51, v57, v8
    v_lshlrev_b32 v56, 16, v18
    v_and_b32 v57, s25, v18
    v_mul_f32 v52, v56, v8
    v_mul_f32 v53, v57, v8
    v_lshlrev_b32 v56, 16, v19
    v_and_b32 v57, s25, v19
    v_mul_f32 v54, v56, v8
    v_mul_f32 v55, v57, v8
    s_waitcnt vmcnt(6)
    v_lshlrev_b32 v56, 16, v20
    v_and_b32 v57, s25, v20
    v_fmac_f32 v48, v56, v9
    v_fmac_f32 v49, v57, v9
    v_lshlrev_b32 v56, 16, v21
    v_and_b32 v57, s25, v21
    v_fmac_f32 v50, v56, v9
    v_fmac_f32 v51, v57, v9
    v_lshlrev_b32 v56, 16, v22
    v_and_b32 v57, s25, v22
    v_fmac_f32 v52, v56, v9
    v_fmac_f32 v53, v57, v9
    v_lshlrev_b32 v56, 16, v23
    v_and_b32 v57, s25, v23
    v_fmac_f32 v54, v56, v9
    v_fmac_f32 v55, v57, v9
    s_waitcnt vmcnt(5)
    v_lshlrev_b32 v56, 16, v24
    v_and_b32 v57, s25, v24
    v_fmac_f32 v48, v56, v10
    v_fmac_f32 v49, v57, v10
    v_lshlrev_b32 v56, 16, v25
    v_and_b32 v57, s25, v25
    v_fmac_f32 v50, v56, v10
    v_fmac_f32 v51, v57, v10
    v_lshlrev_b32 v56, 16, v26
    v_and_b32 v57, s25, v26
    v_fmac_f32 v52, v56, v10
    v_fmac_f32 v53, v57, v10
    v_lshlrev_b32 v56, 16, v27
    v_and_b32 v57, s25, v27
    v_fmac_f32 v54, v56, v10
    v_fmac_f32 v55, v57, v10
    s_waitcnt vmcnt(4)
    v_lshlrev_b32 v56, 16, v28
    v_and_b32 v57, s25, v28
    v_fmac_f32 v48, v56, v11
    v_fmac_f32 v49, v57, v11
    v_lshlrev_b32 v56, 16, v29
    v_and_b32 v57, s25, v29
    v_fmac_f32 v50, v56, v11
    v_fmac_f32 v51, v57, v11
    v_lshlrev_b32 v56, 16, v30
    v_and_b32 v57, s25, v30
    v_fmac_f32 v52, v56, v11
    v_fmac_f32 v53, v57, v11
    v_lshlrev_b32 v56, 16, v31
    v_and_b32 v57, s25, v31
    v_fmac_f32 v54, v56, v11
    v_fmac_f32 v55, v57, v11
    s_waitcnt vmcnt(3)
    v_lshlrev_b32 v56, 16, v32
    v_and_b32 v57, s25, v32
    v_fmac_f32 v48, v56, v12
    v_fmac_f32 v49, v57, v12
    v_lshlrev_b32 v56, 16, v33
    v_and_b32 v57, s25, v33
    v_fmac_f32 v50, v56, v12
    v_fmac_f32 v51, v57, v12
    v_lshlrev_b32 v56, 16, v34
    v_and_b32 v57, s25, v34
    v_fmac_f32 v52, v56, v12
    v_fmac_f32 v53, v57, v12
    v_lshlrev_b32 v56, 16, v35
    v_and_b32 v57, s25, v35
    v_fmac_f32 v54, v56, v12
    v_fmac_f32 v55, v57, v12
    s_waitcnt vmcnt(2)
    v_lshlrev_b32 v56, 16, v36
    v_and_b32 v57, s25, v36
    v_fmac_f32 v48, v56, v13
    v_fmac_f32 v49, v57, v13
    v_lshlrev_b32 v56, 16, v37
    v_and_b32 v57, s25, v37
    v_fmac_f32 v50, v56, v13
    v_fmac_f32 v51, v57, v13
    v_lshlrev_b32 v56, 16, v38
    v_and_b32 v57, s25, v38
    v_fmac_f32 v52, v56, v13
    v_fmac_f32 v53, v57, v13
    v_lshlrev_b32 v56, 16, v39
    v_and_b32 v57, s25, v39
    v_fmac_f32 v54, v56, v13
    v_fmac_f32 v55, v57, v13
    s_waitcnt vmcnt(1)
    v_lshlrev_b32 v56, 16, v40
    v_and_b32 v57, s25, v40
    v_fmac_f32 v48, v56, v14
    v_fmac_f32 v49, v57, v14
    v_lshlrev_b32 v56, 16, v41
    v_and_b32 v57, s25, v41
    v_fmac_f32 v50, v56, v14
    v_fmac_f32 v51, v57, v14
    v_lshlrev_b32 v56, 16, v42
    v_and_b32 v57, s25, v42
    v_fmac_f32 v52, v56, v14
    v_fmac_f32 v53, v57, v14
    v_lshlrev_b32 v56, 16, v43
    v_and_b32 v57, s25, v43
    v_fmac_f32 v54, v56, v14
    v_fmac_f32 v55, v57, v14
    s_waitcnt vmcnt(0)
    v_lshlrev_b32 v56, 16, v44
    v_and_b32 v57, s25, v44
    v_fmac_f32 v48, v56, v15
    v_fmac_f32 v49, v57, v15
    v_lshlrev_b32 v56, 16, v45
    v_and_b32 v57, s25, v45
    v_fmac_f32 v50, v56, v15
    v_fmac_f32 v51, v57, v15
    v_lshlrev_b32 v56, 16, v46
    v_and_b32 v57, s25, v46
    v_fmac_f32 v52, v56, v15
    v_fmac_f32 v53, v57, v15
    v_lshlrev_b32 v56, 16, v47
    v_and_b32 v57, s25, v47
    v_fmac_f32 v54, v56, v15
    v_fmac_f32 v55, v57, v15
    v_add_f32_dpp v48, v48, v48 row_ror:4 row_mask:0xf bank_mask:0xf
    v_add_f32_dpp v49, v49, v49 row_ror:4 row_mask:0xf bank_mask:0xf
    v_add_f32_dpp v50, v50, v50 row_ror:4 row_mask:0xf bank_mask:0xf
    v_add_f32_dpp v51, v51, v51 row_ror:4 row_mask:0xf bank_mask:0xf
    v_add_f32_dpp v52, v52, v52 row_ror:4 row_mask:0xf bank_mask:0xf
    v_add_f32_dpp v53, v53, v53 row_ror:4 row_mask:0xf bank_mask:0xf
    v_add_f32_dpp v54, v54, v54 row_ror:4 row_mask:0xf bank_mask:0xf
    v_add_f32_dpp v55, v55, v55 row_ror:4 row_mask:0xf bank_mask:0xf
    v_add_f32_dpp v48, v48, v48 row_ror:8 row_mask:0xf bank_mask:0xf
    v_add_f32_dpp v49, v49, v49 row_ror:8 row_mask:0xf bank_mask:0xf
    v_add_f32_dpp v50, v50, v50 row_ror:8 row_mask:0xf bank_mask:0xf
    v_add_f32_dpp v51, v51, v51 row_ror:8 row_mask:0xf bank_mask:0xf
    v_add_f32_dpp v52, v52, v52 row_ror:8 row_mask:0xf bank_mask:0xf
    v_add_f32_dpp v53, v53, v53 row_ror:8 row_mask:0xf bank_mask:0xf
    v_add_f32_dpp v54, v54, v54 row_ror:8 row_mask:0xf bank_mask:0xf
    v_add_f32_dpp v55, v55, v55 row_ror:8 row_mask:0xf bank_mask:0xf
    v_lshrrev_b32 v5, 4, v0
    v_lshlrev_b32 v5, 7, v5
    v_lshl_add_u32 v5, v1, 5, v5
    ds_write_b128 v5, v[48:51]
    ds_write_b128 v5, v[52:55] offset:16
    v_lshlrev_b32 v6, 2, v0
    s_waitcnt lgkmcnt(0)
    s_barrier
    v_cmp_gt_u32 vcc, 32, v0
    s_nop 2
    s_and_saveexec_b64 s[26:27], vcc
    s_cbranch_execz L_k1_end
    ds_read2_b32 v[16:17], v6 offset0:0 offset1:32
    v_add_u32 v7, 1024, v6
    ds_read2_b32 v[18:19], v6 offset0:64 offset1:96
    ds_read2_b32 v[20:21], v6 offset0:128 offset1:160
    ds_read2_b32 v[22:23], v6 offset0:192 offset1:224
    ds_read2_b32 v[24:25], v7 offset0:0 offset1:32
    ds_read2_b32 v[26:27], v7 offset0:64 offset1:96
    ds_read2_b32 v[28:29], v7 offset0:128 offset1:160
    ds_read2_b32 v[30:31], v7 offset0:192 offset1:224
    s_waitcnt lgkmcnt(0)
    v_pk_add_f32 v[16:17], v[16:17], v[24:25]
    v_pk_add_f32 v[18:19], v[18:19], v[26:27]
    v_pk_add_f32 v[20:21], v[20:21], v[28:29]
    v_pk_add_f32 v[22:23], v[22:23], v[30:31]
    v_pk_add_f32 v[16:17], v[16:17], v[20:21]
    v_pk_add_f32 v[18:19], v[18:19], v[22:23]
    v_pk_add_f32 v[16:17], v[16:17], v[18:19]
    v_add_f32 v16, v16, v17
    v_cvt_pk_bf16_f32 v16, v16, v16
    v_and_b32 v16, s25, v16
    s_lshr_b32 s23, s21, 4
    s_cmp_eq_u32 s23, 1
    s_cselect_b32 s24, 1.0, 0
    s_cmp_eq_u32 s23, 4
    s_cselect_b32 s24, 1.0, s24
    v_add_f32 v16, s24, v16
    v_cvt_pk_bf16_f32 v16, v16, v16
    v_and_b32 v16, s25, v16
    s_and_b32 s22, s21, 15
    s_lshl_b32 s22, s22, 5
    v_add_u32 v17, s22, v0
    v_and_b32 v18, 7, v17
    v_lshlrev_b32 v18, 6, v18
    v_lshrrev_b32 v19, 7, v17
    v_lshl_add_u32 v18, v19, 4, v18
    v_bfe_u32 v19, v17, 3, 2
    v_lshl_add_u32 v18, v19, 2, v18
    v_bfe_u32 v20, v17, 5, 2
    v_add_u32 v18, v18, v20
    s_cmp_lt_u32 s23, 2
    s_cselect_b64 vcc, -1, 0
    v_cndmask_b32 v17, v17, v18, vcc
    v_lshlrev_b32 v17, 2, v17
    s_lshl_b32 s22, s23, 11
    buffer_store_dword v16, v17, s[12:15], s22 offen sc1
    s_endpgm
L_k1_wpk:
    s_cmp_ge_u32 s2, 360
    s_cbranch_scc1 L_k1_fill
    s_load_dwordx4 s[4:7], s[0:1], 8
    s_sub_u32 s20, s2, 232
    s_and_b32 s21, s20, 31
    s_lshr_b32 s22, s20, 5
    s_sub_u32 s23, 0, s21
    s_bitcmp1_b32 s22, 0
    s_cselect_b32 s23, s23, s21
    s_add_u32 s24, s22, 1
    s_lshr_b32 s24, s24, 1
    s_lshl_b32 s24, s24, 6
    s_add_u32 s23, s23, s24
    s_cmp_eq_u32 s20, 64
    s_cselect_b32 s23, 32, s23
    s_cmp_eq_u32 s20, 96
    s_cselect_b32 s23, 96, s23
    s_mul_i32 s23, s23, 514
    v_lshrrev_b32 v1, 4, v0
    v_and_b32 v2, 15, v0
    v_mul_u32_u24 v1, 65792, v1
    v_min_u32 v2, 8, v2
    v_lshl_add_u32 v1, v2, 6, v1
    s_waitcnt lgkmcnt(0)
    s_mov_b32 s8, s4
    s_mov_b32 s9, s5
    s_mov_b32 s10, 1052672
    s_mov_b32 s11, 0x00020000
    s_mov_b32 s12, s6
    s_mov_b32 s13, s7
    s_mov_b32 s14, 1052672
    s_mov_b32 s15, 0x00020000
    buffer_load_ushort v4, v1, s[8:11], s23 offen
    buffer_load_ushort v5, v1, s[12:15], s23 offen
    s_waitcnt vmcnt(0)
    s_endpgm
L_k1_fill:
    s_cmp_ge_u32 s2, 408
    s_cbranch_scc1 L_k1_end
    s_load_dwordx4 s[4:7], s[0:1], 32
    s_load_dwordx2 s[16:17], s[0:1], 48
    s_sub_u32 s21, s2, 360
    s_lshl_b32 s21, s21, 15
    v_lshlrev_b32 v1, 7, v0
    s_waitcnt lgkmcnt(0)
    s_mov_b32 s8, s16
    s_mov_b32 s9, s17
    s_mov_b32 s10, 1409024
    s_mov_b32 s11, 0x00020000
    buffer_load_dword v4, v1, s[8:11], s21 offen
    s_waitcnt vmcnt(0)
    s_endpgm
L_k1_pf:
    s_cmp_ge_u32 s2, 232
    s_cbranch_scc1 L_k1_wpk
    s_getpc_b64 s[4:5]
L_k1_pc:
    s_add_u32 s4, s4, L_code_k2-L_k1_pc
    s_addc_u32 s5, s5, 0
    v_lshlrev_b32 v1, 4, v0
    global_load_dwordx4 v[4:7], v1, s[4:5]
    v_add_u32 v1, 0x1000, v1
    global_load_dwordx4 v[4:7], v1, s[4:5]
    v_add_u32 v1, 0x1000, v1
    global_load_dwordx4 v[4:7], v1, s[4:5]
    v_add_u32 v1, 0x1000, v1
    global_load_dwordx4 v[4:7], v1, s[4:5]
    v_add_u32 v1, 0x1000, v1
    global_load_dwordx4 v[4:7], v1, s[4:5]
    v_add_u32 v1, 0x1000, v1
    global_load_dwordx4 v[4:7], v1, s[4:5]
    v_add_u32 v1, 0x1000, v1
    global_load_dwordx4 v[4:7], v1, s[4:5]
    v_add_u32 v1, 0x1000, v1
    global_load_dwordx4 v[4:7], v1, s[4:5]
    s_waitcnt vmcnt(0)
L_k1_end:
    s_endpgm
.p2align 8
L_code_k2:
.globl k2_kernel
.p2align 8
.type k2_kernel,@function
k2_kernel:
    s_cmp_ge_u32 s2, 129
    s_cbranch_scc1 L_k2_side
    s_load_dwordx2 s[6:7], s[0:1], 88
    s_load_dwordx4 s[40:43], s[0:1], 8
    s_and_b32 s3, s2, 7
    s_lshr_b32 s4, s2, 5
    s_lshl_b32 s4, s4, 3
    s_add_u32 s3, s3, s4
    s_bfe_u32 s5, s2, 0x20003
    s_and_b32 s34, s5, 1
    s_sub_u32 s4, 0, s3
    s_cmp_eq_u32 s34, 1
    s_cselect_b32 s3, s4, s3
    s_add_u32 s5, s5, 1
    s_lshr_b32 s5, s5, 1
    s_lshl_b32 s5, s5, 6
    s_add_u32 s3, s3, s5
    s_cmp_eq_u32 s2, 16
    s_cselect_b32 s3, 32, s3
    s_cmp_eq_u32 s2, 128
    s_cselect_b32 s3, 96, s3
    v_and_b32 v1, 15, v0
    v_bfe_u32 v2, v0, 4, 2
    v_lshrrev_b32 v3, 6, v0
    v_lshlrev_b32 v7, 8, v3
    v_lshl_add_u32 v7, v1, 4, v7
    v_lshl_add_u32 v4, v2, 13, v7
    v_and_b32 v15, 63, v0
    v_lshlrev_b32 v15, 4, v15
    v_lshlrev_b32 v6, 2, v0
    v_readfirstlane_b32 s27, v3
    s_and_b32 s20, s3, 63
    s_sub_u32 s21, 64, s20
    s_cmp_gt_u32 s20, 32
    s_cselect_b32 s21, s21, s20
    s_cselect_b32 s24, -1.0, 1.0
    s_and_b32 s21, s21, 31
    s_cmp_eq_u32 s21, 0
    s_cselect_b32 s24, 0, s24
    s_cmp_eq_u32 s20, 32
    s_cselect_b32 s22, 0, 1.0
    s_cselect_b32 s23, 1.0, 0
    s_lshl_b32 s21, s21, 16
    s_lshl_b32 s35, s34, 15
    s_add_u32 s36, s21, s35
    s_xor_b32 s35, s35, 0x8000
    s_add_u32 s37, s21, s35
    s_waitcnt lgkmcnt(0)
    s_add_u32 s8, s6, 131072
    s_addc_u32 s9, s7, 0
    s_mov_b32 s10, 2097152
    s_mov_b32 s11, 0x00020000
    s_add_u32 s25, s36, 0
    buffer_load_dwordx4 v[16:19], v4, s[8:11], s25 offen offset:0
    buffer_load_dwordx4 v[20:23], v4, s[8:11], s25 offen offset:2048
    s_add_u32 s25, s36, 4096
    buffer_load_dwordx4 v[24:27], v4, s[8:11], s25 offen offset:0
    buffer_load_dwordx4 v[28:31], v4, s[8:11], s25 offen offset:2048
    v_cvt_f32_u32 v8, v1
    v_cvt_f32_u32 v9, v2
    v_cvt_f32_u32 v11, s3
    v_and_b32 v12, 3, v1
    v_lshrrev_b32 v13, 2, v1
    v_and_b32 v5, 1, v1
    v_lshl_add_u32 v5, v13, 1, v5
    v_cvt_f32_u32 v5, v5
    v_cvt_f32_u32 v12, v12
    v_cvt_f32_u32 v13, v13
    s_cmp_ge_u32 s27, 5
    s_cbranch_scc1 L_k2_c5
    s_cmp_lt_u32 s27, 4
    s_mov_b32 s28, 0x3e800000
    s_mov_b32 s29, 0x3d000000
    s_cselect_b32 s28, s28, 0x3d800000
    s_cselect_b32 s29, s29, 0x3e800000
    s_cselect_b32 s30, 1.0, 4.0
    s_cselect_b32 s31, 0x41000000, 1.0
    s_bitcmp1_b32 s27, 1
    s_cselect_b32 s32, 0x3e000000, 0
    s_bitcmp1_b32 s27, 0
    s_cselect_b32 s33, 4.0, 0
    v_mul_f32 v12, s28, v12
    v_fma_f32 v12, s29, v13, v12
    v_add_f32 v12, s32, v12
    v_mul_f32 v13, s30, v9
    v_add_f32 v13, s33, v13
    v_mul_f32 v13, v13, v12
    v_mul_f32 v12, s31, v12
    s_mul_i32 s28, s27, 1536
    s_add_u32 s28, s28, 32768
    v_add_u32 v14, s28, v15
    v_lshrrev_b32 v10, 1, v15
    v_add_u32 v10, s28, v10
    v_cos_f32 v104, v13
    v_sin_f32 v108, v13
    v_add_f32 v13, v13, v12
    v_cos_f32 v105, v13
    v_sin_f32 v109, v13
    v_add_f32 v13, v13, v12
    v_cos_f32 v106, v13
    v_sin_f32 v110, v13
    v_add_f32 v13, v13, v12
    v_cos_f32 v107, v13
    v_sin_f32 v111, v13
    v_cvt_pk_bf16_f32 v114, v104, v105
    v_cvt_pk_bf16_f32 v115, v106, v107
    v_cvt_pk_bf16_f32 v112, -v108, -v109
    v_cvt_pk_bf16_f32 v113, -v110, -v111
    v_cvt_pk_bf16_f32 v116, v108, v109
    v_cvt_pk_bf16_f32 v117, v110, v111
    ds_write_b128 v14, v[112:115]
    ds_write_b64 v10, v[116:117] offset:1024
    s_cmp_lg_u32 s27, 4
    s_cbranch_scc1 L_k2_cdone
    v_mul_f32 v12, 0x3e000000, v5
    v_mul_f32 v13, 0x3a000000, v11
    v_mul_f32 v13, v13, v5
    v_mul_f32 v14, 4.0, v9
    v_fma_f32 v13, v14, v12, v13
    v_add_u32 v14, 40448, v15
    v_cmp_gt_u32 vcc, 2, v2
    v_cos_f32 v104, v13
    v_sin_f32 v105, v13
    s_nop 0
    v_cvt_pk_bf16_f32 v120, v104, v105
    v_cvt_pk_bf16_f32 v124, v105, -v104
    v_cndmask_b32 v120, 0, v120, vcc
    v_cndmask_b32 v124, 0, v124, vcc
    v_add_f32 v13, v13, v12
    v_cos_f32 v104, v13
    v_sin_f32 v105, v13
    s_nop 0
    v_cvt_pk_bf16_f32 v121, v104, v105
    v_cvt_pk_bf16_f32 v125, v105, -v104
    v_cndmask_b32 v121, 0, v121, vcc
    v_cndmask_b32 v125, 0, v125, vcc
    v_add_f32 v13, v13, v12
    v_cos_f32 v104, v13
    v_sin_f32 v105, v13
    s_nop 0
    v_cvt_pk_bf16_f32 v122, v104, v105
    v_cvt_pk_bf16_f32 v126, v105, -v104
    v_cndmask_b32 v122, 0, v122, vcc
    v_cndmask_b32 v126, 0, v126, vcc
    v_add_f32 v13, v13, v12
    v_cos_f32 v104, v13
    v_sin_f32 v105, v13
    s_nop 0
    v_cvt_pk_bf16_f32 v123, v104, v105
    v_cvt_pk_bf16_f32 v127, v105, -v104
    v_cndmask_b32 v123, 0, v123, vcc
    v_cndmask_b32 v127, 0, v127, vcc
    ds_write_b128 v14, v[120:123]
    ds_write_b128 v14, v[124:127] offset:1024
    s_branch L_k2_cdone
L_k2_c5:
    s_cmp_ge_u32 s27, 6
    s_cbranch_scc1 L_k2_c6
    v_mul_f32 v12, 0x3c800000, v12
    v_mul_f32 v13, 0x3b000000, v13
    v_add_f32 v12, v12, v13
    v_mul_f32 v14, 4.0, v9
    v_add_u32 v10, 42496, v15
    v_mul_f32 v13, v14, v12
    v_cos_f32 v104, v13
    v_sin_f32 v108, v13
    v_add_f32 v13, v13, v12
    v_cos_f32 v105, v13
    v_sin_f32 v109, v13
    v_add_f32 v13, v13, v12
    v_cos_f32 v106, v13
    v_sin_f32 v110, v13
    v_add_f32 v13, v13, v12
    v_cos_f32 v107, v13
    v_sin_f32 v111, v13
    ds_write_b128 v10, v[104:107] offset:0
    ds_write_b128 v10, v[108:111] offset:1024
    v_add_f32 v12, 0x3c000000, v12
    v_mul_f32 v13, v14, v12
    v_cos_f32 v112, v13
    v_sin_f32 v116, v13
    v_add_f32 v13, v13, v12
    v_cos_f32 v113, v13
    v_sin_f32 v117, v13
    v_add_f32 v13, v13, v12
    v_cos_f32 v114, v13
    v_sin_f32 v118, v13
    v_add_f32 v13, v13, v12
    v_cos_f32 v115, v13
    v_sin_f32 v119, v13
    ds_write_b128 v10, v[112:115] offset:2048
    ds_write_b128 v10, v[116:119] offset:3072
    s_branch L_k2_cdone
L_k2_c6:
    v_mul_f32 v12, 0x3e000000, v5
    v_mul_f32 v13, 0x3a000000, v11
    v_add_f32 v12, v12, v13
    s_xor_b32 s28, s27, s34
    s_bitcmp1_b32 s28, 0
    s_cselect_b32 s28, 0x41800000, 0
    s_bitcmp1_b32 s27, 0
    s_mov_b32 s29, 48640
    s_cselect_b32 s29, s29, 46592
    v_mul_f32 v13, 4.0, v9
    v_add_f32 v13, s28, v13
    v_mul_f32 v13, v13, v12
    v_add_u32 v10, s29, v15
    v_cos_f32 v104, v13
    v_sin_f32 v105, v13
    v_mul_f32 v106, s22, v104
    v_mul_f32 v107, s23, v104
    v_mul_f32 v108, s22, v105
    v_mul_f32 v109, s24, v104
    v_fma_f32 v107, s24, v105, v107
    v_fma_f32 v109, -s23, v105, v109
    v_cvt_pk_bf16_f32 v112, v106, v107
    v_cvt_pk_bf16_f32 v116, -v108, v109
    v_add_f32 v13, v13, v12
    v_cos_f32 v104, v13
    v_sin_f32 v105, v13
    v_mul_f32 v106, s22, v104
    v_mul_f32 v107, s23, v104
    v_mul_f32 v108, s22, v105
    v_mul_f32 v109, s24, v104
    v_fma_f32 v107, s24, v105, v107
    v_fma_f32 v109, -s23, v105, v109
    v_cvt_pk_bf16_f32 v113, v106, v107
    v_cvt_pk_bf16_f32 v117, -v108, v109
    v_add_f32 v13, v13, v12
    v_cos_f32 v104, v13
    v_sin_f32 v105, v13
    v_mul_f32 v106, s22, v104
    v_mul_f32 v107, s23, v104
    v_mul_f32 v108, s22, v105
    v_mul_f32 v109, s24, v104
    v_fma_f32 v107, s24, v105, v107
    v_fma_f32 v109, -s23, v105, v109
    v_cvt_pk_bf16_f32 v114, v106, v107
    v_cvt_pk_bf16_f32 v118, -v108, v109
    v_add_f32 v13, v13, v12
    v_cos_f32 v104, v13
    v_sin_f32 v105, v13
    v_mul_f32 v106, s22, v104
    v_mul_f32 v107, s23, v104
    v_mul_f32 v108, s22, v105
    v_mul_f32 v109, s24, v104
    v_fma_f32 v107, s24, v105, v107
    v_fma_f32 v109, -s23, v105, v109
    v_cvt_pk_bf16_f32 v115, v106, v107
    v_cvt_pk_bf16_f32 v119, -v108, v109
    ds_write_b128 v10, v[112:115]
    ds_write_b128 v10, v[116:119] offset:1024
L_k2_cdone:
    s_nop 1
    s_waitcnt lgkmcnt(0)
    s_barrier
    s_add_u32 s25, s37, 0
    buffer_load_dwordx4 v[32:35], v4, s[8:11], s25 offen offset:0
    buffer_load_dwordx4 v[36:39], v4, s[8:11], s25 offen offset:2048
    s_add_u32 s25, s37, 4096
    buffer_load_dwordx4 v[40:43], v4, s[8:11], s25 offen offset:0
    buffer_load_dwordx4 v[44:47], v4, s[8:11], s25 offen offset:2048
    s_mov_b32 s12, s6
    s_mov_b32 s13, s7
    s_mov_b32 s14, 12288
    s_mov_b32 s15, 0x00020000
    s_mov_b32 s16, s40
    s_mov_b32 s17, s41
    s_mov_b32 s18, 1052672
    s_mov_b32 s19, 0x00020000
    s_mov_b32 s44, s42
    s_mov_b32 s45, s43
    s_mov_b32 s46, 1052672
    s_mov_b32 s47, 0x00020000
    buffer_load_dword v100, v6, s[12:15], 0 offen offset:2048
    buffer_load_dword v101, v6, s[12:15], 0 offen
    s_mov_b32 s25, 4096
    buffer_load_dwordx4 v[96:99], v7, s[12:15], s25 offen
    s_lshl_b32 s28, s27, 8
    s_add_u32 s28, s28, s3
    s_sub_u32 s29, 2048, s28
    s_and_b32 s29, s29, 2047
    s_mul_i32 s28, s28, 514
    s_mul_i32 s29, s29, 514
    s_add_u32 s32, s29, -510
    v_cmp_gt_u32 vcc, 512, v15
    v_mov_b32 v102, s32
    v_mov_b32 v103, s28
    v_cndmask_b32 v102, v102, v103, vcc
    v_add_u32 v102, v102, v15
    s_add_u32 s28, s28, 512
    v_mov_b32 v238, s29
    v_writelane_b32 v238, s28, 1
    v_cvt_f32_u32 v10, v3
    v_mul_f32 v12, 0x3b000000, v8
    v_mul_f32 v13, v12, v10
    v_mul_f32 v12, 0x41000000, v12
    v_cos_f32 v182, v13
    v_sin_f32 v183, v13
    v_add_f32 v13, v13, v12
    v_cos_f32 v184, v13
    v_sin_f32 v185, v13
    v_add_f32 v13, v13, v12
    v_cos_f32 v186, v13
    v_sin_f32 v187, v13
    v_add_f32 v13, v13, v12
    v_cos_f32 v188, v13
    v_sin_f32 v189, v13
    s_add_u32 s8, s6, 4456448
    s_addc_u32 s9, s7, 0
    s_mov_b32 s10, 2113536
    s_mov_b32 s11, 0x00020000
    v_add_u32 v14, 32768, v15
    v_lshrrev_b32 v13, 1, v15
    v_add_u32 v13, 32768, v13
    s_cmp_eq_u32 s3, 0
    s_cselect_b32 s28, 0x45000000, 0
    v_cmp_eq_u32 vcc, 0, v1
    v_mov_b32 v11, s28
    s_nop 0
    v_cndmask_b32 v11, 0, v11, vcc
    ds_read_b128 v[128:131], v14 offset:13824
    ds_read_b128 v[132:135], v14 offset:14848
    ds_read_b128 v[136:139], v14 offset:15872
    ds_read_b128 v[140:143], v14 offset:16896
    ds_read_b128 v[144:147], v14 offset:6144
    ds_read_b64 v[148:149], v13 offset:7168
    s_waitcnt vmcnt(7)
    s_waitcnt lgkmcnt(4)
    v_mov_b32 v206, v16
    v_mov_b32 v207, v20
    v_mov_b32 v208, v24
    v_mov_b32 v209, v28
    v_mov_b32 v214, v17
    v_mov_b32 v215, v21
    v_mfma_f32_16x16x32_bf16 v[64:67], v[206:209], v[128:131], 0
    v_mov_b32 v216, v25
    v_mov_b32 v217, v29
    v_mfma_f32_16x16x32_bf16 v[68:71], v[206:209], v[132:135], 0
    v_mov_b32 v222, v18
    v_mov_b32 v223, v22
    v_mfma_f32_16x16x32_bf16 v[72:75], v[214:217], v[128:131], 0
    v_mov_b32 v224, v26
    v_mov_b32 v225, v30
    v_mfma_f32_16x16x32_bf16 v[76:79], v[214:217], v[132:135], 0
    v_mov_b32 v230, v19
    v_mov_b32 v231, v23
    v_mfma_f32_16x16x32_bf16 v[80:83], v[222:225], v[128:131], 0
    v_mov_b32 v232, v27
    v_mov_b32 v233, v31
    v_mfma_f32_16x16x32_bf16 v[84:87], v[222:225], v[132:135], 0
    s_waitcnt vmcnt(3)
    s_waitcnt lgkmcnt(2)
    v_mov_b32 v210, v32
    v_mov_b32 v211, v36
    v_mfma_f32_16x16x32_bf16 v[88:91], v[230:233], v[128:131], 0
    v_mov_b32 v212, v40
    v_mov_b32 v213, v44
    v_mfma_f32_16x16x32_bf16 v[92:95], v[230:233], v[132:135], 0
    v_mov_b32 v218, v33
    v_mov_b32 v219, v37
    v_mfma_f32_16x16x32_bf16 v[64:67], v[210:213], v[136:139], v[64:67]
    v_mov_b32 v220, v41
    v_mov_b32 v221, v45
    v_mfma_f32_16x16x32_bf16 v[68:71], v[210:213], v[140:143], v[68:71]
    v_mov_b32 v226, v34
    v_mov_b32 v227, v38
    v_mfma_f32_16x16x32_bf16 v[72:75], v[218:221], v[136:139], v[72:75]
    v_mov_b32 v228, v42
    v_mov_b32 v229, v46
    v_mfma_f32_16x16x32_bf16 v[76:79], v[218:221], v[140:143], v[76:79]
    v_mov_b32 v234, v35
    v_mov_b32 v235, v39
    v_mfma_f32_16x16x32_bf16 v[80:83], v[226:229], v[136:139], v[80:83]
    v_mov_b32 v236, v43
    v_mov_b32 v237, v47
    v_mfma_f32_16x16x32_bf16 v[84:87], v[226:229], v[140:143], v[84:87]
    s_waitcnt vmcnt(1)
    v_mul_f32_dpp v64, v100, v64 row_newbcast:0 row_mask:0xf bank_mask:0xf
    v_mul_f32_dpp v68, v100, v68 row_newbcast:0 row_mask:0xf bank_mask:0xf
    v_mfma_f32_16x16x32_bf16 v[88:91], v[234:237], v[136:139], v[88:91]
    v_mul_f32_dpp v65, v100, v65 row_newbcast:1 row_mask:0xf bank_mask:0xf
    v_mul_f32_dpp v69, v100, v69 row_newbcast:1 row_mask:0xf bank_mask:0xf
    v_mfma_f32_16x16x32_bf16 v[92:95], v[234:237], v[140:143], v[92:95]
    v_mul_f32_dpp v66, v100, v66 row_newbcast:2 row_mask:0xf bank_mask:0xf
    v_mul_f32_dpp v70, v100, v70 row_newbcast:2 row_mask:0xf bank_mask:0xf
    buffer_load_dwordx4 v[48:51], v102, s[16:19], 0 offen
    v_mul_f32_dpp v67, v100, v67 row_newbcast:3 row_mask:0xf bank_mask:0xf
    v_mul_f32_dpp v71, v100, v71 row_newbcast:3 row_mask:0xf bank_mask:0xf
    v_fmac_f32_dpp v64, v101, v11 row_newbcast:0 row_mask:0xf bank_mask:0xf
    v_fmac_f32_dpp v65, v101, v11 row_newbcast:1 row_mask:0xf bank_mask:0xf
    v_fmac_f32_dpp v66, v101, v11 row_newbcast:2 row_mask:0xf bank_mask:0xf
    v_fmac_f32_dpp v67, v101, v11 row_newbcast:3 row_mask:0xf bank_mask:0xf
    v_cvt_pk_bf16_f32 v104, v64, v65
    v_cvt_pk_bf16_f32 v105, v66, v67
    v_cvt_pk_bf16_f32 v106, v68, v69
    buffer_load_dwordx4 v[52:55], v102, s[44:47], 0 offen
    v_cvt_pk_bf16_f32 v107, v70, v71
    v_mul_f32_dpp v72, v100, v72 row_newbcast:4 row_mask:0xf bank_mask:0xf
    v_mul_f32_dpp v76, v100, v76 row_newbcast:4 row_mask:0xf bank_mask:0xf
    v_mul_f32_dpp v73, v100, v73 row_newbcast:5 row_mask:0xf bank_mask:0xf
    v_mul_f32_dpp v77, v100, v77 row_newbcast:5 row_mask:0xf bank_mask:0xf
    v_mul_f32_dpp v74, v100, v74 row_newbcast:6 row_mask:0xf bank_mask:0xf
    v_mul_f32_dpp v78, v100, v78 row_newbcast:6 row_mask:0xf bank_mask:0xf
    v_mul_f32_dpp v75, v100, v75 row_newbcast:7 row_mask:0xf bank_mask:0xf
    v_mul_f32_dpp v79, v100, v79 row_newbcast:7 row_mask:0xf bank_mask:0xf
    buffer_load_short_d16_hi v239, v238, s[16:19], 0 offen
    v_fmac_f32_dpp v72, v101, v11 row_newbcast:4 row_mask:0xf bank_mask:0xf
    v_fmac_f32_dpp v73, v101, v11 row_newbcast:5 row_mask:0xf bank_mask:0xf
    v_fmac_f32_dpp v74, v101, v11 row_newbcast:6 row_mask:0xf bank_mask:0xf
    v_fmac_f32_dpp v75, v101, v11 row_newbcast:7 row_mask:0xf bank_mask:0xf
    v_cvt_pk_bf16_f32 v108, v72, v73
    v_cvt_pk_bf16_f32 v109, v74, v75
    v_cvt_pk_bf16_f32 v110, v76, v77
    v_cvt_pk_bf16_f32 v111, v78, v79
    v_mul_f32_dpp v80, v100, v80 row_newbcast:8 row_mask:0xf bank_mask:0xf
    buffer_load_short_d16_hi v238, v238, s[44:47], 0 offen
    s_waitcnt lgkmcnt(0)
    v_mfma_f32_16x16x32_bf16 v[16:19], v[104:107], v[146:149], 0
    ds_read_b128 v[158:161], v14 offset:0
    ds_read_b64 v[162:163], v13 offset:1024
    v_mfma_f32_16x16x32_bf16 v[20:23], v[104:107], v[144:147], 0
    ds_read_b128 v[164:167], v14 offset:1536
    ds_read_b64 v[168:169], v13 offset:2560
    v_mfma_f32_16x16x32_bf16 v[24:27], v[108:111], v[146:149], 0
    ds_read_b128 v[170:173], v14 offset:3072
    ds_read_b64 v[174:175], v13 offset:4096
    v_mfma_f32_16x16x32_bf16 v[28:31], v[108:111], v[144:147], 0
    ds_read_b128 v[176:179], v14 offset:4608
    ds_read_b64 v[180:181], v13 offset:5632
    v_mul_f32_dpp v84, v100, v84 row_newbcast:8 row_mask:0xf bank_mask:0xf
    v_mul_f32_dpp v81, v100, v81 row_newbcast:9 row_mask:0xf bank_mask:0xf
    v_mul_f32_dpp v85, v100, v85 row_newbcast:9 row_mask:0xf bank_mask:0xf
    v_mul_f32_dpp v82, v100, v82 row_newbcast:10 row_mask:0xf bank_mask:0xf
    v_mul_f32_dpp v86, v100, v86 row_newbcast:10 row_mask:0xf bank_mask:0xf
    v_mul_f32_dpp v83, v100, v83 row_newbcast:11 row_mask:0xf bank_mask:0xf
    v_mul_f32_dpp v87, v100, v87 row_newbcast:11 row_mask:0xf bank_mask:0xf
    v_fmac_f32_dpp v80, v101, v11 row_newbcast:8 row_mask:0xf bank_mask:0xf
    v_fmac_f32_dpp v81, v101, v11 row_newbcast:9 row_mask:0xf bank_mask:0xf
    v_fmac_f32_dpp v82, v101, v11 row_newbcast:10 row_mask:0xf bank_mask:0xf
    v_fmac_f32_dpp v83, v101, v11 row_newbcast:11 row_mask:0xf bank_mask:0xf
    v_cvt_pk_bf16_f32 v112, v80, v81
    v_cvt_pk_bf16_f32 v113, v82, v83
    v_cvt_pk_bf16_f32 v114, v84, v85
    v_cvt_pk_bf16_f32 v115, v86, v87
    v_mul_f32_dpp v88, v100, v88 row_newbcast:12 row_mask:0xf bank_mask:0xf
    v_mul_f32_dpp v92, v100, v92 row_newbcast:12 row_mask:0xf bank_mask:0xf
    v_mfma_f32_16x16x32_bf16 v[32:35], v[112:115], v[146:149], 0
    v_mul_f32_dpp v89, v100, v89 row_newbcast:13 row_mask:0xf bank_mask:0xf
    v_mul_f32_dpp v93, v100, v93 row_newbcast:13 row_mask:0xf bank_mask:0xf
    v_mfma_f32_16x16x32_bf16 v[36:39], v[112:115], v[144:147], 0
    v_mul_f32_dpp v90, v100, v90 row_newbcast:14 row_mask:0xf bank_mask:0xf
    v_mul_f32_dpp v94, v100, v94 row_newbcast:14 row_mask:0xf bank_mask:0xf
    v_mul_f32_dpp v91, v100, v91 row_newbcast:15 row_mask:0xf bank_mask:0xf
    v_mul_f32_dpp v95, v100, v95 row_newbcast:15 row_mask:0xf bank_mask:0xf
    v_fmac_f32_dpp v88, v101, v11 row_newbcast:12 row_mask:0xf bank_mask:0xf
    v_fmac_f32_dpp v89, v101, v11 row_newbcast:13 row_mask:0xf bank_mask:0xf
    v_fmac_f32_dpp v90, v101, v11 row_newbcast:14 row_mask:0xf bank_mask:0xf
    v_fmac_f32_dpp v91, v101, v11 row_newbcast:15 row_mask:0xf bank_mask:0xf
    v_cvt_pk_bf16_f32 v116, v88, v89
    v_cvt_pk_bf16_f32 v117, v90, v91
    v_cvt_pk_bf16_f32 v118, v92, v93
    v_cvt_pk_bf16_f32 v119, v94, v95
    ds_read_b128 v[190:193], v14 offset:9728
    ds_read_b128 v[194:197], v14 offset:10752
    v_mfma_f32_16x16x32_bf16 v[40:43], v[116:119], v[146:149], 0
    ds_read_b128 v[198:201], v14 offset:11776
    ds_read_b128 v[202:205], v14 offset:12800
    v_mfma_f32_16x16x32_bf16 v[44:47], v[116:119], v[144:147], 0
    ds_read_b128 v[150:153], v14 offset:7680
    ds_read_b128 v[154:157], v14 offset:8704
    v_lshl_add_u32 v4, v2, 12, v7
    v_lshl_add_u32 v5, v3, 11, v15
    v_lshrrev_b32 v8, 2, v3
    v_lshlrev_b32 v8, 13, v8
    v_and_b32 v9, 3, v3
    v_lshl_add_u32 v8, v9, 2, v8
    v_lshl_add_u32 v8, v2, 11, v8
    v_lshrrev_b32 v9, 2, v1
    v_lshl_add_u32 v8, v9, 8, v8
    v_and_b32 v9, 1, v9
    v_lshl_add_u32 v8, v9, 4, v8
    v_and_b32 v9, 3, v1
    v_lshl_add_u32 v8, v9, 5, v8
    v_add_u32 v8, 16384, v8
    v_and_b32 v9, 1, v2
    v_lshlrev_b32 v9, 13, v9
    v_lshl_add_u32 v9, v3, 10, v9
    v_lshl_add_u32 v9, v1, 4, v9
    v_add_u32 v9, 16384, v9
    v_mul_u32_u24 v10, 528384, v2
    v_add_u32 v10, v10, v7
    v_xor_b32 v56, 16, v8
    v_xor_b32 v57, 16, v9
    v_add_u32 v58, 50688, v5
    v_lshrrev_b32 v60, 3, v15
    v_lshl_add_u32 v59, v3, 11, v60
    v_add_u32 v59, 50688, v59
    v_lshlrev_b32 v60, 1, v60
    v_sub_u32 v60, v59, v60
    v_mul_f32 v64, v20, v183
    v_mul_f32 v68, v20, v182
    v_fmac_f32 v64, v16, v182
    v_fma_f32 v68, -v16, v183, v68
    v_mul_f32 v65, v21, v183
    v_mul_f32 v69, v21, v182
    v_fmac_f32 v65, v17, v182
    v_fma_f32 v69, -v17, v183, v69
    v_mul_f32 v72, v28, v185
    v_mul_f32 v76, v28, v184
    v_fmac_f32 v72, v24, v184
    v_fma_f32 v76, -v24, v185, v76
    v_mul_f32 v73, v29, v185
    v_mul_f32 v77, v29, v184
    v_fmac_f32 v73, v25, v184
    v_fma_f32 v77, -v25, v185, v77
    v_mul_f32 v80, v36, v187
    v_mul_f32 v84, v36, v186
    v_fmac_f32 v80, v32, v186
    v_fma_f32 v84, -v32, v187, v84
    v_mul_f32 v81, v37, v187
    v_mul_f32 v85, v37, v186
    v_fmac_f32 v81, v33, v186
    v_fma_f32 v85, -v33, v187, v85
    v_mul_f32 v88, v44, v189
    v_mul_f32 v92, v44, v188
    v_fmac_f32 v88, v40, v188
    v_fma_f32 v92, -v40, v189, v92
    v_mul_f32 v89, v45, v189
    v_mul_f32 v93, v45, v188
    v_fmac_f32 v89, v41, v188
    v_fma_f32 v93, -v41, v189, v93
    v_cvt_pk_bf16_f32 v206, v64, v72
    v_cvt_pk_bf16_f32 v207, v80, v88
    v_cvt_pk_bf16_f32 v208, v68, v76
    v_cvt_pk_bf16_f32 v209, v84, v92
    ds_write_b128 v4, v[206:209] offset:0
    v_cvt_pk_bf16_f32 v210, v65, v73
    v_cvt_pk_bf16_f32 v211, v81, v89
    v_cvt_pk_bf16_f32 v212, v69, v77
    v_cvt_pk_bf16_f32 v213, v85, v93
    s_waitcnt lgkmcnt(14)
    ds_write_b128 v4, v[210:213] offset:2048
    s_waitcnt vmcnt(0)
    s_waitcnt lgkmcnt(14)
    ds_write_b128 v58, v[48:51]
    s_waitcnt lgkmcnt(14)
    ds_write_b128 v58, v[52:55] offset:1024
    s_waitcnt lgkmcnt(0)
    s_barrier
    ds_read_b128 v[214:217], v5 offset:0
    ds_read_b128 v[218:221], v5 offset:1024
    ds_read_u16_d16_hi v108, v59 offset:128
    ds_read_u16_d16_hi v116, v59 offset:1152
    ds_read_u16_d16_hi v109, v59 offset:384
    ds_read_u16_d16_hi v117, v59 offset:1408
    ds_read_u16_d16_hi v110, v60 offset:894
    ds_read_u16_d16_hi v118, v60 offset:1918
    ds_read_u16_d16_hi v111, v60 offset:638
    ds_read_u16_d16_hi v119, v60 offset:1662
    s_waitcnt lgkmcnt(9)
    v_mfma_f32_16x16x32_bf16 v[24:27], v[172:175], v[214:217], 0
    s_waitcnt lgkmcnt(8)
    ds_read_u16_d16_hi v104, v59 offset:0
    ds_read_u16_d16_hi v112, v59 offset:1024
    v_mfma_f32_16x16x32_bf16 v[28:31], v[170:173], v[214:217], 0
    ds_read_u16_d16_hi v105, v59 offset:256
    ds_read_u16_d16_hi v113, v59 offset:1280
    v_mfma_f32_16x16x32_bf16 v[16:19], v[160:163], v[214:217], 0
    ds_read_u16_d16_hi v106, v60 offset:1022
    ds_read_u16_d16_hi v114, v60 offset:2046
    v_mfma_f32_16x16x32_bf16 v[20:23], v[158:161], v[214:217], 0
    ds_read_u16_d16_hi v107, v60 offset:766
    s_waitcnt lgkmcnt(14)
    ds_read_u16_d16_hi v115, v60 offset:1790
    v_mfma_f32_16x16x32_bf16 v[24:27], v[178:181], v[218:221], v[24:27]
    v_cmp_eq_u32 vcc, 0, v15
    s_waitcnt lgkmcnt(8)
    s_waitcnt lgkmcnt(0)
    v_add_f32_dpp v120, v239, v104 quad_perm:[0,0,0,0] row_mask:0xf bank_mask:0xf
    v_mfma_f32_16x16x32_bf16 v[28:31], v[176:179], v[218:221], v[28:31]
    v_mul_f32 v120, 0.5, v120
    v_cndmask_b32 v104, v104, v120, vcc
    v_mfma_f32_16x16x32_bf16 v[16:19], v[166:169], v[218:221], v[16:19]
    v_mul_f32 v72, v24, v108
    v_mul_f32 v73, v25, v109
    v_mfma_f32_16x16x32_bf16 v[20:23], v[164:167], v[218:221], v[20:23]
    s_nop 1
    v_mul_f32 v76, v28, v108
    v_fma_f32 v72, -v28, v116, v72
    v_fma_f32 v76, -v24, v116, -v76
    v_mul_f32 v77, v29, v109
    v_fma_f32 v73, -v29, v117, v73
    v_fma_f32 v77, -v25, v117, -v77
    v_mul_f32 v74, v26, v110
    v_mul_f32 v78, v30, v110
    v_fma_f32 v74, v30, v118, v74
    v_fma_f32 v78, v26, v118, -v78
    v_mul_f32 v75, v27, v111
    v_mul_f32 v79, v31, v111
    v_fma_f32 v75, v31, v119, v75
    v_fma_f32 v79, v27, v119, -v79
    v_cvt_pk_bf16_f32 v226, v72, v73
    v_cvt_pk_bf16_f32 v227, v74, v75
    v_cvt_pk_bf16_f32 v228, v76, v77
    v_cvt_pk_bf16_f32 v229, v78, v79
    v_subrev_f32_dpp v121, v238, v112 quad_perm:[0,0,0,0] row_mask:0xf bank_mask:0xf
    v_mul_f32 v121, 0.5, v121
    v_mfma_f32_16x16x32_bf16 v[32:35], v[226:229], v[166:169], 0
    v_cndmask_b32 v112, v112, v121, vcc
    v_add_f32_dpp v122, v239, v106 quad_perm:[1,1,1,1] row_mask:0xf bank_mask:0xf
    v_mfma_f32_16x16x32_bf16 v[36:39], v[226:229], v[164:167], 0
    v_mul_f32 v122, 0.5, v122
    v_cndmask_b32 v106, v106, v122, vcc
    v_mfma_f32_16x16x32_bf16 v[40:43], v[226:229], v[178:181], 0
    v_subrev_f32_dpp v123, v238, v114 quad_perm:[1,1,1,1] row_mask:0xf bank_mask:0xf
    v_mul_f32 v123, 0.5, v123
    v_mfma_f32_16x16x32_bf16 v[44:47], v[226:229], v[176:179], 0
    v_cndmask_b32 v114, v114, v123, vcc
    v_mul_f32 v64, v16, v104
    v_mul_f32 v68, v20, v104
    v_fma_f32 v64, -v20, v112, v64
    v_fma_f32 v68, -v16, v112, -v68
    v_mul_f32 v65, v17, v105
    v_mul_f32 v69, v21, v105
    v_fma_f32 v65, -v21, v113, v65
    v_fma_f32 v69, -v17, v113, -v69
    v_mul_f32 v66, v18, v106
    v_mul_f32 v70, v22, v106
    v_fma_f32 v66, v22, v114, v66
    v_fma_f32 v70, v18, v114, -v70
    v_mul_f32 v67, v19, v107
    v_mul_f32 v71, v23, v107
    v_fma_f32 v67, v23, v115, v67
    v_fma_f32 v71, v19, v115, -v71
    v_cvt_pk_bf16_f32 v222, v64, v65
    v_cvt_pk_bf16_f32 v223, v66, v67
    v_cvt_pk_bf16_f32 v224, v68, v69
    v_cvt_pk_bf16_f32 v225, v70, v71
    v_mul_f32 v96, 0x36000000, v96
    v_mul_f32 v97, 0x36000000, v97
    v_mfma_f32_16x16x32_bf16 v[32:35], v[222:225], v[160:163], v[32:35]
    v_mul_f32 v98, 0x36000000, v98
    v_mul_f32 v99, 0x36000000, v99
    v_mfma_f32_16x16x32_bf16 v[36:39], v[222:225], v[158:161], v[36:39]
    v_mfma_f32_16x16x32_bf16 v[40:43], v[222:225], v[172:175], v[40:43]
    v_mfma_f32_16x16x32_bf16 v[44:47], v[222:225], v[170:173], v[44:47]
    s_nop 5
    v_mul_f32 v80, v36, v194
    v_mul_f32 v84, v36, v190
    v_fmac_f32 v80, v32, v190
    v_fma_f32 v84, -v32, v194, v84
    v_mul_f32 v81, v37, v195
    v_mul_f32 v85, v37, v191
    v_fmac_f32 v81, v33, v191
    v_fma_f32 v85, -v33, v195, v85
    v_mul_f32 v82, v38, v196
    v_mul_f32 v86, v38, v192
    v_fmac_f32 v82, v34, v192
    v_fma_f32 v86, -v34, v196, v86
    v_mul_f32 v83, v39, v197
    v_mul_f32 v87, v39, v193
    v_fmac_f32 v83, v35, v193
    v_fma_f32 v87, -v35, v197, v87
    v_cvt_pk_bf16_f32 v230, v80, v81
    v_cvt_pk_bf16_f32 v231, v82, v83
    v_cvt_pk_bf16_f32 v232, v84, v85
    v_cvt_pk_bf16_f32 v233, v86, v87
    v_mul_f32 v88, v44, v202
    v_mul_f32 v92, v44, v198
    v_mfma_f32_16x16x32_bf16 v[16:19], v[146:149], v[230:233], 0
    v_fmac_f32 v88, v40, v198
    v_fma_f32 v92, -v40, v202, v92
    v_mfma_f32_16x16x32_bf16 v[20:23], v[144:147], v[230:233], 0
    v_mul_f32 v89, v45, v203
    v_mul_f32 v93, v45, v199
    v_fmac_f32 v89, v41, v199
    v_fma_f32 v93, -v41, v203, v93
    v_mul_f32 v90, v46, v204
    v_mul_f32 v94, v46, v200
    v_fmac_f32 v90, v42, v200
    v_fma_f32 v94, -v42, v204, v94
    v_mul_f32 v91, v47, v205
    v_mul_f32 v95, v47, v201
    v_fmac_f32 v91, v43, v201
    v_fma_f32 v95, -v43, v205, v95
    v_cvt_pk_bf16_f32 v234, v88, v89
    v_cvt_pk_bf16_f32 v235, v90, v91
    v_cvt_pk_bf16_f32 v236, v92, v93
    v_cvt_pk_bf16_f32 v237, v94, v95
    v_cvt_pk_bf16_f32 v206, v16, v20
    ds_write_b32 v8, v206 offset:0
    v_mfma_f32_16x16x32_bf16 v[24:27], v[146:149], v[234:237], 0
    v_cvt_pk_bf16_f32 v207, v17, v21
    ds_write_b32 v8, v207 offset:128
    v_mfma_f32_16x16x32_bf16 v[28:31], v[144:147], v[234:237], 0
    v_cvt_pk_bf16_f32 v208, v18, v22
    ds_write_b32 v8, v208 offset:1024
    v_cvt_pk_bf16_f32 v209, v19, v23
    ds_write_b32 v8, v209 offset:1152
    s_nop 3
    v_cvt_pk_bf16_f32 v210, v24, v28
    ds_write_b32 v56, v210 offset:0
    v_cvt_pk_bf16_f32 v211, v25, v29
    ds_write_b32 v56, v211 offset:128
    v_cvt_pk_bf16_f32 v212, v26, v30
    ds_write_b32 v56, v212 offset:1024
    v_cvt_pk_bf16_f32 v213, v27, v31
    ds_write_b32 v56, v213 offset:1152
    s_waitcnt lgkmcnt(0)
    s_barrier
    ds_read_b128 v[104:107], v9 offset:0
    ds_read_b128 v[108:111], v57 offset:256
    ds_read_b128 v[112:115], v9 offset:512
    ds_read_b128 v[116:119], v57 offset:768
    s_lshl_b32 s28, s3, 11
    s_add_u32 s29, s28, 264192
    s_waitcnt lgkmcnt(3)
    v_mfma_f32_16x16x32_bf16 v[16:19], v[150:153], v[104:107], 0
    s_waitcnt lgkmcnt(2)
    s_waitcnt lgkmcnt(1)
    s_waitcnt lgkmcnt(0)
    v_mfma_f32_16x16x32_bf16 v[20:23], v[154:157], v[104:107], 0
    v_mfma_f32_16x16x32_bf16 v[24:27], v[150:153], v[108:111], 0
    s_nop 2
    v_mul_f32 v16, v16, v96
    v_mul_f32 v17, v17, v96
    v_mfma_f32_16x16x32_bf16 v[28:31], v[154:157], v[108:111], 0
    s_nop 0
    v_mul_f32 v20, v20, v96
    v_cvt_pk_bf16_f32 v64, v16, v20
    v_mfma_f32_16x16x32_bf16 v[32:35], v[150:153], v[112:115], 0
    v_mul_f32 v21, v21, v96
    v_cvt_pk_bf16_f32 v68, v17, v21
    v_mfma_f32_16x16x32_bf16 v[36:39], v[154:157], v[112:115], 0
    v_mul_f32 v24, v24, v97
    v_mul_f32 v28, v28, v97
    v_mfma_f32_16x16x32_bf16 v[40:43], v[150:153], v[116:119], 0
    v_cvt_pk_bf16_f32 v65, v24, v28
    v_mul_f32 v25, v25, v97
    v_mfma_f32_16x16x32_bf16 v[44:47], v[154:157], v[116:119], 0
    v_mul_f32 v29, v29, v97
    v_cvt_pk_bf16_f32 v69, v25, v29
    v_mul_f32 v32, v32, v98
    v_mul_f32 v36, v36, v98
    v_cvt_pk_bf16_f32 v66, v32, v36
    v_mul_f32 v33, v33, v98
    v_mul_f32 v37, v37, v98
    v_cvt_pk_bf16_f32 v70, v33, v37
    v_mul_f32 v40, v40, v99
    v_mul_f32 v44, v44, v99
    v_cvt_pk_bf16_f32 v67, v40, v44
    v_mul_f32 v41, v41, v99
    v_mul_f32 v45, v45, v99
    v_cvt_pk_bf16_f32 v71, v41, v45
    buffer_store_dwordx4 v[64:67], v10, s[8:11], s28 offen sc1
    buffer_store_dwordx4 v[68:71], v10, s[8:11], s29 offen sc1
    s_endpgm
L_k2_side:
    s_cmp_lt_u32 s2, 136
    s_cbranch_scc1 L_k2_zf
    s_cmp_ge_u32 s2, 224
    s_cbranch_scc1 L_k2_end
    s_load_dwordx4 s[8:11], s[0:1], 32
    s_load_dwordx2 s[4:5], s[0:1], 48
    s_load_dwordx2 s[6:7], s[0:1], 88
    s_sub_u32 s21, s2, 136
    v_lshrrev_b32 v1, 6, v0
    v_and_b32 v2, 63, v0
    v_readfirstlane_b32 s22, v1
    s_nop 2
    s_cmp_ge_u32 s22, 4
    s_cbranch_scc1 L_k2_pk2
    s_bfe_u32 s23, s21, 0x10003
    s_and_b32 s24, s21, 7
    s_lshr_b32 s25, s21, 4
    s_lshl_b32 s25, s25, 3
    s_add_u32 s24, s24, s25
    s_cmp_ge_u32 s21, 80
    s_cbranch_scc0 L_k2_map
    s_and_b32 s23, s21, 1
    s_sub_u32 s24, s21, 80
    s_lshr_b32 s24, s24, 1
    s_add_u32 s24, s24, 40
L_k2_map:
    s_and_b32 s26, s24, 1
    s_lshl_b32 s26, s26, 1
    s_add_u32 s23, s23, s26
    s_bfe_u32 s33, s24, 0x10001
    s_lshr_b32 s25, s24, 2
    s_mov_b32 s24, s33
    v_and_b32 v2, 3, v0
    v_lshrrev_b32 v3, 2, v0
    v_mul_u32_u24 v4, 22016, v3
    v_lshl_add_u32 v4, v2, 4, v4
    s_lshl_b32 s26, s25, 8
    s_lshl_b32 s27, s23, 6
    s_add_u32 s26, s26, s27
    s_cmp_ge_u32 s26, 2752
    s_cselect_b32 s32, 0, 1409024
    v_lshlrev_b32 v5, 5, v3
    s_waitcnt lgkmcnt(0)
    s_cmp_eq_u32 s24, 0
    s_cselect_b32 s8, s8, s10
    s_cselect_b32 s9, s9, s11
    s_mov_b32 s10, s32
    s_mov_b32 s11, 0x00020000
    buffer_load_dwordx4 v[16:19], v4, s[8:11], s26 offen
    s_add_u32 s26, s26, 2752
    buffer_load_dwordx4 v[20:23], v4, s[8:11], s26 offen
    s_add_u32 s26, s26, 2752
    buffer_load_dwordx4 v[24:27], v4, s[8:11], s26 offen
    s_add_u32 s26, s26, 2752
    buffer_load_dwordx4 v[28:31], v4, s[8:11], s26 offen
    s_add_u32 s26, s26, 2752
    buffer_load_dwordx4 v[32:35], v4, s[8:11], s26 offen
    s_add_u32 s26, s26, 2752
    buffer_load_dwordx4 v[36:39], v4, s[8:11], s26 offen
    s_add_u32 s26, s26, 2752
    buffer_load_dwordx4 v[40:43], v4, s[8:11], s26 offen
    s_add_u32 s26, s26, 2752
    buffer_load_dwordx4 v[44:47], v4, s[8:11], s26 offen
    s_mov_b32 s12, s6
    s_mov_b32 s13, s7
    s_mov_b32 s14, 12288
    s_mov_b32 s15, 0x00020000
    s_movk_i32 s27, 0x1800
    s_movk_i32 s28, 0x2000
    buffer_load_dwordx4 v[48:51], v5, s[12:15], s28 offen offset:0
    buffer_load_dwordx4 v[56:59], v5, s[12:15], s27 offen offset:0
    buffer_load_dwordx4 v[52:55], v5, s[12:15], s28 offen offset:16
    buffer_load_dwordx4 v[60:63], v5, s[12:15], s27 offen offset:16
    s_add_u32 s8, s6, 6684672
    s_addc_u32 s9, s7, 0
    s_mov_b32 s10, 2883584
    s_mov_b32 s11, 0x00020000
    s_add_u32 s12, s6, 16384
    s_addc_u32 s13, s7, 0
    s_mov_b32 s14, 22528
    s_mov_b32 s15, 0x00020000
    s_mov_b32 s30, 0xffff0000
    s_mov_b32 s31, 0x3f803f80
    v_lshlrev_b32 v6, 8, v3
    v_lshl_add_u32 v6, v2, 4, v6
    s_lshl_b32 s26, s25, 18
    s_lshl_b32 s27, s24, 14
    s_add_u32 s26, s26, s27
    s_lshl_b32 s27, s23, 6
    s_add_u32 s26, s26, s27
    v_mov_b64 v[96:97], 0
    v_mov_b64 v[98:99], 0
    v_mov_b64 v[100:101], 0
    v_mov_b64 v[102:103], 0
    s_waitcnt vmcnt(0)
    v_lshlrev_b32 v112, 16, v16
    v_lshlrev_b32 v113, 16, v20
    v_lshlrev_b32 v114, 16, v24
    v_lshlrev_b32 v115, 16, v28
    v_lshlrev_b32 v116, 16, v32
    v_lshlrev_b32 v117, 16, v36
    v_lshlrev_b32 v118, 16, v40
    v_lshlrev_b32 v119, 16, v44
    v_pk_mul_f32 v[176:177], v[112:113], v[48:49]
    v_pk_mul_f32 v[178:179], v[114:115], v[50:51]
    v_pk_mul_f32 v[180:181], v[116:117], v[52:53]
    v_pk_mul_f32 v[182:183], v[118:119], v[54:55]
    v_cvt_pk_bf16_f32 v64, v176, v177
    v_cvt_pk_bf16_f32 v65, v178, v179
    v_cvt_pk_bf16_f32 v66, v180, v181
    v_cvt_pk_bf16_f32 v67, v182, v183
    s_lshl_b32 s36, s25, 3
    s_add_u32 s36, s36, 0
    s_mul_i32 s36, s36, 373
    s_lshr_b32 s36, s36, 12
    s_lshl_b32 s36, s36, 11
    v_subrev_u32 v184, s36, v6
    v_and_b32 v184, 0x3fff, v184
    buffer_store_dwordx4 v[64:67], v184, s[8:11], s26 offen sc1
    s_add_u32 s26, s26, 0x8000
    v_and_b32 v120, s30, v16
    v_and_b32 v121, s30, v20
    v_and_b32 v122, s30, v24
    v_and_b32 v123, s30, v28
    v_and_b32 v124, s30, v32
    v_and_b32 v125, s30, v36
    v_and_b32 v126, s30, v40
    v_and_b32 v127, s30, v44
    v_pk_mul_f32 v[176:177], v[120:121], v[48:49]
    v_pk_mul_f32 v[178:179], v[122:123], v[50:51]
    v_pk_mul_f32 v[180:181], v[124:125], v[52:53]
    v_pk_mul_f32 v[182:183], v[126:127], v[54:55]
    v_cvt_pk_bf16_f32 v68, v176, v177
    v_cvt_pk_bf16_f32 v69, v178, v179
    v_cvt_pk_bf16_f32 v70, v180, v181
    v_cvt_pk_bf16_f32 v71, v182, v183
    s_lshl_b32 s36, s25, 3
    s_add_u32 s36, s36, 1
    s_mul_i32 s36, s36, 373
    s_lshr_b32 s36, s36, 12
    s_lshl_b32 s36, s36, 11
    v_subrev_u32 v185, s36, v6
    v_and_b32 v185, 0x3fff, v185
    buffer_store_dwordx4 v[68:71], v185, s[8:11], s26 offen sc1
    s_add_u32 s26, s26, 0x8000
    v_lshlrev_b32 v128, 16, v17
    v_lshlrev_b32 v129, 16, v21
    v_lshlrev_b32 v130, 16, v25
    v_lshlrev_b32 v131, 16, v29
    v_lshlrev_b32 v132, 16, v33
    v_lshlrev_b32 v133, 16, v37
    v_lshlrev_b32 v134, 16, v41
    v_lshlrev_b32 v135, 16, v45
    v_pk_mul_f32 v[176:177], v[128:129], v[48:49]
    v_pk_mul_f32 v[178:179], v[130:131], v[50:51]
    v_pk_mul_f32 v[180:181], v[132:133], v[52:53]
    v_pk_mul_f32 v[182:183], v[134:135], v[54:55]
    v_cvt_pk_bf16_f32 v72, v176, v177
    v_cvt_pk_bf16_f32 v73, v178, v179
    v_cvt_pk_bf16_f32 v74, v180, v181
    v_cvt_pk_bf16_f32 v75, v182, v183
    s_lshl_b32 s36, s25, 3
    s_add_u32 s36, s36, 2
    s_mul_i32 s36, s36, 373
    s_lshr_b32 s36, s36, 12
    s_lshl_b32 s36, s36, 11
    v_subrev_u32 v184, s36, v6
    v_and_b32 v184, 0x3fff, v184
    buffer_store_dwordx4 v[72:75], v184, s[8:11], s26 offen sc1
    s_add_u32 s26, s26, 0x8000
    v_and_b32 v136, s30, v17
    v_and_b32 v137, s30, v21
    v_and_b32 v138, s30, v25
    v_and_b32 v139, s30, v29
    v_and_b32 v140, s30, v33
    v_and_b32 v141, s30, v37
    v_and_b32 v142, s30, v41
    v_and_b32 v143, s30, v45
    v_pk_mul_f32 v[176:177], v[136:137], v[48:49]
    v_pk_mul_f32 v[178:179], v[138:139], v[50:51]
    v_pk_mul_f32 v[180:181], v[140:141], v[52:53]
    v_pk_mul_f32 v[182:183], v[142:143], v[54:55]
    v_cvt_pk_bf16_f32 v76, v176, v177
    v_cvt_pk_bf16_f32 v77, v178, v179
    v_cvt_pk_bf16_f32 v78, v180, v181
    v_cvt_pk_bf16_f32 v79, v182, v183
    s_lshl_b32 s36, s25, 3
    s_add_u32 s36, s36, 3
    s_mul_i32 s36, s36, 373
    s_lshr_b32 s36, s36, 12
    s_lshl_b32 s36, s36, 11
    v_subrev_u32 v185, s36, v6
    v_and_b32 v185, 0x3fff, v185
    buffer_store_dwordx4 v[76:79], v185, s[8:11], s26 offen sc1
    s_add_u32 s26, s26, 0x8000
    v_lshlrev_b32 v144, 16, v18
    v_lshlrev_b32 v145, 16, v22
    v_lshlrev_b32 v146, 16, v26
    v_lshlrev_b32 v147, 16, v30
    v_lshlrev_b32 v148, 16, v34
    v_lshlrev_b32 v149, 16, v38
    v_lshlrev_b32 v150, 16, v42
    v_lshlrev_b32 v151, 16, v46
    v_pk_mul_f32 v[176:177], v[144:145], v[48:49]
    v_pk_mul_f32 v[178:179], v[146:147], v[50:51]
    v_pk_mul_f32 v[180:181], v[148:149], v[52:53]
    v_pk_mul_f32 v[182:183], v[150:151], v[54:55]
    v_cvt_pk_bf16_f32 v80, v176, v177
    v_cvt_pk_bf16_f32 v81, v178, v179
    v_cvt_pk_bf16_f32 v82, v180, v181
    v_cvt_pk_bf16_f32 v83, v182, v183
    s_lshl_b32 s36, s25, 3
    s_add_u32 s36, s36, 4
    s_mul_i32 s36, s36, 373
    s_lshr_b32 s36, s36, 12
    s_lshl_b32 s36, s36, 11
    v_subrev_u32 v184, s36, v6
    v_and_b32 v184, 0x3fff, v184
    buffer_store_dwordx4 v[80:83], v184, s[8:11], s26 offen sc1
    s_add_u32 s26, s26, 0x8000
    v_and_b32 v152, s30, v18
    v_and_b32 v153, s30, v22
    v_and_b32 v154, s30, v26
    v_and_b32 v155, s30, v30
    v_and_b32 v156, s30, v34
    v_and_b32 v157, s30, v38
    v_and_b32 v158, s30, v42
    v_and_b32 v159, s30, v46
    v_pk_mul_f32 v[176:177], v[152:153], v[48:49]
    v_pk_mul_f32 v[178:179], v[154:155], v[50:51]
    v_pk_mul_f32 v[180:181], v[156:157], v[52:53]
    v_pk_mul_f32 v[182:183], v[158:159], v[54:55]
    v_cvt_pk_bf16_f32 v84, v176, v177
    v_cvt_pk_bf16_f32 v85, v178, v179
    v_cvt_pk_bf16_f32 v86, v180, v181
    v_cvt_pk_bf16_f32 v87, v182, v183
    s_lshl_b32 s36, s25, 3
    s_add_u32 s36, s36, 5
    s_mul_i32 s36, s36, 373
    s_lshr_b32 s36, s36, 12
    s_lshl_b32 s36, s36, 11
    v_subrev_u32 v185, s36, v6
    v_and_b32 v185, 0x3fff, v185
    buffer_store_dwordx4 v[84:87], v185, s[8:11], s26 offen sc1
    s_add_u32 s26, s26, 0x8000
    v_lshlrev_b32 v160, 16, v19
    v_lshlrev_b32 v161, 16, v23
    v_lshlrev_b32 v162, 16, v27
    v_lshlrev_b32 v163, 16, v31
    v_lshlrev_b32 v164, 16, v35
    v_lshlrev_b32 v165, 16, v39
    v_lshlrev_b32 v166, 16, v43
    v_lshlrev_b32 v167, 16, v47
    v_pk_mul_f32 v[176:177], v[160:161], v[48:49]
    v_pk_mul_f32 v[178:179], v[162:163], v[50:51]
    v_pk_mul_f32 v[180:181], v[164:165], v[52:53]
    v_pk_mul_f32 v[182:183], v[166:167], v[54:55]
    v_cvt_pk_bf16_f32 v88, v176, v177
    v_cvt_pk_bf16_f32 v89, v178, v179
    v_cvt_pk_bf16_f32 v90, v180, v181
    v_cvt_pk_bf16_f32 v91, v182, v183
    s_lshl_b32 s36, s25, 3
    s_add_u32 s36, s36, 6
    s_mul_i32 s36, s36, 373
    s_lshr_b32 s36, s36, 12
    s_lshl_b32 s36, s36, 11
    v_subrev_u32 v184, s36, v6
    v_and_b32 v184, 0x3fff, v184
    buffer_store_dwordx4 v[88:91], v184, s[8:11], s26 offen sc1
    s_add_u32 s26, s26, 0x8000
    v_and_b32 v168, s30, v19
    v_and_b32 v169, s30, v23
    v_and_b32 v170, s30, v27
    v_and_b32 v171, s30, v31
    v_and_b32 v172, s30, v35
    v_and_b32 v173, s30, v39
    v_and_b32 v174, s30, v43
    v_and_b32 v175, s30, v47
    v_pk_mul_f32 v[176:177], v[168:169], v[48:49]
    v_pk_mul_f32 v[178:179], v[170:171], v[50:51]
    v_pk_mul_f32 v[180:181], v[172:173], v[52:53]
    v_pk_mul_f32 v[182:183], v[174:175], v[54:55]
    v_cvt_pk_bf16_f32 v92, v176, v177
    v_cvt_pk_bf16_f32 v93, v178, v179
    v_cvt_pk_bf16_f32 v94, v180, v181
    v_cvt_pk_bf16_f32 v95, v182, v183
    s_lshl_b32 s36, s25, 3
    s_add_u32 s36, s36, 7
    s_mul_i32 s36, s36, 373
    s_lshr_b32 s36, s36, 12
    s_lshl_b32 s36, s36, 11
    v_subrev_u32 v185, s36, v6
    v_and_b32 v185, 0x3fff, v185
    buffer_store_dwordx4 v[92:95], v185, s[8:11], s26 offen sc1
    v_pk_mul_f32 v[112:113], v[112:113], v[56:57]
    v_pk_fma_f32 v[112:113], v[114:115], v[58:59], v[112:113]
    v_pk_fma_f32 v[112:113], v[116:117], v[60:61], v[112:113]
    v_pk_fma_f32 v[112:113], v[118:119], v[62:63], v[112:113]
    v_add_f32 v104, v112, v113
    v_dot2c_f32_bf16 v96, s31, v64
    v_dot2c_f32_bf16 v96, s31, v65
    v_dot2c_f32_bf16 v96, s31, v66
    v_dot2c_f32_bf16 v96, s31, v67
    v_pk_mul_f32 v[120:121], v[120:121], v[56:57]
    v_pk_fma_f32 v[120:121], v[122:123], v[58:59], v[120:121]
    v_pk_fma_f32 v[120:121], v[124:125], v[60:61], v[120:121]
    v_pk_fma_f32 v[120:121], v[126:127], v[62:63], v[120:121]
    v_add_f32 v105, v120, v121
    v_dot2c_f32_bf16 v97, s31, v68
    v_dot2c_f32_bf16 v97, s31, v69
    v_dot2c_f32_bf16 v97, s31, v70
    v_dot2c_f32_bf16 v97, s31, v71
    v_pk_mul_f32 v[128:129], v[128:129], v[56:57]
    v_pk_fma_f32 v[128:129], v[130:131], v[58:59], v[128:129]
    v_pk_fma_f32 v[128:129], v[132:133], v[60:61], v[128:129]
    v_pk_fma_f32 v[128:129], v[134:135], v[62:63], v[128:129]
    v_add_f32 v106, v128, v129
    v_dot2c_f32_bf16 v98, s31, v72
    v_dot2c_f32_bf16 v98, s31, v73
    v_dot2c_f32_bf16 v98, s31, v74
    v_dot2c_f32_bf16 v98, s31, v75
    v_pk_mul_f32 v[136:137], v[136:137], v[56:57]
    v_pk_fma_f32 v[136:137], v[138:139], v[58:59], v[136:137]
    v_pk_fma_f32 v[136:137], v[140:141], v[60:61], v[136:137]
    v_pk_fma_f32 v[136:137], v[142:143], v[62:63], v[136:137]
    v_add_f32 v107, v136, v137
    v_dot2c_f32_bf16 v99, s31, v76
    v_dot2c_f32_bf16 v99, s31, v77
    v_dot2c_f32_bf16 v99, s31, v78
    v_dot2c_f32_bf16 v99, s31, v79
    v_pk_mul_f32 v[144:145], v[144:145], v[56:57]
    v_pk_fma_f32 v[144:145], v[146:147], v[58:59], v[144:145]
    v_pk_fma_f32 v[144:145], v[148:149], v[60:61], v[144:145]
    v_pk_fma_f32 v[144:145], v[150:151], v[62:63], v[144:145]
    v_add_f32 v108, v144, v145
    v_dot2c_f32_bf16 v100, s31, v80
    v_dot2c_f32_bf16 v100, s31, v81
    v_dot2c_f32_bf16 v100, s31, v82
    v_dot2c_f32_bf16 v100, s31, v83
    v_pk_mul_f32 v[152:153], v[152:153], v[56:57]
    v_pk_fma_f32 v[152:153], v[154:155], v[58:59], v[152:153]
    v_pk_fma_f32 v[152:153], v[156:157], v[60:61], v[152:153]
    v_pk_fma_f32 v[152:153], v[158:159], v[62:63], v[152:153]
    v_add_f32 v109, v152, v153
    v_dot2c_f32_bf16 v101, s31, v84
    v_dot2c_f32_bf16 v101, s31, v85
    v_dot2c_f32_bf16 v101, s31, v86
    v_dot2c_f32_bf16 v101, s31, v87
    v_pk_mul_f32 v[160:161], v[160:161], v[56:57]
    v_pk_fma_f32 v[160:161], v[162:163], v[58:59], v[160:161]
    v_pk_fma_f32 v[160:161], v[164:165], v[60:61], v[160:161]
    v_pk_fma_f32 v[160:161], v[166:167], v[62:63], v[160:161]
    v_add_f32 v110, v160, v161
    v_dot2c_f32_bf16 v102, s31, v88
    v_dot2c_f32_bf16 v102, s31, v89
    v_dot2c_f32_bf16 v102, s31, v90
    v_dot2c_f32_bf16 v102, s31, v91
    v_pk_mul_f32 v[168:169], v[168:169], v[56:57]
    v_pk_fma_f32 v[168:169], v[170:171], v[58:59], v[168:169]
    v_pk_fma_f32 v[168:169], v[172:173], v[60:61], v[168:169]
    v_pk_fma_f32 v[168:169], v[174:175], v[62:63], v[168:169]
    v_add_f32 v111, v168, v169
    v_dot2c_f32_bf16 v103, s31, v92
    v_dot2c_f32_bf16 v103, s31, v93
    v_dot2c_f32_bf16 v103, s31, v94
    v_dot2c_f32_bf16 v103, s31, v95
    v_add_f32_dpp v96, v96, v96 row_ror:4 row_mask:0xf bank_mask:0xf
    v_add_f32_dpp v97, v97, v97 row_ror:4 row_mask:0xf bank_mask:0xf
    v_add_f32_dpp v98, v98, v98 row_ror:4 row_mask:0xf bank_mask:0xf
    v_add_f32_dpp v99, v99, v99 row_ror:4 row_mask:0xf bank_mask:0xf
    v_add_f32_dpp v100, v100, v100 row_ror:4 row_mask:0xf bank_mask:0xf
    v_add_f32_dpp v101, v101, v101 row_ror:4 row_mask:0xf bank_mask:0xf
    v_add_f32_dpp v102, v102, v102 row_ror:4 row_mask:0xf bank_mask:0xf
    v_add_f32_dpp v103, v103, v103 row_ror:4 row_mask:0xf bank_mask:0xf
    v_add_f32_dpp v104, v104, v104 row_ror:4 row_mask:0xf bank_mask:0xf
    v_add_f32_dpp v105, v105, v105 row_ror:4 row_mask:0xf bank_mask:0xf
    v_add_f32_dpp v106, v106, v106 row_ror:4 row_mask:0xf bank_mask:0xf
    v_add_f32_dpp v107, v107, v107 row_ror:4 row_mask:0xf bank_mask:0xf
    v_add_f32_dpp v108, v108, v108 row_ror:4 row_mask:0xf bank_mask:0xf
    v_add_f32_dpp v109, v109, v109 row_ror:4 row_mask:0xf bank_mask:0xf
    v_add_f32_dpp v110, v110, v110 row_ror:4 row_mask:0xf bank_mask:0xf
    v_add_f32_dpp v111, v111, v111 row_ror:4 row_mask:0xf bank_mask:0xf
    v_add_f32_dpp v96, v96, v96 row_ror:8 row_mask:0xf bank_mask:0xf
    v_add_f32_dpp v97, v97, v97 row_ror:8 row_mask:0xf bank_mask:0xf
    v_add_f32_dpp v98, v98, v98 row_ror:8 row_mask:0xf bank_mask:0xf
    v_add_f32_dpp v99, v99, v99 row_ror:8 row_mask:0xf bank_mask:0xf
    v_add_f32_dpp v100, v100, v100 row_ror:8 row_mask:0xf bank_mask:0xf
    v_add_f32_dpp v101, v101, v101 row_ror:8 row_mask:0xf bank_mask:0xf
    v_add_f32_dpp v102, v102, v102 row_ror:8 row_mask:0xf bank_mask:0xf
    v_add_f32_dpp v103, v103, v103 row_ror:8 row_mask:0xf bank_mask:0xf
    v_add_f32_dpp v104, v104, v104 row_ror:8 row_mask:0xf bank_mask:0xf
    v_add_f32_dpp v105, v105, v105 row_ror:8 row_mask:0xf bank_mask:0xf
    v_add_f32_dpp v106, v106, v106 row_ror:8 row_mask:0xf bank_mask:0xf
    v_add_f32_dpp v107, v107, v107 row_ror:8 row_mask:0xf bank_mask:0xf
    v_add_f32_dpp v108, v108, v108 row_ror:8 row_mask:0xf bank_mask:0xf
    v_add_f32_dpp v109, v109, v109 row_ror:8 row_mask:0xf bank_mask:0xf
    v_add_f32_dpp v110, v110, v110 row_ror:8 row_mask:0xf bank_mask:0xf
    v_add_f32_dpp v111, v111, v111 row_ror:8 row_mask:0xf bank_mask:0xf
    v_lshrrev_b32 v7, 4, v0
    v_lshlrev_b32 v7, 8, v7
    v_lshl_add_u32 v7, v2, 6, v7
    ds_write_b128 v7, v[96:99]
    ds_write_b128 v7, v[100:103] offset:16
    ds_write_b128 v7, v[104:107] offset:32
    ds_write_b128 v7, v[108:111] offset:48
    v_lshlrev_b32 v10, 2, v0
    v_and_b32 v11, 7, v0
    v_lshlrev_b32 v11, 8, v11
    v_bfe_u32 v13, v0, 3, 1
    v_lshl_add_u32 v11, v13, 4, v11
    v_bfe_u32 v13, v0, 4, 2
    v_lshl_add_u32 v11, v13, 2, v11
    s_lshl_b32 s26, s25, 11
    s_lshl_b32 s27, s24, 5
    s_add_u32 s26, s26, s27
    s_lshl_b32 s27, s23, 6
    s_add_u32 s26, s26, s27
    s_waitcnt lgkmcnt(0)
    s_barrier
    s_cmp_lg_u32 s22, 0
    s_cbranch_scc1 L_k2_end
    ds_read2st64_b32 v[16:17], v10 offset0:0 offset1:1
    ds_read2st64_b32 v[18:19], v10 offset0:2 offset1:3
    ds_read2st64_b32 v[20:21], v10 offset0:4 offset1:5
    ds_read2st64_b32 v[22:23], v10 offset0:6 offset1:7
    ds_read2st64_b32 v[24:25], v10 offset0:8 offset1:9
    ds_read2st64_b32 v[26:27], v10 offset0:10 offset1:11
    ds_read2st64_b32 v[28:29], v10 offset0:12 offset1:13
    ds_read2st64_b32 v[30:31], v10 offset0:14 offset1:15
    s_waitcnt lgkmcnt(0)
    v_pk_add_f32 v[16:17], v[16:17], v[24:25]
    v_pk_add_f32 v[18:19], v[18:19], v[26:27]
    v_pk_add_f32 v[20:21], v[20:21], v[28:29]
    v_pk_add_f32 v[22:23], v[22:23], v[30:31]
    v_pk_add_f32 v[16:17], v[16:17], v[20:21]
    v_pk_add_f32 v[18:19], v[18:19], v[22:23]
    v_pk_add_f32 v[16:17], v[16:17], v[18:19]
    v_add_f32 v16, v16, v17
    buffer_store_dword v16, v11, s[12:15], s26 offen sc1
    s_endpgm
L_k2_pk2:
    s_and_b32 s27, s22, 3
    s_lshr_b32 s26, s21, 1
    s_and_b32 s28, s21, 1
    s_mul_i32 s36, s26, 373
    s_lshr_b32 s36, s36, 12
    s_mul_i32 s37, s36, 11
    s_sub_u32 s37, s26, s37
    s_mul_i32 s36, s36, 3
    v_lshlrev_b32 v4, 3, v2
    s_mul_i32 s38, s37, 11
    s_add_u32 s38, s38, s36
    s_add_u32 s38, s38, 0
    s_add_u32 s39, s36, s37
    s_sub_u32 s39, s39, 8
    s_lshl_b32 s39, s39, 1
    s_add_u32 s39, s39, 0
    s_mul_i32 s40, s39, 43
    s_lshr_b32 s40, s40, 7
    s_mul_i32 s39, s39, 3
    s_lshl_b32 s40, s40, 1
    s_add_u32 s39, s39, s40
    s_add_u32 s39, s39, 2
    s_cmp_lt_u32 s37, 8
    s_cselect_b32 s38, s38, s39
    s_lshr_b32 s30, s38, 3
    s_lshl_b32 s30, s30, 7
    s_and_b32 s29, s38, 7
    s_add_u32 s30, s30, s29
    s_lshl_b32 s29, s27, 5
    s_add_u32 s30, s30, s29
    s_lshl_b32 s32, s30, 10
    s_lshl_b32 s29, s28, 9
    s_add_u32 s32, s32, s29
    s_mul_i32 s38, s37, 11
    s_add_u32 s38, s38, s36
    s_add_u32 s38, s38, 1
    s_add_u32 s39, s36, s37
    s_sub_u32 s39, s39, 8
    s_lshl_b32 s39, s39, 1
    s_add_u32 s39, s39, 1
    s_mul_i32 s40, s39, 43
    s_lshr_b32 s40, s40, 7
    s_mul_i32 s39, s39, 3
    s_lshl_b32 s40, s40, 1
    s_add_u32 s39, s39, s40
    s_add_u32 s39, s39, 2
    s_cmp_lt_u32 s37, 8
    s_cselect_b32 s38, s38, s39
    s_lshr_b32 s30, s38, 3
    s_lshl_b32 s30, s30, 7
    s_and_b32 s29, s38, 7
    s_add_u32 s30, s30, s29
    s_lshl_b32 s29, s27, 5
    s_add_u32 s30, s30, s29
    s_lshl_b32 s33, s30, 10
    s_lshl_b32 s29, s28, 9
    s_add_u32 s33, s33, s29
    s_waitcnt lgkmcnt(0)
    s_mov_b32 s8, s4
    s_mov_b32 s9, s5
    s_mov_b32 s10, 1409024
    s_mov_b32 s11, 0x00020000
    s_add_u32 s29, s32, 0
    buffer_load_dwordx2 v[16:17], v4, s[8:11], s29 offen
    s_add_u32 s29, s32, 8192
    buffer_load_dwordx2 v[18:19], v4, s[8:11], s29 offen
    s_add_u32 s29, s32, 16384
    buffer_load_dwordx2 v[20:21], v4, s[8:11], s29 offen
    s_add_u32 s29, s32, 24576
    buffer_load_dwordx2 v[22:23], v4, s[8:11], s29 offen
    s_add_u32 s29, s33, 0
    buffer_load_dwordx2 v[24:25], v4, s[8:11], s29 offen
    s_add_u32 s29, s33, 8192
    buffer_load_dwordx2 v[26:27], v4, s[8:11], s29 offen
    s_add_u32 s29, s33, 16384
    buffer_load_dwordx2 v[28:29], v4, s[8:11], s29 offen
    s_add_u32 s29, s33, 24576
    buffer_load_dwordx2 v[30:31], v4, s[8:11], s29 offen
    s_add_u32 s12, s6, 9568256
    s_addc_u32 s13, s7, 0
    s_mov_b32 s14, 1441792
    s_mov_b32 s15, 0x00020000
    s_lshl_b32 s29, s26, 12
    s_lshl_b32 s30, s27, 8
    s_add_u32 s29, s29, s30
    s_mul_i32 s30, s28, 720896
    s_add_u32 s29, s29, s30
    v_lshrrev_b32 v5, 4, v2
    v_mul_u32_u24 v5, 180224, v5
    v_and_b32 v6, 15, v2
    v_lshl_add_u32 v5, v6, 4, v5
    s_mov_b32 s34, 0x05040100
    s_mov_b32 s35, 0x07060302
    s_waitcnt vmcnt(0)
    v_perm_b32 v48, v18, v16, s34
    v_perm_b32 v49, v22, v20, s34
    v_perm_b32 v50, v26, v24, s34
    v_perm_b32 v51, v30, v28, s34
    buffer_store_dwordx4 v[48:51], v5, s[12:15], s29 offen offset:0 sc1
    v_perm_b32 v52, v18, v16, s35
    v_perm_b32 v53, v22, v20, s35
    v_perm_b32 v54, v26, v24, s35
    v_perm_b32 v55, v30, v28, s35
    buffer_store_dwordx4 v[52:55], v5, s[12:15], s29 offen offset:1024 sc1
    v_perm_b32 v56, v19, v17, s34
    v_perm_b32 v57, v23, v21, s34
    v_perm_b32 v58, v27, v25, s34
    v_perm_b32 v59, v31, v29, s34
    buffer_store_dwordx4 v[56:59], v5, s[12:15], s29 offen offset:2048 sc1
    v_perm_b32 v60, v19, v17, s35
    v_perm_b32 v61, v23, v21, s35
    v_perm_b32 v62, v27, v25, s35
    v_perm_b32 v63, v31, v29, s35
    buffer_store_dwordx4 v[60:63], v5, s[12:15], s29 offen offset:3072 sc1
    s_barrier
    s_endpgm
L_k2_zf:
    s_cmp_lg_u32 s2, 129
    s_cbranch_scc1 L_k2_et
    s_load_dwordx2 s[6:7], s[0:1], 88
    v_lshlrev_b32 v1, 4, v0
    v_mov_b64 v[4:5], 0
    v_mov_b64 v[6:7], 0
    s_waitcnt lgkmcnt(0)
    s_add_u32 s8, s6, 65536
    s_addc_u32 s9, s7, 0
    s_mov_b32 s10, 8192
    s_mov_b32 s11, 0x00020000
    buffer_store_dwordx4 v[4:7], v1, s[8:11], 0 offen sc1
    s_endpgm
L_k2_et:
    s_cmp_ge_u32 s2, 132
    s_cbranch_scc1 L_k2_end
    s_load_dwordx2 s[6:7], s[0:1], 88
    s_sub_u32 s20, s2, 130
    s_lshl_b32 s20, s20, 7
    v_and_b32 v1, 15, v0
    v_bfe_u32 v2, v0, 4, 2
    v_lshrrev_b32 v3, 6, v0
    v_lshl_add_u32 v10, v3, 4, v1
    v_add_u32 v10, s20, v10
    v_cvt_f32_u32 v10, v10
    v_mul_f32 v10, 0x3b800000, v10
    v_lshlrev_b32 v8, 2, v2
    v_cvt_f32_u32 v9, v8
    v_mul_f32 v13, v9, v10
    v_mul_f32 v12, 0x41500000, v10
    v_cmp_eq_u32 vcc, 0, v2
    v_and_b32 v11, 1, v1
    v_lshlrev_b32 v11, 31, v11
    v_or_b32 v11, 0x3f003f00, v11
    v_and_b32 v4, 63, v0
    v_lshlrev_b32 v4, 4, v4
    v_lshl_add_u32 v4, v3, 13, v4
    s_lshl_b32 s20, s20, 9
    s_add_u32 s21, s20, 4096
    s_waitcnt lgkmcnt(0)
    s_add_u32 s8, s6, 2228224
    s_addc_u32 s9, s7, 0
    s_mov_b32 s10, 131072
    s_mov_b32 s11, 0x00020000
    v_cos_f32 v14, v13
    v_sin_f32 v15, v13
    s_nop 0
    v_cvt_pk_bf16_f32 v16, v14, -v15
    v_add_f32 v13, v13, v10
    v_cos_f32 v14, v13
    v_sin_f32 v15, v13
    s_nop 0
    v_cvt_pk_bf16_f32 v17, v14, -v15
    v_add_f32 v13, v13, v10
    v_cos_f32 v14, v13
    v_sin_f32 v15, v13
    s_nop 0
    v_cvt_pk_bf16_f32 v18, v14, -v15
    v_add_f32 v13, v13, v10
    v_cos_f32 v14, v13
    v_sin_f32 v15, v13
    s_nop 0
    v_cvt_pk_bf16_f32 v19, v14, -v15
    v_cndmask_b32 v16, v16, v11, vcc
    buffer_store_dwordx4 v[16:19], v4, s[8:11], s20 offen offset:0 sc1
    v_add_f32 v13, v13, v12
    v_cos_f32 v14, v13
    v_sin_f32 v15, v13
    s_nop 0
    v_cvt_pk_bf16_f32 v20, v14, -v15
    v_add_f32 v13, v13, v10
    v_cos_f32 v14, v13
    v_sin_f32 v15, v13
    s_nop 0
    v_cvt_pk_bf16_f32 v21, v14, -v15
    v_add_f32 v13, v13, v10
    v_cos_f32 v14, v13
    v_sin_f32 v15, v13
    s_nop 0
    v_cvt_pk_bf16_f32 v22, v14, -v15
    v_add_f32 v13, v13, v10
    v_cos_f32 v14, v13
    v_sin_f32 v15, v13
    s_nop 0
    v_cvt_pk_bf16_f32 v23, v14, -v15
    buffer_store_dwordx4 v[20:23], v4, s[8:11], s20 offen offset:1024 sc1
    v_add_f32 v13, v13, v12
    v_cos_f32 v14, v13
    v_sin_f32 v15, v13
    s_nop 0
    v_cvt_pk_bf16_f32 v24, v14, -v15
    v_add_f32 v13, v13, v10
    v_cos_f32 v14, v13
    v_sin_f32 v15, v13
    s_nop 0
    v_cvt_pk_bf16_f32 v25, v14, -v15
    v_add_f32 v13, v13, v10
    v_cos_f32 v14, v13
    v_sin_f32 v15, v13
    s_nop 0
    v_cvt_pk_bf16_f32 v26, v14, -v15
    v_add_f32 v13, v13, v10
    v_cos_f32 v14, v13
    v_sin_f32 v15, v13
    s_nop 0
    v_cvt_pk_bf16_f32 v27, v14, -v15
    buffer_store_dwordx4 v[24:27], v4, s[8:11], s20 offen offset:2048 sc1
    v_add_f32 v13, v13, v12
    v_cos_f32 v14, v13
    v_sin_f32 v15, v13
    s_nop 0
    v_cvt_pk_bf16_f32 v28, v14, -v15
    v_add_f32 v13, v13, v10
    v_cos_f32 v14, v13
    v_sin_f32 v15, v13
    s_nop 0
    v_cvt_pk_bf16_f32 v29, v14, -v15
    v_add_f32 v13, v13, v10
    v_cos_f32 v14, v13
    v_sin_f32 v15, v13
    s_nop 0
    v_cvt_pk_bf16_f32 v30, v14, -v15
    v_add_f32 v13, v13, v10
    v_cos_f32 v14, v13
    v_sin_f32 v15, v13
    s_nop 0
    v_cvt_pk_bf16_f32 v31, v14, -v15
    buffer_store_dwordx4 v[28:31], v4, s[8:11], s20 offen offset:3072 sc1
    v_add_f32 v13, v13, v12
    v_cos_f32 v14, v13
    v_sin_f32 v15, v13
    s_nop 0
    v_cvt_pk_bf16_f32 v32, v14, -v15
    v_add_f32 v13, v13, v10
    v_cos_f32 v14, v13
    v_sin_f32 v15, v13
    s_nop 0
    v_cvt_pk_bf16_f32 v33, v14, -v15
    v_add_f32 v13, v13, v10
    v_cos_f32 v14, v13
    v_sin_f32 v15, v13
    s_nop 0
    v_cvt_pk_bf16_f32 v34, v14, -v15
    v_add_f32 v13, v13, v10
    v_cos_f32 v14, v13
    v_sin_f32 v15, v13
    s_nop 0
    v_cvt_pk_bf16_f32 v35, v14, -v15
    buffer_store_dwordx4 v[32:35], v4, s[8:11], s21 offen offset:0 sc1
    v_add_f32 v13, v13, v12
    v_cos_f32 v14, v13
    v_sin_f32 v15, v13
    s_nop 0
    v_cvt_pk_bf16_f32 v36, v14, -v15
    v_add_f32 v13, v13, v10
    v_cos_f32 v14, v13
    v_sin_f32 v15, v13
    s_nop 0
    v_cvt_pk_bf16_f32 v37, v14, -v15
    v_add_f32 v13, v13, v10
    v_cos_f32 v14, v13
    v_sin_f32 v15, v13
    s_nop 0
    v_cvt_pk_bf16_f32 v38, v14, -v15
    v_add_f32 v13, v13, v10
    v_cos_f32 v14, v13
    v_sin_f32 v15, v13
    s_nop 0
    v_cvt_pk_bf16_f32 v39, v14, -v15
    buffer_store_dwordx4 v[36:39], v4, s[8:11], s21 offen offset:1024 sc1
    v_add_f32 v13, v13, v12
    v_cos_f32 v14, v13
    v_sin_f32 v15, v13
    s_nop 0
    v_cvt_pk_bf16_f32 v40, v14, -v15
    v_add_f32 v13, v13, v10
    v_cos_f32 v14, v13
    v_sin_f32 v15, v13
    s_nop 0
    v_cvt_pk_bf16_f32 v41, v14, -v15
    v_add_f32 v13, v13, v10
    v_cos_f32 v14, v13
    v_sin_f32 v15, v13
    s_nop 0
    v_cvt_pk_bf16_f32 v42, v14, -v15
    v_add_f32 v13, v13, v10
    v_cos_f32 v14, v13
    v_sin_f32 v15, v13
    s_nop 0
    v_cvt_pk_bf16_f32 v43, v14, -v15
    buffer_store_dwordx4 v[40:43], v4, s[8:11], s21 offen offset:2048 sc1
    v_add_f32 v13, v13, v12
    v_cos_f32 v14, v13
    v_sin_f32 v15, v13
    s_nop 0
    v_cvt_pk_bf16_f32 v44, v14, -v15
    v_add_f32 v13, v13, v10
    v_cos_f32 v14, v13
    v_sin_f32 v15, v13
    s_nop 0
    v_cvt_pk_bf16_f32 v45, v14, -v15
    v_add_f32 v13, v13, v10
    v_cos_f32 v14, v13
    v_sin_f32 v15, v13
    s_nop 0
    v_cvt_pk_bf16_f32 v46, v14, -v15
    v_add_f32 v13, v13, v10
    v_cos_f32 v14, v13
    v_sin_f32 v15, v13
    s_nop 0
    v_cvt_pk_bf16_f32 v47, v14, -v15
    buffer_store_dwordx4 v[44:47], v4, s[8:11], s21 offen offset:3072 sc1
L_k2_end:
    s_endpgm
.globl k34_kernel
.p2align 8
.type k34_kernel,@function
k34_kernel:
    s_cmp_ge_u32 s2, 256
    s_cbranch_scc1 L_k3_end
    s_load_dwordx2 s[4:5], s[0:1], 0
    s_load_dwordx2 s[6:7], s[0:1], 88
    s_load_dwordx2 s[42:43], s[0:1], 72
    s_and_b32 s20, s2, 7
    s_lshr_b32 s21, s20, 1
    s_lshl_b32 s21, s21, 3
    s_lshr_b32 s22, s2, 5
    s_add_u32 s21, s21, s22
    s_and_b32 s22, s20, 1
    s_lshl_b32 s22, s22, 2
    s_bfe_u32 s32, s2, 0x20003
    s_add_u32 s22, s22, s32
    s_lshr_b32 s23, s21, 2
    s_and_b32 s24, s21, 3
    v_mov_b32 v208, v0
    v_and_b32 v209, 15, v0
    v_bfe_u32 v210, v0, 4, 2
    v_lshrrev_b32 v211, 6, v0
    v_lshlrev_b32 v1, 4, v209
    v_lshl_add_u32 v2, v210, 13, v1
    v_readfirstlane_b32 s25, v211
    v_lshl_add_u32 v3, v211, 2, v210
    v_lshlrev_b32 v3, 15, v3
    v_lshl_add_u32 v3, v209, 3, v3
    s_lshl_b32 s26, s24, 19
    s_lshl_b32 s27, s23, 10
    s_add_u32 s26, s26, s27
    s_lshl_b32 s27, s22, 7
    s_add_u32 s26, s26, s27
    s_mul_i32 s27, s23, 264192
    s_lshl_b32 s28, s22, 8
    s_add_u32 s27, s27, s28
    s_waitcnt lgkmcnt(0)
    s_add_u32 s12, s6, 4456448
    s_addc_u32 s13, s7, 0
    s_mov_b32 s14, 2113536
    s_mov_b32 s15, 0x00020000
    s_mov_b32 s8, s4
    s_mov_b32 s9, s5
    s_mov_b32 s10, 2097152
    s_mov_b32 s11, 0x00020000
    s_lshl_b32 s28, s25, 15
    s_add_u32 s28, s28, s27
    s_add_u32 s29, s28, 4096
    buffer_load_dwordx4 v[128:131], v2, s[12:15], s28 offen
    buffer_load_dwordx4 v[132:135], v2, s[12:15], s28 offen offset:2048
    buffer_load_dwordx4 v[136:139], v2, s[12:15], s29 offen
    buffer_load_dwordx4 v[140:143], v2, s[12:15], s29 offen offset:2048
    s_add_u32 s31, s27, 262144
    buffer_load_dwordx4 v[192:195], v1, s[12:15], s31 offen
    s_add_u32 s28, s28, 131072
    s_add_u32 s29, s29, 131072
    buffer_load_dwordx4 v[144:147], v2, s[12:15], s28 offen
    buffer_load_dwordx4 v[148:151], v2, s[12:15], s28 offen offset:2048
    buffer_load_dwordx4 v[152:155], v2, s[12:15], s29 offen
    buffer_load_dwordx4 v[156:159], v2, s[12:15], s29 offen offset:2048
    s_add_u32 s28, s26, 0
    buffer_load_dwordx2 v[196:197], v3, s[8:11], s28 offen
    s_add_u32 s28, s26, 8192
    buffer_load_dwordx2 v[198:199], v3, s[8:11], s28 offen
    s_add_u32 s28, s26, 16384
    buffer_load_dwordx2 v[200:201], v3, s[8:11], s28 offen
    s_add_u32 s28, s26, 24576
    buffer_load_dwordx2 v[202:203], v3, s[8:11], s28 offen
    s_add_u32 s16, s6, 6684672
    s_addc_u32 s17, s7, 0
    s_mov_b32 s18, 2883584
    s_mov_b32 s19, 0x00020000
    s_add_u32 s44, s6, 11141120
    s_addc_u32 s45, s7, 0
    s_mov_b32 s46, 2097152
    s_mov_b32 s47, 0x00020000
    s_add_u32 s52, s6, 65536
    s_addc_u32 s53, s7, 0
    s_mov_b32 s54, 8192
    s_mov_b32 s55, 0x00020000
    v_mov_b32 v223, v3
    v_and_b32 v212, 63, v0
    v_lshlrev_b32 v212, 4, v212
    s_mul_i32 s29, s22, 11
    s_mul_i32 s30, s25, 3
    s_add_u32 s29, s29, s30
    s_lshl_b32 s30, s29, 15
    s_lshl_b32 s56, s21, 7
    s_mov_b32 s33, 0xffff0000
    s_mov_b32 s36, 0x05040100
    s_add_u32 s48, s6, 2228224
    s_addc_u32 s49, s7, 0
    s_mov_b32 s50, 131072
    s_mov_b32 s51, 0x00020000
    s_lshl_b32 s31, s24, 15
    s_lshl_b32 s32, s25, 13
    s_add_u32 s31, s31, s32
    s_add_u32 s32, s31, 4096
    buffer_load_dwordx4 v[96:99], v212, s[48:51], s31 offen offset:0
    buffer_load_dwordx4 v[100:103], v212, s[48:51], s31 offen offset:1024
    buffer_load_dwordx4 v[104:107], v212, s[48:51], s31 offen offset:2048
    buffer_load_dwordx4 v[108:111], v212, s[48:51], s31 offen offset:3072
    buffer_load_dwordx4 v[112:115], v212, s[48:51], s32 offen offset:0
    buffer_load_dwordx4 v[116:119], v212, s[48:51], s32 offen offset:1024
    buffer_load_dwordx4 v[120:123], v212, s[48:51], s32 offen offset:2048
    buffer_load_dwordx4 v[124:127], v212, s[48:51], s32 offen offset:3072
    v_lshrrev_b32 v8, 3, v209
    v_lshlrev_b32 v8, 12, v8
    v_lshl_add_u32 v8, v211, 10, v8
    v_bfe_u32 v9, v209, 1, 2
    v_lshl_add_u32 v8, v9, 8, v8
    v_and_b32 v9, 1, v209
    v_lshl_add_u32 v8, v9, 3, v8
    s_lshl_b32 s59, s22, 13
    v_lshrrev_b32 v9, 1, v209
    v_lshlrev_b32 v10, 2, v210
    v_xor_b32 v9, v9, v10
    v_xor_b32 v10, 0, v9
    v_lshl_add_u32 v236, v10, 4, v8
    v_xor_b32 v10, 1, v9
    v_lshl_add_u32 v237, v10, 4, v8
    v_xor_b32 v10, 2, v9
    v_lshl_add_u32 v238, v10, 4, v8
    v_xor_b32 v10, 3, v9
    v_lshl_add_u32 v239, v10, 4, v8
    v_xor_b32 v9, v209, v210
    v_lshlrev_b32 v10, 8, v210
    v_lshl_add_u32 v214, v9, 4, v10
    v_xor_b32 v215, 64, v214
    v_lshl_add_u32 v16, v211, 10, v212
    v_and_b32 v216, 7, v0
    v_lshlrev_b32 v216, 2, v216
    s_lshl_b32 s37, s21, 16
    v_add_u32 v17, 66048, v212
    v_lshl_add_u32 v18, v211, 12, v17
    v_cmp_gt_u32 vcc, 16, v0
    s_waitcnt vmcnt(16)
    v_perm_b32 v72, v192, v128, s36
    v_cndmask_b32 v40, v128, v72, vcc
    v_mov_b32 v41, v132
    v_mov_b32 v42, v136
    v_mov_b32 v43, v140
    ds_write_b128 v18, v[40:43] offset:0
    v_perm_b32 v73, v193, v129, s36
    v_cndmask_b32 v44, v129, v73, vcc
    v_mov_b32 v45, v133
    v_mov_b32 v46, v137
    v_mov_b32 v47, v141
    ds_write_b128 v18, v[44:47] offset:1024
    v_perm_b32 v74, v194, v130, s36
    v_cndmask_b32 v48, v130, v74, vcc
    v_mov_b32 v49, v134
    v_mov_b32 v50, v138
    v_mov_b32 v51, v142
    ds_write_b128 v18, v[48:51] offset:2048
    v_perm_b32 v75, v195, v131, s36
    v_cndmask_b32 v52, v131, v75, vcc
    v_mov_b32 v53, v135
    v_mov_b32 v54, v139
    v_mov_b32 v55, v143
    ds_write_b128 v18, v[52:55] offset:3072
    s_waitcnt vmcnt(12)
    v_mov_b32 v56, v144
    v_mov_b32 v57, v148
    v_mov_b32 v58, v152
    v_mov_b32 v59, v156
    ds_write_b128 v18, v[56:59] offset:16384
    v_mov_b32 v60, v145
    v_mov_b32 v61, v149
    v_mov_b32 v62, v153
    v_mov_b32 v63, v157
    ds_write_b128 v18, v[60:63] offset:17408
    v_mov_b32 v64, v146
    v_mov_b32 v65, v150
    v_mov_b32 v66, v154
    v_mov_b32 v67, v158
    ds_write_b128 v18, v[64:67] offset:18432
    v_mov_b32 v68, v147
    v_mov_b32 v69, v151
    v_mov_b32 v70, v155
    v_mov_b32 v71, v159
    ds_write_b128 v18, v[68:71] offset:19456
    s_waitcnt vmcnt(8)
    v_lshlrev_b32 v20, 16, v196
    v_and_b32 v24, s33, v196
    v_lshlrev_b32 v28, 16, v197
    v_and_b32 v32, s33, v197
    v_lshlrev_b32 v21, 16, v198
    v_and_b32 v25, s33, v198
    v_lshlrev_b32 v29, 16, v199
    v_and_b32 v33, s33, v199
    v_lshlrev_b32 v22, 16, v200
    v_and_b32 v26, s33, v200
    v_lshlrev_b32 v30, 16, v201
    v_and_b32 v34, s33, v201
    v_lshlrev_b32 v23, 16, v202
    v_and_b32 v27, s33, v202
    v_lshlrev_b32 v31, 16, v203
    v_and_b32 v35, s33, v203
    s_waitcnt lgkmcnt(0)
    s_barrier
    ds_read_b128 v[128:131], v17 offset:0
    ds_read_b128 v[132:135], v17 offset:1024
    ds_read_b128 v[136:139], v17 offset:2048
    ds_read_b128 v[140:143], v17 offset:3072
    ds_read_b128 v[144:147], v17 offset:4096
    ds_read_b128 v[148:151], v17 offset:5120
    ds_read_b128 v[152:155], v17 offset:6144
    ds_read_b128 v[156:159], v17 offset:7168
    ds_read_b128 v[160:163], v17 offset:8192
    ds_read_b128 v[164:167], v17 offset:9216
    ds_read_b128 v[168:171], v17 offset:10240
    ds_read_b128 v[172:175], v17 offset:11264
    s_waitcnt vmcnt(0)
    ds_read_b128 v[176:179], v17 offset:12288
    ds_read_b128 v[180:183], v17 offset:13312
    ds_read_b128 v[184:187], v17 offset:14336
    s_waitcnt lgkmcnt(14)
    ds_read_b128 v[188:191], v17 offset:15360
    s_waitcnt lgkmcnt(12)
    v_mfma_f32_16x16x32_bf16 v[20:23], v[96:99], v[128:131], v[20:23]
    ds_read_b128 v[128:131], v17 offset:16384
    v_mfma_f32_16x16x32_bf16 v[24:27], v[96:99], v[132:135], v[24:27]
    ds_read_b128 v[132:135], v17 offset:17408
    v_mfma_f32_16x16x32_bf16 v[28:31], v[96:99], v[136:139], v[28:31]
    ds_read_b128 v[136:139], v17 offset:18432
    v_mfma_f32_16x16x32_bf16 v[32:35], v[96:99], v[140:143], v[32:35]
    s_waitcnt lgkmcnt(14)
    ds_read_b128 v[140:143], v17 offset:19456
    s_waitcnt lgkmcnt(12)
    v_mfma_f32_16x16x32_bf16 v[20:23], v[100:103], v[144:147], v[20:23]
    ds_read_b128 v[144:147], v17 offset:20480
    v_mfma_f32_16x16x32_bf16 v[24:27], v[100:103], v[148:151], v[24:27]
    ds_read_b128 v[148:151], v17 offset:21504
    v_mfma_f32_16x16x32_bf16 v[28:31], v[100:103], v[152:155], v[28:31]
    ds_read_b128 v[152:155], v17 offset:22528
    v_mfma_f32_16x16x32_bf16 v[32:35], v[100:103], v[156:159], v[32:35]
    s_waitcnt lgkmcnt(14)
    ds_read_b128 v[156:159], v17 offset:23552
    s_waitcnt lgkmcnt(12)
    v_mfma_f32_16x16x32_bf16 v[20:23], v[104:107], v[160:163], v[20:23]
    ds_read_b128 v[160:163], v17 offset:24576
    v_mfma_f32_16x16x32_bf16 v[24:27], v[104:107], v[164:167], v[24:27]
    ds_read_b128 v[164:167], v17 offset:25600
    v_mfma_f32_16x16x32_bf16 v[28:31], v[104:107], v[168:171], v[28:31]
    ds_read_b128 v[168:171], v17 offset:26624
    v_mfma_f32_16x16x32_bf16 v[32:35], v[104:107], v[172:175], v[32:35]
    s_waitcnt lgkmcnt(14)
    ds_read_b128 v[172:175], v17 offset:27648
    s_waitcnt lgkmcnt(12)
    v_mfma_f32_16x16x32_bf16 v[20:23], v[108:111], v[176:179], v[20:23]
    ds_read_b128 v[176:179], v17 offset:28672
    v_mfma_f32_16x16x32_bf16 v[24:27], v[108:111], v[180:183], v[24:27]
    ds_read_b128 v[180:183], v17 offset:29696
    v_mfma_f32_16x16x32_bf16 v[28:31], v[108:111], v[184:187], v[28:31]
    ds_read_b128 v[184:187], v17 offset:30720
    v_mfma_f32_16x16x32_bf16 v[32:35], v[108:111], v[188:191], v[32:35]
    s_waitcnt lgkmcnt(14)
    ds_read_b128 v[188:191], v17 offset:31744
    s_waitcnt lgkmcnt(12)
    s_waitcnt lgkmcnt(8)
    s_waitcnt lgkmcnt(4)
    s_waitcnt lgkmcnt(0)
    v_mfma_f32_16x16x32_bf16 v[20:23], v[112:115], v[128:131], v[20:23]
    v_mfma_f32_16x16x32_bf16 v[24:27], v[112:115], v[132:135], v[24:27]
    v_mfma_f32_16x16x32_bf16 v[28:31], v[112:115], v[136:139], v[28:31]
    v_mfma_f32_16x16x32_bf16 v[32:35], v[112:115], v[140:143], v[32:35]
    v_mfma_f32_16x16x32_bf16 v[20:23], v[116:119], v[144:147], v[20:23]
    v_mfma_f32_16x16x32_bf16 v[24:27], v[116:119], v[148:151], v[24:27]
    v_mfma_f32_16x16x32_bf16 v[28:31], v[116:119], v[152:155], v[28:31]
    v_mfma_f32_16x16x32_bf16 v[32:35], v[116:119], v[156:159], v[32:35]
    v_mfma_f32_16x16x32_bf16 v[20:23], v[120:123], v[160:163], v[20:23]
    v_mfma_f32_16x16x32_bf16 v[24:27], v[120:123], v[164:167], v[24:27]
    v_mfma_f32_16x16x32_bf16 v[28:31], v[120:123], v[168:171], v[28:31]
    v_mfma_f32_16x16x32_bf16 v[32:35], v[120:123], v[172:175], v[32:35]
    v_mfma_f32_16x16x32_bf16 v[20:23], v[124:127], v[176:179], v[20:23]
    v_mfma_f32_16x16x32_bf16 v[24:27], v[124:127], v[180:183], v[24:27]
    v_mfma_f32_16x16x32_bf16 v[28:31], v[124:127], v[184:187], v[28:31]
    v_mfma_f32_16x16x32_bf16 v[32:35], v[124:127], v[188:191], v[32:35]
    s_nop 5
    v_cvt_pk_bf16_f32 v76, v20, v24
    v_cvt_pk_bf16_f32 v78, v21, v25
    v_cvt_pk_bf16_f32 v80, v22, v26
    v_cvt_pk_bf16_f32 v82, v23, v27
    v_cvt_pk_bf16_f32 v77, v28, v32
    ds_write_b64 v236, v[76:77]
    v_cvt_pk_bf16_f32 v79, v29, v33
    ds_write_b64 v237, v[78:79]
    v_cvt_pk_bf16_f32 v81, v30, v34
    ds_write_b64 v238, v[80:81]
    v_cvt_pk_bf16_f32 v83, v31, v35
    ds_write_b64 v239, v[82:83]
    s_waitcnt lgkmcnt(0)
    ds_read_b128 v[84:87], v16
    ds_read_b128 v[88:91], v16 offset:4096
    s_waitcnt lgkmcnt(0)
    s_add_u32 s38, s37, s59
    buffer_store_dwordx4 v[84:87], v16, s[44:47], s38 offen sc1
    s_add_u32 s38, s38, 4096
    buffer_store_dwordx4 v[88:91], v16, s[44:47], s38 offen sc1
    s_cmp_eq_u32 s25, 3
    s_cbranch_scc1 L_k3_role1
    s_add_u32 s76, s30, 0
    buffer_load_dwordx4 a[0:3], v212, s[16:19], s76 offen offset:0
    s_add_u32 s77, s30, 16384
    buffer_load_dwordx4 a[4:7], v212, s[16:19], s77 offen offset:0
    s_add_u32 s78, s30, 32768
    buffer_load_dwordx4 a[8:11], v212, s[16:19], s78 offen offset:0
    s_add_u32 s79, s30, 49152
    buffer_load_dwordx4 a[12:15], v212, s[16:19], s79 offen offset:0
    s_add_u32 s80, s30, 65536
    buffer_load_dwordx4 a[16:19], v212, s[16:19], s80 offen offset:0
    s_add_u32 s81, s30, 81920
    buffer_load_dwordx4 a[20:23], v212, s[16:19], s81 offen offset:0
    buffer_load_dwordx4 a[24:27], v212, s[16:19], s76 offen offset:1024
    buffer_load_dwordx4 a[28:31], v212, s[16:19], s77 offen offset:1024
    buffer_load_dwordx4 a[32:35], v212, s[16:19], s78 offen offset:1024
    buffer_load_dwordx4 a[36:39], v212, s[16:19], s79 offen offset:1024
    buffer_load_dwordx4 a[40:43], v212, s[16:19], s80 offen offset:1024
    buffer_load_dwordx4 a[44:47], v212, s[16:19], s81 offen offset:1024
    s_waitcnt vmcnt(12)
    s_barrier
    ds_read_b128 v[96:99], v214 offset:0
    ds_read_b128 v[100:103], v214 offset:1024
    ds_read_b128 v[104:107], v214 offset:2048
    ds_read_b128 v[108:111], v214 offset:3072
    ds_read_b128 v[112:115], v215 offset:4096
    ds_read_b128 v[116:119], v215 offset:5120
    ds_read_b128 v[120:123], v215 offset:6144
    ds_read_b128 v[124:127], v215 offset:7168
    s_waitcnt lgkmcnt(4)
    s_waitcnt vmcnt(6)
    v_mfma_f32_16x16x32_bf16 v[0:3], a[0:3], v[96:99], 0
    buffer_load_dwordx4 a[48:51], v212, s[16:19], s76 offen offset:2048
    v_mfma_f32_16x16x32_bf16 v[4:7], a[0:3], v[100:103], 0
    v_mfma_f32_16x16x32_bf16 v[8:11], a[0:3], v[104:107], 0
    v_mfma_f32_16x16x32_bf16 v[12:15], a[0:3], v[108:111], 0
    v_mfma_f32_16x16x32_bf16 v[16:19], a[4:7], v[96:99], 0
    buffer_load_dwordx4 a[52:55], v212, s[16:19], s77 offen offset:2048
    v_mfma_f32_16x16x32_bf16 v[20:23], a[4:7], v[100:103], 0
    v_mfma_f32_16x16x32_bf16 v[24:27], a[4:7], v[104:107], 0
    v_mfma_f32_16x16x32_bf16 v[28:31], a[4:7], v[108:111], 0
    v_mfma_f32_16x16x32_bf16 v[32:35], a[8:11], v[96:99], 0
    buffer_load_dwordx4 a[56:59], v212, s[16:19], s78 offen offset:2048
    v_mfma_f32_16x16x32_bf16 v[36:39], a[8:11], v[100:103], 0
    v_mfma_f32_16x16x32_bf16 v[40:43], a[8:11], v[104:107], 0
    v_mfma_f32_16x16x32_bf16 v[44:47], a[8:11], v[108:111], 0
    v_mfma_f32_16x16x32_bf16 v[48:51], a[12:15], v[96:99], 0
    buffer_load_dwordx4 a[60:63], v212, s[16:19], s79 offen offset:2048
    v_mfma_f32_16x16x32_bf16 v[52:55], a[12:15], v[100:103], 0
    v_mfma_f32_16x16x32_bf16 v[56:59], a[12:15], v[104:107], 0
    v_mfma_f32_16x16x32_bf16 v[60:63], a[12:15], v[108:111], 0
    v_mfma_f32_16x16x32_bf16 v[64:67], a[16:19], v[96:99], 0
    buffer_load_dwordx4 a[64:67], v212, s[16:19], s80 offen offset:2048
    v_mfma_f32_16x16x32_bf16 v[68:71], a[16:19], v[100:103], 0
    v_mfma_f32_16x16x32_bf16 v[72:75], a[16:19], v[104:107], 0
    v_mfma_f32_16x16x32_bf16 v[76:79], a[16:19], v[108:111], 0
    v_mfma_f32_16x16x32_bf16 v[80:83], a[20:23], v[96:99], 0
    buffer_load_dwordx4 a[68:71], v212, s[16:19], s81 offen offset:2048
    v_mfma_f32_16x16x32_bf16 v[84:87], a[20:23], v[100:103], 0
    v_mfma_f32_16x16x32_bf16 v[88:91], a[20:23], v[104:107], 0
    v_mfma_f32_16x16x32_bf16 v[92:95], a[20:23], v[108:111], 0
    s_waitcnt lgkmcnt(0)
    s_waitcnt vmcnt(6)
    v_mfma_f32_16x16x32_bf16 v[0:3], a[24:27], v[112:115], v[0:3]
    buffer_load_dwordx4 a[72:75], v212, s[16:19], s76 offen offset:3072
    v_mfma_f32_16x16x32_bf16 v[4:7], a[24:27], v[116:119], v[4:7]
    v_mfma_f32_16x16x32_bf16 v[8:11], a[24:27], v[120:123], v[8:11]
    v_mfma_f32_16x16x32_bf16 v[12:15], a[24:27], v[124:127], v[12:15]
    v_mfma_f32_16x16x32_bf16 v[16:19], a[28:31], v[112:115], v[16:19]
    buffer_load_dwordx4 a[76:79], v212, s[16:19], s77 offen offset:3072
    v_mfma_f32_16x16x32_bf16 v[20:23], a[28:31], v[116:119], v[20:23]
    v_mfma_f32_16x16x32_bf16 v[24:27], a[28:31], v[120:123], v[24:27]
    v_mfma_f32_16x16x32_bf16 v[28:31], a[28:31], v[124:127], v[28:31]
    v_mfma_f32_16x16x32_bf16 v[32:35], a[32:35], v[112:115], v[32:35]
    buffer_load_dwordx4 a[80:83], v212, s[16:19], s78 offen offset:3072
    v_mfma_f32_16x16x32_bf16 v[36:39], a[32:35], v[116:119], v[36:39]
    v_mfma_f32_16x16x32_bf16 v[40:43], a[32:35], v[120:123], v[40:43]
    v_mfma_f32_16x16x32_bf16 v[44:47], a[32:35], v[124:127], v[44:47]
    v_mfma_f32_16x16x32_bf16 v[48:51], a[36:39], v[112:115], v[48:51]
    buffer_load_dwordx4 a[84:87], v212, s[16:19], s79 offen offset:3072
    v_mfma_f32_16x16x32_bf16 v[52:55], a[36:39], v[116:119], v[52:55]
    v_mfma_f32_16x16x32_bf16 v[56:59], a[36:39], v[120:123], v[56:59]
    v_mfma_f32_16x16x32_bf16 v[60:63], a[36:39], v[124:127], v[60:63]
    v_mfma_f32_16x16x32_bf16 v[64:67], a[40:43], v[112:115], v[64:67]
    buffer_load_dwordx4 a[88:91], v212, s[16:19], s80 offen offset:3072
    v_mfma_f32_16x16x32_bf16 v[68:71], a[40:43], v[116:119], v[68:71]
    v_mfma_f32_16x16x32_bf16 v[72:75], a[40:43], v[120:123], v[72:75]
    v_mfma_f32_16x16x32_bf16 v[76:79], a[40:43], v[124:127], v[76:79]
    v_mfma_f32_16x16x32_bf16 v[80:83], a[44:47], v[112:115], v[80:83]
    buffer_load_dwordx4 a[92:95], v212, s[16:19], s81 offen offset:3072
    v_mfma_f32_16x16x32_bf16 v[84:87], a[44:47], v[116:119], v[84:87]
    v_mfma_f32_16x16x32_bf16 v[88:91], a[44:47], v[120:123], v[88:91]
    v_mfma_f32_16x16x32_bf16 v[92:95], a[44:47], v[124:127], v[92:95]
    s_add_u32 s76, s30, 4096
    buffer_load_dwordx4 a[96:99], v212, s[16:19], s76 offen offset:0
    s_add_u32 s77, s30, 20480
    buffer_load_dwordx4 a[100:103], v212, s[16:19], s77 offen offset:0
    s_add_u32 s78, s30, 36864
    buffer_load_dwordx4 a[104:107], v212, s[16:19], s78 offen offset:0
    s_add_u32 s79, s30, 53248
    buffer_load_dwordx4 a[108:111], v212, s[16:19], s79 offen offset:0
    s_add_u32 s80, s30, 69632
    buffer_load_dwordx4 a[112:115], v212, s[16:19], s80 offen offset:0
    s_add_u32 s81, s30, 86016
    buffer_load_dwordx4 a[116:119], v212, s[16:19], s81 offen offset:0
    buffer_load_dwordx4 a[120:123], v212, s[16:19], s76 offen offset:1024
    buffer_load_dwordx4 a[124:127], v212, s[16:19], s77 offen offset:1024
    buffer_load_dwordx4 a[128:131], v212, s[16:19], s78 offen offset:1024
    buffer_load_dwordx4 a[132:135], v212, s[16:19], s79 offen offset:1024
    buffer_load_dwordx4 a[136:139], v212, s[16:19], s80 offen offset:1024
    buffer_load_dwordx4 a[140:143], v212, s[16:19], s81 offen offset:1024
    buffer_load_dwordx4 a[144:147], v212, s[16:19], s76 offen offset:2048
    buffer_load_dwordx4 a[148:151], v212, s[16:19], s77 offen offset:2048
    s_barrier
    s_lshl_b32 s38, s25, 10
    s_add_u32 s39, s37, s38
    s_add_u32 m0, s38, 8192
    s_add_u32 s40, s59, 8192
    s_and_b32 s40, s40, 0xffff
    s_add_u32 s40, s40, s39
    buffer_load_dwordx4 v212, s[44:47], s40 offen sc1 lds
    s_add_u32 m0, s38, 12288
    s_add_u32 s40, s59, 12288
    s_and_b32 s40, s40, 0xffff
    s_add_u32 s40, s40, s39
    buffer_load_dwordx4 v212, s[44:47], s40 offen sc1 lds
    s_add_u32 m0, s38, 16384
    s_add_u32 s40, s59, 16384
    s_and_b32 s40, s40, 0xffff
    s_add_u32 s40, s40, s39
    buffer_load_dwordx4 v212, s[44:47], s40 offen sc1 lds
    s_add_u32 m0, s38, 20480
    s_add_u32 s40, s59, 20480
    s_and_b32 s40, s40, 0xffff
    s_add_u32 s40, s40, s39
    buffer_load_dwordx4 v212, s[44:47], s40 offen sc1 lds
    s_add_u32 m0, s38, 24576
    s_add_u32 s40, s59, 24576
    s_and_b32 s40, s40, 0xffff
    s_add_u32 s40, s40, s39
    buffer_load_dwordx4 v212, s[44:47], s40 offen sc1 lds
    s_add_u32 m0, s38, 28672
    s_add_u32 s40, s59, 28672
    s_and_b32 s40, s40, 0xffff
    s_add_u32 s40, s40, s39
    buffer_load_dwordx4 v212, s[44:47], s40 offen sc1 lds
    s_add_u32 m0, s38, 32768
    s_add_u32 s40, s59, 32768
    s_and_b32 s40, s40, 0xffff
    s_add_u32 s40, s40, s39
    buffer_load_dwordx4 v212, s[44:47], s40 offen sc1 lds
    s_add_u32 m0, s38, 36864
    s_add_u32 s40, s59, 36864
    s_and_b32 s40, s40, 0xffff
    s_add_u32 s40, s40, s39
    buffer_load_dwordx4 v212, s[44:47], s40 offen sc1 lds
    s_add_u32 m0, s38, 40960
    s_add_u32 s40, s59, 40960
    s_and_b32 s40, s40, 0xffff
    s_add_u32 s40, s40, s39
    buffer_load_dwordx4 v212, s[44:47], s40 offen sc1 lds
    s_add_u32 m0, s38, 45056
    s_add_u32 s40, s59, 45056
    s_and_b32 s40, s40, 0xffff
    s_add_u32 s40, s40, s39
    buffer_load_dwordx4 v212, s[44:47], s40 offen sc1 lds
    s_add_u32 m0, s38, 49152
    s_add_u32 s40, s59, 49152
    s_and_b32 s40, s40, 0xffff
    s_add_u32 s40, s40, s39
    buffer_load_dwordx4 v212, s[44:47], s40 offen sc1 lds
    s_add_u32 m0, s38, 53248
    s_add_u32 s40, s59, 53248
    s_and_b32 s40, s40, 0xffff
    s_add_u32 s40, s40, s39
    buffer_load_dwordx4 v212, s[44:47], s40 offen sc1 lds
    s_add_u32 m0, s38, 57344
    s_add_u32 s40, s59, 57344
    s_and_b32 s40, s40, 0xffff
    s_add_u32 s40, s40, s39
    buffer_load_dwordx4 v212, s[44:47], s40 offen sc1 lds
    s_add_u32 m0, s38, 61440
    s_add_u32 s40, s59, 61440
    s_and_b32 s40, s40, 0xffff
    s_add_u32 s40, s40, s39
    buffer_load_dwordx4 v212, s[44:47], s40 offen sc1 lds
    s_waitcnt vmcnt(10)
    s_barrier
    ds_read_b128 v[96:99], v214 offset:8192
    ds_read_b128 v[100:103], v214 offset:9216
    ds_read_b128 v[104:107], v214 offset:10240
    ds_read_b128 v[108:111], v214 offset:11264
    s_waitcnt lgkmcnt(0)
    v_mfma_f32_16x16x32_bf16 v[0:3], a[48:51], v[96:99], v[0:3]
    ds_read_b128 v[112:115], v215 offset:12288
    buffer_load_dwordx4 a[152:155], v212, s[16:19], s78 offen offset:2048
    ds_read_b128 v[116:119], v215 offset:13312
    v_mfma_f32_16x16x32_bf16 v[4:7], a[48:51], v[100:103], v[4:7]
    ds_read_b128 v[120:123], v215 offset:14336
    ds_read_b128 v[124:127], v215 offset:15360
    s_add_u32 s12, s6, 16384
    s_addc_u32 s13, s7, 0
    v_mfma_f32_16x16x32_bf16 v[8:11], a[48:51], v[104:107], v[8:11]
    s_mov_b32 s14, 22528
    s_mov_b32 s15, 0x00020000
    s_add_u32 s8, s6, 13238272
    s_addc_u32 s9, s7, 0
    v_mfma_f32_16x16x32_bf16 v[12:15], a[48:51], v[108:111], v[12:15]
    s_mov_b32 s10, 5767168
    s_mov_b32 s11, 0x00020000
    s_add_u32 s48, s6, 9568256
    s_addc_u32 s49, s7, 0
    v_mfma_f32_16x16x32_bf16 v[16:19], a[52:55], v[96:99], v[16:19]
    buffer_load_dwordx4 a[156:159], v212, s[16:19], s79 offen offset:2048
    s_mov_b32 s50, 1441792
    s_mov_b32 s51, 0x00020000
    v_mfma_f32_16x16x32_bf16 v[20:23], a[52:55], v[100:103], v[20:23]
    s_lshl_b32 s40, s29, 8
    v_lshrrev_b32 v219, 2, v212
    v_mfma_f32_16x16x32_bf16 v[24:27], a[52:55], v[104:107], v[24:27]
    s_mul_i32 s41, s21, 88
    s_mul_i32 s82, s22, 3
    s_add_u32 s82, s82, s25
    v_mfma_f32_16x16x32_bf16 v[28:31], a[52:55], v[108:111], v[28:31]
    s_lshr_b32 s83, s82, 1
    s_and_b32 s82, s82, 1
    s_add_u32 s82, s82, s41
    v_mfma_f32_16x16x32_bf16 v[32:35], a[56:59], v[96:99], v[32:35]
    buffer_load_dwordx4 a[160:163], v212, s[16:19], s80 offen offset:2048
    s_mul_i32 s32, s83, 43
    s_lshr_b32 s32, s32, 7
    v_mfma_f32_16x16x32_bf16 v[36:39], a[56:59], v[100:103], v[36:39]
    s_lshl_b32 s32, s32, 3
    s_add_u32 s83, s83, s32
    s_add_u32 s83, s83, 8
    v_mfma_f32_16x16x32_bf16 v[40:43], a[56:59], v[104:107], v[40:43]
    s_lshl_b32 s83, s83, 1
    s_add_u32 s83, s83, s82
    s_lshl_b32 s83, s83, 11
    v_mfma_f32_16x16x32_bf16 v[44:47], a[56:59], v[108:111], v[44:47]
    s_mul_i32 s82, s25, 22
    s_add_u32 s41, s41, s82
    v_mfma_f32_16x16x32_bf16 v[48:51], a[60:63], v[96:99], v[48:51]
    s_lshl_b32 s82, s22, 1
    buffer_load_dwordx4 a[164:167], v212, s[16:19], s81 offen offset:2048
    s_add_u32 s41, s41, s82
    v_mfma_f32_16x16x32_bf16 v[52:55], a[60:63], v[100:103], v[52:55]
    s_lshl_b32 s41, s41, 11
    s_mul_i32 s27, s25, 11
    s_mul_i32 s28, s22, 44
    v_mfma_f32_16x16x32_bf16 v[56:59], a[60:63], v[104:107], v[56:59]
    s_add_u32 s28, s28, s27
    s_lshl_b32 s28, s28, 12
    s_mul_i32 s32, s21, 44
    v_mfma_f32_16x16x32_bf16 v[60:63], a[60:63], v[108:111], v[60:63]
    s_add_u32 s27, s27, s32
    s_lshl_b32 s27, s27, 12
    s_lshl_b32 s64, s22, 12
    v_mfma_f32_16x16x32_bf16 v[64:67], a[64:67], v[96:99], v[64:67]
    buffer_load_dwordx4 a[168:171], v212, s[16:19], s76 offen offset:3072
    s_movk_i32 s65, 4096
    s_cmp_gt_u32 s22, 0
    s_cselect_b32 s65, 0, s65
    v_mfma_f32_16x16x32_bf16 v[68:71], a[64:67], v[100:103], v[68:71]
    s_movk_i32 s66, 8192
    s_cmp_gt_u32 s22, 1
    s_cselect_b32 s66, 4096, s66
    v_mfma_f32_16x16x32_bf16 v[72:75], a[64:67], v[104:107], v[72:75]
    s_movk_i32 s67, 12288
    s_cmp_gt_u32 s22, 2
    s_cselect_b32 s67, 8192, s67
    s_movk_i32 s68, 16384
    v_mfma_f32_16x16x32_bf16 v[76:79], a[64:67], v[108:111], v[76:79]
    s_cmp_gt_u32 s22, 3
    s_cselect_b32 s68, 12288, s68
    s_movk_i32 s69, 20480
    s_cmp_gt_u32 s22, 4
    s_cselect_b32 s69, 16384, s69
    v_mfma_f32_16x16x32_bf16 v[80:83], a[68:71], v[96:99], v[80:83]
    buffer_load_dwordx4 a[172:175], v212, s[16:19], s77 offen offset:3072
    s_movk_i32 s70, 24576
    s_cmp_gt_u32 s22, 5
    s_cselect_b32 s70, 20480, s70
    v_mfma_f32_16x16x32_bf16 v[84:87], a[68:71], v[100:103], v[84:87]
    s_movk_i32 s71, 28672
    s_cmp_gt_u32 s22, 6
    s_cselect_b32 s71, 24576, s71
    s_mov_b32 s72, 32768
    v_mfma_f32_16x16x32_bf16 v[88:91], a[68:71], v[104:107], v[88:91]
    s_mov_b32 s73, 36864
    s_mov_b32 s74, 40960
    buffer_load_dword v232, v219, s[12:15], s40 offen offset:0
    v_mfma_f32_16x16x32_bf16 v[92:95], a[68:71], v[108:111], v[92:95]
    buffer_load_dword v233, v219, s[12:15], s40 offen offset:256
    buffer_load_dword v234, v219, s[12:15], s40 offen offset:512
    s_waitcnt vmcnt(15)
    s_barrier
    s_waitcnt lgkmcnt(0)
    v_mfma_f32_16x16x32_bf16 v[0:3], a[72:75], v[112:115], v[0:3]
    ds_read_b128 v[96:99], v214 offset:16384
    v_mfma_f32_16x16x32_bf16 v[4:7], a[72:75], v[116:119], v[4:7]
    v_mfma_f32_16x16x32_bf16 v[8:11], a[72:75], v[120:123], v[8:11]
    buffer_load_dwordx4 a[176:179], v212, s[16:19], s78 offen offset:3072
    v_mfma_f32_16x16x32_bf16 v[12:15], a[72:75], v[124:127], v[12:15]
    v_mfma_f32_16x16x32_bf16 v[16:19], a[76:79], v[112:115], v[16:19]
    buffer_load_dwordx4 a[180:183], v212, s[16:19], s79 offen offset:3072
    v_mfma_f32_16x16x32_bf16 v[20:23], a[76:79], v[116:119], v[20:23]
    v_mfma_f32_16x16x32_bf16 v[24:27], a[76:79], v[120:123], v[24:27]
    v_mfma_f32_16x16x32_bf16 v[28:31], a[76:79], v[124:127], v[28:31]
    ds_read_b128 v[100:103], v214 offset:17408
    v_mfma_f32_16x16x32_bf16 v[32:35], a[80:83], v[112:115], v[32:35]
    v_mfma_f32_16x16x32_bf16 v[36:39], a[80:83], v[116:119], v[36:39]
    buffer_load_dwordx4 a[184:187], v212, s[16:19], s80 offen offset:3072
    v_mfma_f32_16x16x32_bf16 v[40:43], a[80:83], v[120:123], v[40:43]
    v_mfma_f32_16x16x32_bf16 v[44:47], a[80:83], v[124:127], v[44:47]
    v_mfma_f32_16x16x32_bf16 v[48:51], a[84:87], v[112:115], v[48:51]
    ds_read_b128 v[104:107], v214 offset:18432
    v_mfma_f32_16x16x32_bf16 v[52:55], a[84:87], v[116:119], v[52:55]
    v_mfma_f32_16x16x32_bf16 v[56:59], a[84:87], v[120:123], v[56:59]
    buffer_load_dwordx4 a[188:191], v212, s[16:19], s81 offen offset:3072
    v_mfma_f32_16x16x32_bf16 v[60:63], a[84:87], v[124:127], v[60:63]
    v_mfma_f32_16x16x32_bf16 v[64:67], a[88:91], v[112:115], v[64:67]
    s_add_u32 s76, s30, 8192
    buffer_load_dwordx4 a[192:195], v212, s[16:19], s76 offen offset:0
    v_mfma_f32_16x16x32_bf16 v[68:71], a[88:91], v[116:119], v[68:71]
    v_mfma_f32_16x16x32_bf16 v[72:75], a[88:91], v[120:123], v[72:75]
    v_mfma_f32_16x16x32_bf16 v[76:79], a[88:91], v[124:127], v[76:79]
    ds_read_b128 v[108:111], v214 offset:19456
    v_mfma_f32_16x16x32_bf16 v[80:83], a[92:95], v[112:115], v[80:83]
    v_mfma_f32_16x16x32_bf16 v[84:87], a[92:95], v[116:119], v[84:87]
    s_add_u32 s77, s30, 24576
    buffer_load_dwordx4 a[196:199], v212, s[16:19], s77 offen offset:0
    v_mfma_f32_16x16x32_bf16 v[88:91], a[92:95], v[120:123], v[88:91]
    v_mfma_f32_16x16x32_bf16 v[92:95], a[92:95], v[124:127], v[92:95]
    s_waitcnt lgkmcnt(0)
    v_mfma_f32_16x16x32_bf16 v[0:3], a[96:99], v[96:99], v[0:3]
    ds_read_b128 v[112:115], v215 offset:20480
    v_mfma_f32_16x16x32_bf16 v[4:7], a[96:99], v[100:103], v[4:7]
    v_mfma_f32_16x16x32_bf16 v[8:11], a[96:99], v[104:107], v[8:11]
    s_add_u32 s78, s30, 40960
    buffer_load_dwordx4 a[200:203], v212, s[16:19], s78 offen offset:0
    v_mfma_f32_16x16x32_bf16 v[12:15], a[96:99], v[108:111], v[12:15]
    v_mfma_f32_16x16x32_bf16 v[16:19], a[100:103], v[96:99], v[16:19]
    s_add_u32 s79, s30, 57344
    buffer_load_dwordx4 a[204:207], v212, s[16:19], s79 offen offset:0
    v_mfma_f32_16x16x32_bf16 v[20:23], a[100:103], v[100:103], v[20:23]
    v_mfma_f32_16x16x32_bf16 v[24:27], a[100:103], v[104:107], v[24:27]
    v_mfma_f32_16x16x32_bf16 v[28:31], a[100:103], v[108:111], v[28:31]
    ds_read_b128 v[116:119], v215 offset:21504
    v_mfma_f32_16x16x32_bf16 v[32:35], a[104:107], v[96:99], v[32:35]
    v_mfma_f32_16x16x32_bf16 v[36:39], a[104:107], v[100:103], v[36:39]
    s_add_u32 s80, s30, 73728
    buffer_load_dwordx4 a[208:211], v212, s[16:19], s80 offen offset:0
    v_mfma_f32_16x16x32_bf16 v[40:43], a[104:107], v[104:107], v[40:43]
    v_mfma_f32_16x16x32_bf16 v[44:47], a[104:107], v[108:111], v[44:47]
    v_mfma_f32_16x16x32_bf16 v[48:51], a[108:111], v[96:99], v[48:51]
    ds_read_b128 v[120:123], v215 offset:22528
    v_mfma_f32_16x16x32_bf16 v[52:55], a[108:111], v[100:103], v[52:55]
    v_mfma_f32_16x16x32_bf16 v[56:59], a[108:111], v[104:107], v[56:59]
    s_add_u32 s81, s30, 90112
    buffer_load_dwordx4 a[212:215], v212, s[16:19], s81 offen offset:0
    v_mfma_f32_16x16x32_bf16 v[60:63], a[108:111], v[108:111], v[60:63]
    v_mfma_f32_16x16x32_bf16 v[64:67], a[112:115], v[96:99], v[64:67]
    buffer_load_dwordx4 a[216:219], v212, s[16:19], s76 offen offset:1024
    v_mfma_f32_16x16x32_bf16 v[68:71], a[112:115], v[100:103], v[68:71]
    v_mfma_f32_16x16x32_bf16 v[72:75], a[112:115], v[104:107], v[72:75]
    v_mfma_f32_16x16x32_bf16 v[76:79], a[112:115], v[108:111], v[76:79]
    ds_read_b128 v[124:127], v215 offset:23552
    v_mfma_f32_16x16x32_bf16 v[80:83], a[116:119], v[96:99], v[80:83]
    v_mfma_f32_16x16x32_bf16 v[84:87], a[116:119], v[100:103], v[84:87]
    buffer_load_dwordx4 a[220:223], v212, s[16:19], s77 offen offset:1024
    v_mfma_f32_16x16x32_bf16 v[88:91], a[116:119], v[104:107], v[88:91]
    v_mfma_f32_16x16x32_bf16 v[92:95], a[116:119], v[108:111], v[92:95]
    s_waitcnt vmcnt(23)
    s_barrier
    s_waitcnt lgkmcnt(0)
    v_mfma_f32_16x16x32_bf16 v[0:3], a[120:123], v[112:115], v[0:3]
    ds_read_b128 v[96:99], v214 offset:24576
    v_mfma_f32_16x16x32_bf16 v[4:7], a[120:123], v[116:119], v[4:7]
    v_mfma_f32_16x16x32_bf16 v[8:11], a[120:123], v[120:123], v[8:11]
    buffer_load_dwordx4 a[224:227], v212, s[16:19], s78 offen offset:1024
    v_mfma_f32_16x16x32_bf16 v[12:15], a[120:123], v[124:127], v[12:15]
    v_mfma_f32_16x16x32_bf16 v[16:19], a[124:127], v[112:115], v[16:19]
    buffer_load_dwordx4 a[228:231], v212, s[16:19], s79 offen offset:1024
    v_mfma_f32_16x16x32_bf16 v[20:23], a[124:127], v[116:119], v[20:23]
    v_mfma_f32_16x16x32_bf16 v[24:27], a[124:127], v[120:123], v[24:27]
    v_mfma_f32_16x16x32_bf16 v[28:31], a[124:127], v[124:127], v[28:31]
    ds_read_b128 v[100:103], v214 offset:25600
    v_mfma_f32_16x16x32_bf16 v[32:35], a[128:131], v[112:115], v[32:35]
    v_mfma_f32_16x16x32_bf16 v[36:39], a[128:131], v[116:119], v[36:39]
    buffer_load_dwordx4 a[232:235], v212, s[16:19], s80 offen offset:1024
    v_mfma_f32_16x16x32_bf16 v[40:43], a[128:131], v[120:123], v[40:43]
    v_mfma_f32_16x16x32_bf16 v[44:47], a[128:131], v[124:127], v[44:47]
    v_mfma_f32_16x16x32_bf16 v[48:51], a[132:135], v[112:115], v[48:51]
    ds_read_b128 v[104:107], v214 offset:26624
    v_mfma_f32_16x16x32_bf16 v[52:55], a[132:135], v[116:119], v[52:55]
    v_mfma_f32_16x16x32_bf16 v[56:59], a[132:135], v[120:123], v[56:59]
    buffer_load_dwordx4 a[236:239], v212, s[16:19], s81 offen offset:1024
    v_mfma_f32_16x16x32_bf16 v[60:63], a[132:135], v[124:127], v[60:63]
    v_mfma_f32_16x16x32_bf16 v[64:67], a[136:139], v[112:115], v[64:67]
    buffer_load_dwordx4 a[0:3], v212, s[16:19], s76 offen offset:2048
    v_mfma_f32_16x16x32_bf16 v[68:71], a[136:139], v[116:119], v[68:71]
    v_mfma_f32_16x16x32_bf16 v[72:75], a[136:139], v[120:123], v[72:75]
    v_mfma_f32_16x16x32_bf16 v[76:79], a[136:139], v[124:127], v[76:79]
    ds_read_b128 v[108:111], v214 offset:27648
    v_mfma_f32_16x16x32_bf16 v[80:83], a[140:143], v[112:115], v[80:83]
    v_mfma_f32_16x16x32_bf16 v[84:87], a[140:143], v[116:119], v[84:87]
    buffer_load_dwordx4 a[4:7], v212, s[16:19], s77 offen offset:2048
    v_mfma_f32_16x16x32_bf16 v[88:91], a[140:143], v[120:123], v[88:91]
    v_mfma_f32_16x16x32_bf16 v[92:95], a[140:143], v[124:127], v[92:95]
    s_waitcnt vmcnt(27)
    s_barrier
    s_waitcnt vmcnt(23)
    s_waitcnt lgkmcnt(0)
    v_mfma_f32_16x16x32_bf16 v[0:3], a[144:147], v[96:99], v[0:3]
    ds_read_b128 v[112:115], v215 offset:28672
    v_mfma_f32_16x16x32_bf16 v[4:7], a[144:147], v[100:103], v[4:7]
    v_mfma_f32_16x16x32_bf16 v[8:11], a[144:147], v[104:107], v[8:11]
    buffer_load_dwordx4 a[8:11], v212, s[16:19], s78 offen offset:2048
    v_mfma_f32_16x16x32_bf16 v[12:15], a[144:147], v[108:111], v[12:15]
    v_mfma_f32_16x16x32_bf16 v[16:19], a[148:151], v[96:99], v[16:19]
    buffer_load_dwordx4 a[12:15], v212, s[16:19], s79 offen offset:2048
    v_mfma_f32_16x16x32_bf16 v[20:23], a[148:151], v[100:103], v[20:23]
    v_mfma_f32_16x16x32_bf16 v[24:27], a[148:151], v[104:107], v[24:27]
    v_mfma_f32_16x16x32_bf16 v[28:31], a[148:151], v[108:111], v[28:31]
    ds_read_b128 v[116:119], v215 offset:29696
    v_mfma_f32_16x16x32_bf16 v[32:35], a[152:155], v[96:99], v[32:35]
    v_mfma_f32_16x16x32_bf16 v[36:39], a[152:155], v[100:103], v[36:39]
    buffer_load_dwordx4 a[16:19], v212, s[16:19], s80 offen offset:2048
    v_mfma_f32_16x16x32_bf16 v[40:43], a[152:155], v[104:107], v[40:43]
    v_mfma_f32_16x16x32_bf16 v[44:47], a[152:155], v[108:111], v[44:47]
    v_mfma_f32_16x16x32_bf16 v[48:51], a[156:159], v[96:99], v[48:51]
    ds_read_b128 v[120:123], v215 offset:30720
    v_mfma_f32_16x16x32_bf16 v[52:55], a[156:159], v[100:103], v[52:55]
    v_mfma_f32_16x16x32_bf16 v[56:59], a[156:159], v[104:107], v[56:59]
    buffer_load_dwordx4 a[20:23], v212, s[16:19], s81 offen offset:2048
    v_mfma_f32_16x16x32_bf16 v[60:63], a[156:159], v[108:111], v[60:63]
    v_mfma_f32_16x16x32_bf16 v[64:67], a[160:163], v[96:99], v[64:67]
    buffer_load_dwordx4 a[24:27], v212, s[16:19], s76 offen offset:3072
    v_mfma_f32_16x16x32_bf16 v[68:71], a[160:163], v[100:103], v[68:71]
    v_mfma_f32_16x16x32_bf16 v[72:75], a[160:163], v[104:107], v[72:75]
    v_mfma_f32_16x16x32_bf16 v[76:79], a[160:163], v[108:111], v[76:79]
    ds_read_b128 v[124:127], v215 offset:31744
    v_mfma_f32_16x16x32_bf16 v[80:83], a[164:167], v[96:99], v[80:83]
    v_mfma_f32_16x16x32_bf16 v[84:87], a[164:167], v[100:103], v[84:87]
    buffer_load_dwordx4 a[28:31], v212, s[16:19], s77 offen offset:3072
    v_mfma_f32_16x16x32_bf16 v[88:91], a[164:167], v[104:107], v[88:91]
    v_mfma_f32_16x16x32_bf16 v[92:95], a[164:167], v[108:111], v[92:95]
    s_barrier
    s_waitcnt vmcnt(20)
    s_waitcnt lgkmcnt(0)
    v_mfma_f32_16x16x32_bf16 v[0:3], a[168:171], v[112:115], v[0:3]
    ds_read_b128 v[96:99], v214 offset:32768
    v_mfma_f32_16x16x32_bf16 v[4:7], a[168:171], v[116:119], v[4:7]
    v_mfma_f32_16x16x32_bf16 v[8:11], a[168:171], v[120:123], v[8:11]
    buffer_load_dwordx4 a[32:35], v212, s[16:19], s78 offen offset:3072
    v_mfma_f32_16x16x32_bf16 v[12:15], a[168:171], v[124:127], v[12:15]
    v_mfma_f32_16x16x32_bf16 v[16:19], a[172:175], v[112:115], v[16:19]
    buffer_load_dwordx4 a[36:39], v212, s[16:19], s79 offen offset:3072
    v_mfma_f32_16x16x32_bf16 v[20:23], a[172:175], v[116:119], v[20:23]
    v_mfma_f32_16x16x32_bf16 v[24:27], a[172:175], v[120:123], v[24:27]
    v_mfma_f32_16x16x32_bf16 v[28:31], a[172:175], v[124:127], v[28:31]
    ds_read_b128 v[100:103], v214 offset:33792
    v_mfma_f32_16x16x32_bf16 v[32:35], a[176:179], v[112:115], v[32:35]
    v_mfma_f32_16x16x32_bf16 v[36:39], a[176:179], v[116:119], v[36:39]
    buffer_load_dwordx4 a[40:43], v212, s[16:19], s80 offen offset:3072
    v_mfma_f32_16x16x32_bf16 v[40:43], a[176:179], v[120:123], v[40:43]
    v_mfma_f32_16x16x32_bf16 v[44:47], a[176:179], v[124:127], v[44:47]
    v_mfma_f32_16x16x32_bf16 v[48:51], a[180:183], v[112:115], v[48:51]
    ds_read_b128 v[104:107], v214 offset:34816
    v_mfma_f32_16x16x32_bf16 v[52:55], a[180:183], v[116:119], v[52:55]
    v_mfma_f32_16x16x32_bf16 v[56:59], a[180:183], v[120:123], v[56:59]
    buffer_load_dwordx4 a[44:47], v212, s[16:19], s81 offen offset:3072
    v_mfma_f32_16x16x32_bf16 v[60:63], a[180:183], v[124:127], v[60:63]
    v_mfma_f32_16x16x32_bf16 v[64:67], a[184:187], v[112:115], v[64:67]
    s_add_u32 s76, s30, 12288
    buffer_load_dwordx4 a[48:51], v212, s[16:19], s76 offen offset:0
    v_mfma_f32_16x16x32_bf16 v[68:71], a[184:187], v[116:119], v[68:71]
    v_mfma_f32_16x16x32_bf16 v[72:75], a[184:187], v[120:123], v[72:75]
    v_mfma_f32_16x16x32_bf16 v[76:79], a[184:187], v[124:127], v[76:79]
    ds_read_b128 v[108:111], v214 offset:35840
    v_mfma_f32_16x16x32_bf16 v[80:83], a[188:191], v[112:115], v[80:83]
    v_mfma_f32_16x16x32_bf16 v[84:87], a[188:191], v[116:119], v[84:87]
    s_add_u32 s77, s30, 28672
    buffer_load_dwordx4 a[52:55], v212, s[16:19], s77 offen offset:0
    v_mfma_f32_16x16x32_bf16 v[88:91], a[188:191], v[120:123], v[88:91]
    v_mfma_f32_16x16x32_bf16 v[92:95], a[188:191], v[124:127], v[92:95]
    s_waitcnt vmcnt(20)
    s_waitcnt lgkmcnt(0)
    v_mfma_f32_16x16x32_bf16 v[0:3], a[192:195], v[96:99], v[0:3]
    ds_read_b128 v[112:115], v215 offset:36864
    v_mfma_f32_16x16x32_bf16 v[4:7], a[192:195], v[100:103], v[4:7]
    v_mfma_f32_16x16x32_bf16 v[8:11], a[192:195], v[104:107], v[8:11]
    s_add_u32 s78, s30, 45056
    buffer_load_dwordx4 a[56:59], v212, s[16:19], s78 offen offset:0
    v_mfma_f32_16x16x32_bf16 v[12:15], a[192:195], v[108:111], v[12:15]
    v_mfma_f32_16x16x32_bf16 v[16:19], a[196:199], v[96:99], v[16:19]
    s_add_u32 s79, s30, 61440
    buffer_load_dwordx4 a[60:63], v212, s[16:19], s79 offen offset:0
    v_mfma_f32_16x16x32_bf16 v[20:23], a[196:199], v[100:103], v[20:23]
    v_mfma_f32_16x16x32_bf16 v[24:27], a[196:199], v[104:107], v[24:27]
    v_mfma_f32_16x16x32_bf16 v[28:31], a[196:199], v[108:111], v[28:31]
    ds_read_b128 v[116:119], v215 offset:37888
    v_mfma_f32_16x16x32_bf16 v[32:35], a[200:203], v[96:99], v[32:35]
    v_mfma_f32_16x16x32_bf16 v[36:39], a[200:203], v[100:103], v[36:39]
    s_add_u32 s80, s30, 77824
    buffer_load_dwordx4 a[64:67], v212, s[16:19], s80 offen offset:0
    v_mfma_f32_16x16x32_bf16 v[40:43], a[200:203], v[104:107], v[40:43]
    v_mfma_f32_16x16x32_bf16 v[44:47], a[200:203], v[108:111], v[44:47]
    v_mfma_f32_16x16x32_bf16 v[48:51], a[204:207], v[96:99], v[48:51]
    ds_read_b128 v[120:123], v215 offset:38912
    v_mfma_f32_16x16x32_bf16 v[52:55], a[204:207], v[100:103], v[52:55]
    v_mfma_f32_16x16x32_bf16 v[56:59], a[204:207], v[104:107], v[56:59]
    s_add_u32 s81, s30, 94208
    buffer_load_dwordx4 a[68:71], v212, s[16:19], s81 offen offset:0
    v_mfma_f32_16x16x32_bf16 v[60:63], a[204:207], v[108:111], v[60:63]
    v_mfma_f32_16x16x32_bf16 v[64:67], a[208:211], v[96:99], v[64:67]
    buffer_load_dwordx4 a[72:75], v212, s[16:19], s76 offen offset:1024
    v_mfma_f32_16x16x32_bf16 v[68:71], a[208:211], v[100:103], v[68:71]
    v_mfma_f32_16x16x32_bf16 v[72:75], a[208:211], v[104:107], v[72:75]
    v_mfma_f32_16x16x32_bf16 v[76:79], a[208:211], v[108:111], v[76:79]
    ds_read_b128 v[124:127], v215 offset:39936
    v_mfma_f32_16x16x32_bf16 v[80:83], a[212:215], v[96:99], v[80:83]
    v_mfma_f32_16x16x32_bf16 v[84:87], a[212:215], v[100:103], v[84:87]
    buffer_load_dwordx4 a[76:79], v212, s[16:19], s77 offen offset:1024
    v_mfma_f32_16x16x32_bf16 v[88:91], a[212:215], v[104:107], v[88:91]
    v_mfma_f32_16x16x32_bf16 v[92:95], a[212:215], v[108:111], v[92:95]
    s_waitcnt vmcnt(20)
    s_waitcnt lgkmcnt(0)
    v_mfma_f32_16x16x32_bf16 v[0:3], a[216:219], v[112:115], v[0:3]
    ds_read_b128 v[96:99], v214 offset:40960
    buffer_load_dwordx4 a[80:83], v212, s[16:19], s78 offen offset:1024
    v_mfma_f32_16x16x32_bf16 v[4:7], a[216:219], v[116:119], v[4:7]
    ds_read_b128 v[100:103], v214 offset:41984
    v_mfma_f32_16x16x32_bf16 v[8:11], a[216:219], v[120:123], v[8:11]
    ds_read_b128 v[104:107], v214 offset:43008
    ds_read_b128 v[108:111], v214 offset:44032
    v_mfma_f32_16x16x32_bf16 v[12:15], a[216:219], v[124:127], v[12:15]
    v_mov_b32_dpp v128, v232 row_newbcast:0 row_mask:0xf bank_mask:0xf
    v_mfma_f32_16x16x32_bf16 v[16:19], a[220:223], v[112:115], v[16:19]
    buffer_load_dwordx4 a[84:87], v212, s[16:19], s79 offen offset:1024
    v_mov_b32_dpp v129, v232 row_newbcast:1 row_mask:0xf bank_mask:0xf
    v_mfma_f32_16x16x32_bf16 v[20:23], a[220:223], v[116:119], v[20:23]
    v_mov_b32_dpp v130, v232 row_newbcast:2 row_mask:0xf bank_mask:0xf
    v_mfma_f32_16x16x32_bf16 v[24:27], a[220:223], v[120:123], v[24:27]
    v_mov_b32_dpp v131, v232 row_newbcast:3 row_mask:0xf bank_mask:0xf
    v_mfma_f32_16x16x32_bf16 v[28:31], a[220:223], v[124:127], v[28:31]
    v_mov_b32_dpp v132, v232 row_newbcast:4 row_mask:0xf bank_mask:0xf
    v_mov_b32_dpp v133, v232 row_newbcast:5 row_mask:0xf bank_mask:0xf
    v_mfma_f32_16x16x32_bf16 v[32:35], a[224:227], v[112:115], v[32:35]
    buffer_load_dwordx4 a[88:91], v212, s[16:19], s80 offen offset:1024
    v_mfma_f32_16x16x32_bf16 v[36:39], a[224:227], v[116:119], v[36:39]
    v_mov_b32_dpp v134, v232 row_newbcast:6 row_mask:0xf bank_mask:0xf
    v_mov_b32_dpp v135, v232 row_newbcast:7 row_mask:0xf bank_mask:0xf
    v_mfma_f32_16x16x32_bf16 v[40:43], a[224:227], v[120:123], v[40:43]
    v_mov_b32_dpp v136, v232 row_newbcast:8 row_mask:0xf bank_mask:0xf
    v_mfma_f32_16x16x32_bf16 v[44:47], a[224:227], v[124:127], v[44:47]
    v_mov_b32_dpp v137, v232 row_newbcast:9 row_mask:0xf bank_mask:0xf
    v_mfma_f32_16x16x32_bf16 v[48:51], a[228:231], v[112:115], v[48:51]
    v_mov_b32_dpp v138, v232 row_newbcast:10 row_mask:0xf bank_mask:0xf
    buffer_load_dwordx4 a[92:95], v212, s[16:19], s81 offen offset:1024
    v_mfma_f32_16x16x32_bf16 v[52:55], a[228:231], v[116:119], v[52:55]
    v_mov_b32_dpp v139, v232 row_newbcast:11 row_mask:0xf bank_mask:0xf
    v_mfma_f32_16x16x32_bf16 v[56:59], a[228:231], v[120:123], v[56:59]
    v_mov_b32_dpp v140, v232 row_newbcast:12 row_mask:0xf bank_mask:0xf
    v_mov_b32_dpp v141, v232 row_newbcast:13 row_mask:0xf bank_mask:0xf
    v_mfma_f32_16x16x32_bf16 v[60:63], a[228:231], v[124:127], v[60:63]
    v_mov_b32_dpp v142, v232 row_newbcast:14 row_mask:0xf bank_mask:0xf
    v_mfma_f32_16x16x32_bf16 v[64:67], a[232:235], v[112:115], v[64:67]
    buffer_load_dwordx4 a[96:99], v212, s[16:19], s76 offen offset:2048
    v_mov_b32_dpp v143, v232 row_newbcast:15 row_mask:0xf bank_mask:0xf
    v_mfma_f32_16x16x32_bf16 v[68:71], a[232:235], v[116:119], v[68:71]
    v_mov_b32_dpp v144, v233 row_newbcast:0 row_mask:0xf bank_mask:0xf
    v_mfma_f32_16x16x32_bf16 v[72:75], a[232:235], v[120:123], v[72:75]
    v_mov_b32_dpp v145, v233 row_newbcast:1 row_mask:0xf bank_mask:0xf
    v_mfma_f32_16x16x32_bf16 v[76:79], a[232:235], v[124:127], v[76:79]
    v_mov_b32_dpp v146, v233 row_newbcast:2 row_mask:0xf bank_mask:0xf
    v_mov_b32_dpp v147, v233 row_newbcast:3 row_mask:0xf bank_mask:0xf
    v_mfma_f32_16x16x32_bf16 v[80:83], a[236:239], v[112:115], v[80:83]
    buffer_load_dwordx4 a[100:103], v212, s[16:19], s77 offen offset:2048
    v_mfma_f32_16x16x32_bf16 v[84:87], a[236:239], v[116:119], v[84:87]
    v_mov_b32_dpp v148, v233 row_newbcast:4 row_mask:0xf bank_mask:0xf
    v_mov_b32_dpp v149, v233 row_newbcast:5 row_mask:0xf bank_mask:0xf
    v_mfma_f32_16x16x32_bf16 v[88:91], a[236:239], v[120:123], v[88:91]
    v_mov_b32_dpp v150, v233 row_newbcast:6 row_mask:0xf bank_mask:0xf
    v_mfma_f32_16x16x32_bf16 v[92:95], a[236:239], v[124:127], v[92:95]
    v_mov_b32_dpp v151, v233 row_newbcast:7 row_mask:0xf bank_mask:0xf
    s_waitcnt vmcnt(20)
    s_waitcnt lgkmcnt(0)
    v_mfma_f32_16x16x32_bf16 v[0:3], a[0:3], v[96:99], v[0:3]
    ds_read_b128 v[112:115], v215 offset:45056
    buffer_load_dwordx4 a[104:107], v212, s[16:19], s78 offen offset:2048
    v_mfma_f32_16x16x32_bf16 v[4:7], a[0:3], v[100:103], v[4:7]
    ds_read_b128 v[116:119], v215 offset:46080
    v_mfma_f32_16x16x32_bf16 v[8:11], a[0:3], v[104:107], v[8:11]
    ds_read_b128 v[120:123], v215 offset:47104
    ds_read_b128 v[124:127], v215 offset:48128
    v_mfma_f32_16x16x32_bf16 v[12:15], a[0:3], v[108:111], v[12:15]
    v_mov_b32_dpp v152, v233 row_newbcast:8 row_mask:0xf bank_mask:0xf
    v_mfma_f32_16x16x32_bf16 v[16:19], a[4:7], v[96:99], v[16:19]
    buffer_load_dwordx4 a[108:111], v212, s[16:19], s79 offen offset:2048
    v_mov_b32_dpp v153, v233 row_newbcast:9 row_mask:0xf bank_mask:0xf
    v_mfma_f32_16x16x32_bf16 v[20:23], a[4:7], v[100:103], v[20:23]
    v_mov_b32_dpp v154, v233 row_newbcast:10 row_mask:0xf bank_mask:0xf
    v_mfma_f32_16x16x32_bf16 v[24:27], a[4:7], v[104:107], v[24:27]
    v_mov_b32_dpp v155, v233 row_newbcast:11 row_mask:0xf bank_mask:0xf
    v_mfma_f32_16x16x32_bf16 v[28:31], a[4:7], v[108:111], v[28:31]
    v_mov_b32_dpp v156, v233 row_newbcast:12 row_mask:0xf bank_mask:0xf
    v_mov_b32_dpp v157, v233 row_newbcast:13 row_mask:0xf bank_mask:0xf
    v_mfma_f32_16x16x32_bf16 v[32:35], a[8:11], v[96:99], v[32:35]
    buffer_load_dwordx4 a[112:115], v212, s[16:19], s80 offen offset:2048
    v_mfma_f32_16x16x32_bf16 v[36:39], a[8:11], v[100:103], v[36:39]
    v_mov_b32_dpp v158, v233 row_newbcast:14 row_mask:0xf bank_mask:0xf
    v_mov_b32_dpp v159, v233 row_newbcast:15 row_mask:0xf bank_mask:0xf
    v_mfma_f32_16x16x32_bf16 v[40:43], a[8:11], v[104:107], v[40:43]
    v_mov_b32_dpp v160, v234 row_newbcast:0 row_mask:0xf bank_mask:0xf
    v_mfma_f32_16x16x32_bf16 v[44:47], a[8:11], v[108:111], v[44:47]
    v_mov_b32_dpp v161, v234 row_newbcast:1 row_mask:0xf bank_mask:0xf
    v_mfma_f32_16x16x32_bf16 v[48:51], a[12:15], v[96:99], v[48:51]
    v_mov_b32_dpp v162, v234 row_newbcast:2 row_mask:0xf bank_mask:0xf
    buffer_load_dwordx4 a[116:119], v212, s[16:19], s81 offen offset:2048
    v_mfma_f32_16x16x32_bf16 v[52:55], a[12:15], v[100:103], v[52:55]
    v_mov_b32_dpp v163, v234 row_newbcast:3 row_mask:0xf bank_mask:0xf
    v_mfma_f32_16x16x32_bf16 v[56:59], a[12:15], v[104:107], v[56:59]
    v_mov_b32_dpp v164, v234 row_newbcast:4 row_mask:0xf bank_mask:0xf
    v_mov_b32_dpp v165, v234 row_newbcast:5 row_mask:0xf bank_mask:0xf
    v_mfma_f32_16x16x32_bf16 v[60:63], a[12:15], v[108:111], v[60:63]
    v_mov_b32_dpp v166, v234 row_newbcast:6 row_mask:0xf bank_mask:0xf
    v_mfma_f32_16x16x32_bf16 v[64:67], a[16:19], v[96:99], v[64:67]
    buffer_load_dwordx4 a[120:123], v212, s[16:19], s76 offen offset:3072
    v_mov_b32_dpp v167, v234 row_newbcast:7 row_mask:0xf bank_mask:0xf
    v_mfma_f32_16x16x32_bf16 v[68:71], a[16:19], v[100:103], v[68:71]
    v_mov_b32_dpp v168, v234 row_newbcast:8 row_mask:0xf bank_mask:0xf
    v_mfma_f32_16x16x32_bf16 v[72:75], a[16:19], v[104:107], v[72:75]
    v_mov_b32_dpp v169, v234 row_newbcast:9 row_mask:0xf bank_mask:0xf
    v_mfma_f32_16x16x32_bf16 v[76:79], a[16:19], v[108:111], v[76:79]
    v_mov_b32_dpp v170, v234 row_newbcast:10 row_mask:0xf bank_mask:0xf
    v_mov_b32_dpp v171, v234 row_newbcast:11 row_mask:0xf bank_mask:0xf
    v_mfma_f32_16x16x32_bf16 v[80:83], a[20:23], v[96:99], v[80:83]
    buffer_load_dwordx4 a[124:127], v212, s[16:19], s77 offen offset:3072
    v_mfma_f32_16x16x32_bf16 v[84:87], a[20:23], v[100:103], v[84:87]
    v_mov_b32_dpp v172, v234 row_newbcast:12 row_mask:0xf bank_mask:0xf
    v_mov_b32_dpp v173, v234 row_newbcast:13 row_mask:0xf bank_mask:0xf
    v_mfma_f32_16x16x32_bf16 v[88:91], a[20:23], v[104:107], v[88:91]
    v_mov_b32_dpp v174, v234 row_newbcast:14 row_mask:0xf bank_mask:0xf
    v_mfma_f32_16x16x32_bf16 v[92:95], a[20:23], v[108:111], v[92:95]
    v_mov_b32_dpp v175, v234 row_newbcast:15 row_mask:0xf bank_mask:0xf
    s_waitcnt vmcnt(20)
    s_waitcnt lgkmcnt(0)
    v_mfma_f32_16x16x32_bf16 v[0:3], a[24:27], v[112:115], v[0:3]
    ds_read_b128 v[96:99], v214 offset:49152
    v_mfma_f32_16x16x32_bf16 v[4:7], a[24:27], v[116:119], v[4:7]
    buffer_load_dwordx4 a[128:131], v212, s[16:19], s78 offen offset:3072
    v_mfma_f32_16x16x32_bf16 v[8:11], a[24:27], v[120:123], v[8:11]
    v_mfma_f32_16x16x32_bf16 v[12:15], a[24:27], v[124:127], v[12:15]
    ds_read_b128 v[100:103], v214 offset:50176
    v_mfma_f32_16x16x32_bf16 v[16:19], a[28:31], v[112:115], v[16:19]
    buffer_load_dwordx4 a[132:135], v212, s[16:19], s79 offen offset:3072
    v_mfma_f32_16x16x32_bf16 v[20:23], a[28:31], v[116:119], v[20:23]
    v_mfma_f32_16x16x32_bf16 v[24:27], a[28:31], v[120:123], v[24:27]
    ds_read_b128 v[104:107], v214 offset:51200
    v_mfma_f32_16x16x32_bf16 v[28:31], a[28:31], v[124:127], v[28:31]
    ds_read_b128 v[108:111], v214 offset:52224
    v_mfma_f32_16x16x32_bf16 v[32:35], a[32:35], v[112:115], v[32:35]
    v_mfma_f32_16x16x32_bf16 v[36:39], a[32:35], v[116:119], v[36:39]
    buffer_load_dwordx4 a[136:139], v212, s[16:19], s80 offen offset:3072
    v_mfma_f32_16x16x32_bf16 v[40:43], a[32:35], v[120:123], v[40:43]
    v_lshlrev_b32 v218, 2, v209
    v_mfma_f32_16x16x32_bf16 v[44:47], a[32:35], v[124:127], v[44:47]
    v_mfma_f32_16x16x32_bf16 v[48:51], a[36:39], v[112:115], v[48:51]
    v_add_u32 v218, 65536, v218
    v_mfma_f32_16x16x32_bf16 v[52:55], a[36:39], v[116:119], v[52:55]
    buffer_load_dwordx4 a[140:143], v212, s[16:19], s81 offen offset:3072
    v_mfma_f32_16x16x32_bf16 v[56:59], a[36:39], v[120:123], v[56:59]
    v_mfma_f32_16x16x32_bf16 v[60:63], a[36:39], v[124:127], v[60:63]
    ds_read2_b32 v[224:225], v218 offset0:0 offset1:64
    v_mfma_f32_16x16x32_bf16 v[64:67], a[40:43], v[112:115], v[64:67]
    s_add_u32 s31, s28, s64
    buffer_load_dwordx4 a[240:243], v212, s[48:51], s31 offen offset:0
    v_mfma_f32_16x16x32_bf16 v[68:71], a[40:43], v[116:119], v[68:71]
    v_mfma_f32_16x16x32_bf16 v[72:75], a[40:43], v[120:123], v[72:75]
    ds_read2_b32 v[226:227], v218 offset0:16 offset1:80
    v_mfma_f32_16x16x32_bf16 v[76:79], a[40:43], v[124:127], v[76:79]
    ds_read2_b32 v[228:229], v218 offset0:32 offset1:96
    v_mfma_f32_16x16x32_bf16 v[80:83], a[44:47], v[112:115], v[80:83]
    v_mfma_f32_16x16x32_bf16 v[84:87], a[44:47], v[116:119], v[84:87]
    buffer_load_dwordx4 a[244:247], v212, s[48:51], s31 offen offset:1024
    v_mfma_f32_16x16x32_bf16 v[88:91], a[44:47], v[120:123], v[88:91]
    ds_read2_b32 v[230:231], v218 offset0:48 offset1:112
    v_mfma_f32_16x16x32_bf16 v[92:95], a[44:47], v[124:127], v[92:95]
    s_waitcnt vmcnt(20)
    s_waitcnt lgkmcnt(4)
    v_mfma_f32_16x16x32_bf16 v[0:3], a[48:51], v[96:99], v[0:3]
    buffer_load_dwordx4 a[248:251], v212, s[48:51], s31 offen offset:2048
    v_mfma_f32_16x16x32_bf16 v[4:7], a[48:51], v[100:103], v[4:7]
    v_mfma_f32_16x16x32_bf16 v[8:11], a[48:51], v[104:107], v[8:11]
    v_mfma_f32_16x16x32_bf16 v[12:15], a[48:51], v[108:111], v[12:15]
    v_mfma_f32_16x16x32_bf16 v[16:19], a[52:55], v[96:99], v[16:19]
    buffer_load_dwordx4 a[252:255], v212, s[48:51], s31 offen offset:3072
    v_mfma_f32_16x16x32_bf16 v[20:23], a[52:55], v[100:103], v[20:23]
    v_mfma_f32_16x16x32_bf16 v[24:27], a[52:55], v[104:107], v[24:27]
    v_mfma_f32_16x16x32_bf16 v[28:31], a[52:55], v[108:111], v[28:31]
    v_mfma_f32_16x16x32_bf16 v[32:35], a[56:59], v[96:99], v[32:35]
    s_add_u32 s31, s28, s65
    buffer_load_dwordx4 a[144:147], v212, s[48:51], s31 offen offset:0
    v_mfma_f32_16x16x32_bf16 v[36:39], a[56:59], v[100:103], v[36:39]
    v_mfma_f32_16x16x32_bf16 v[40:43], a[56:59], v[104:107], v[40:43]
    v_mfma_f32_16x16x32_bf16 v[44:47], a[56:59], v[108:111], v[44:47]
    v_mfma_f32_16x16x32_bf16 v[48:51], a[60:63], v[96:99], v[48:51]
    buffer_load_dwordx4 a[148:151], v212, s[48:51], s31 offen offset:1024
    v_mfma_f32_16x16x32_bf16 v[52:55], a[60:63], v[100:103], v[52:55]
    v_mfma_f32_16x16x32_bf16 v[56:59], a[60:63], v[104:107], v[56:59]
    v_mfma_f32_16x16x32_bf16 v[60:63], a[60:63], v[108:111], v[60:63]
    v_mfma_f32_16x16x32_bf16 v[64:67], a[64:67], v[96:99], v[64:67]
    buffer_load_dwordx4 a[152:155], v212, s[48:51], s31 offen offset:2048
    v_mfma_f32_16x16x32_bf16 v[68:71], a[64:67], v[100:103], v[68:71]
    v_mfma_f32_16x16x32_bf16 v[72:75], a[64:67], v[104:107], v[72:75]
    v_mfma_f32_16x16x32_bf16 v[76:79], a[64:67], v[108:111], v[76:79]
    v_mfma_f32_16x16x32_bf16 v[80:83], a[68:71], v[96:99], v[80:83]
    buffer_load_dwordx4 a[156:159], v212, s[48:51], s31 offen offset:3072
    v_mfma_f32_16x16x32_bf16 v[84:87], a[68:71], v[100:103], v[84:87]
    v_mfma_f32_16x16x32_bf16 v[88:91], a[68:71], v[104:107], v[88:91]
    v_mfma_f32_16x16x32_bf16 v[92:95], a[68:71], v[108:111], v[92:95]
    ds_read_b128 v[96:99], v215 offset:53248
    ds_read_b128 v[100:103], v215 offset:54272
    ds_read_b128 v[104:107], v215 offset:55296
    ds_read_b128 v[108:111], v215 offset:56320
    ds_read_b128 v[112:115], v214 offset:57344
    ds_read_b128 v[116:119], v214 offset:58368
    ds_read_b128 v[120:123], v214 offset:59392
    ds_read_b128 v[124:127], v214 offset:60416
    ds_read_b128 v[176:179], v215 offset:61440
    ds_read_b128 v[180:183], v215 offset:62464
    ds_read_b128 v[184:187], v215 offset:63488
    s_waitcnt lgkmcnt(14)
    ds_read_b128 v[188:191], v215 offset:64512
    s_waitcnt vmcnt(8)
    s_waitcnt lgkmcnt(12)
    s_waitcnt lgkmcnt(8)
    v_mfma_f32_16x16x32_bf16 v[0:3], a[72:75], v[96:99], v[0:3]
    s_add_u32 s31, s28, s66
    buffer_load_dwordx4 a[160:163], v212, s[48:51], s31 offen offset:0
    v_mfma_f32_16x16x32_bf16 v[16:19], a[76:79], v[96:99], v[16:19]
    v_mfma_f32_16x16x32_bf16 v[4:7], a[72:75], v[100:103], v[4:7]
    v_mfma_f32_16x16x32_bf16 v[20:23], a[76:79], v[100:103], v[20:23]
    v_mfma_f32_16x16x32_bf16 v[8:11], a[72:75], v[104:107], v[8:11]
    v_mfma_f32_16x16x32_bf16 v[24:27], a[76:79], v[104:107], v[24:27]
    v_mfma_f32_16x16x32_bf16 v[12:15], a[72:75], v[108:111], v[12:15]
    buffer_load_dwordx4 a[164:167], v212, s[48:51], s31 offen offset:1024
    v_mfma_f32_16x16x32_bf16 v[28:31], a[76:79], v[108:111], v[28:31]
    s_waitcnt lgkmcnt(4)
    v_mfma_f32_16x16x32_bf16 v[0:3], a[96:99], v[112:115], v[0:3]
    v_mfma_f32_16x16x32_bf16 v[16:19], a[100:103], v[112:115], v[16:19]
    v_mfma_f32_16x16x32_bf16 v[4:7], a[96:99], v[116:119], v[4:7]
    v_mfma_f32_16x16x32_bf16 v[20:23], a[100:103], v[116:119], v[20:23]
    v_mfma_f32_16x16x32_bf16 v[8:11], a[96:99], v[120:123], v[8:11]
    buffer_load_dwordx4 a[168:171], v212, s[48:51], s31 offen offset:2048
    v_mfma_f32_16x16x32_bf16 v[24:27], a[100:103], v[120:123], v[24:27]
    v_mfma_f32_16x16x32_bf16 v[12:15], a[96:99], v[124:127], v[12:15]
    v_mfma_f32_16x16x32_bf16 v[28:31], a[100:103], v[124:127], v[28:31]
    s_waitcnt lgkmcnt(0)
    v_mfma_f32_16x16x32_bf16 v[0:3], a[120:123], v[176:179], v[0:3]
    v_mfma_f32_16x16x32_bf16 v[16:19], a[124:127], v[176:179], v[16:19]
    v_mfma_f32_16x16x32_bf16 v[4:7], a[120:123], v[180:183], v[4:7]
    buffer_load_dwordx4 a[172:175], v212, s[48:51], s31 offen offset:3072
    v_mfma_f32_16x16x32_bf16 v[20:23], a[124:127], v[180:183], v[20:23]
    v_mfma_f32_16x16x32_bf16 v[8:11], a[120:123], v[184:187], v[8:11]
    v_mfma_f32_16x16x32_bf16 v[24:27], a[124:127], v[184:187], v[24:27]
    v_mfma_f32_16x16x32_bf16 v[12:15], a[120:123], v[188:191], v[12:15]
    v_mfma_f32_16x16x32_bf16 v[28:31], a[124:127], v[188:191], v[28:31]
    v_mfma_f32_16x16x32_bf16 v[32:35], a[80:83], v[96:99], v[32:35]
    s_add_u32 s31, s28, s67
    buffer_load_dwordx4 a[176:179], v212, s[48:51], s31 offen offset:0
    v_mfma_f32_16x16x32_bf16 v[48:51], a[84:87], v[96:99], v[48:51]
    v_fma_f32 v0, -v128, v224, v0
    v_fma_f32 v1, -v129, v224, v1
    v_mfma_f32_16x16x32_bf16 v[36:39], a[80:83], v[100:103], v[36:39]
    v_fma_f32 v0, v0, v225, v132
    v_fma_f32 v1, v1, v225, v133
    v_mfma_f32_16x16x32_bf16 v[52:55], a[84:87], v[100:103], v[52:55]
    v_fma_f32 v2, -v130, v224, v2
    v_fma_f32 v3, -v131, v224, v3
    v_mfma_f32_16x16x32_bf16 v[40:43], a[80:83], v[104:107], v[40:43]
    v_fma_f32 v2, v2, v225, v134
    v_fma_f32 v3, v3, v225, v135
    v_mfma_f32_16x16x32_bf16 v[56:59], a[84:87], v[104:107], v[56:59]
    v_fma_f32 v16, -v136, v224, v16
    v_fma_f32 v17, -v137, v224, v17
    v_mfma_f32_16x16x32_bf16 v[44:47], a[80:83], v[108:111], v[44:47]
    v_fma_f32 v16, v16, v225, v140
    v_fma_f32 v17, v17, v225, v141
    v_mfma_f32_16x16x32_bf16 v[60:63], a[84:87], v[108:111], v[60:63]
    v_fma_f32 v18, -v138, v224, v18
    v_fma_f32 v19, -v139, v224, v19
    v_mfma_f32_16x16x32_bf16 v[32:35], a[104:107], v[112:115], v[32:35]
    v_fma_f32 v18, v18, v225, v142
    buffer_load_dwordx4 a[180:183], v212, s[48:51], s31 offen offset:1024
    v_fma_f32 v19, v19, v225, v143
    v_mfma_f32_16x16x32_bf16 v[48:51], a[108:111], v[112:115], v[48:51]
    v_mul_f32 v0, v0, v16
    v_mul_f32 v1, v1, v17
    v_mfma_f32_16x16x32_bf16 v[36:39], a[104:107], v[116:119], v[36:39]
    v_mul_f32 v2, v2, v18
    v_mul_f32 v3, v3, v19
    v_mfma_f32_16x16x32_bf16 v[52:55], a[108:111], v[116:119], v[52:55]
    v_cvt_pk_bf16_f32 v16, v0, v1
    v_cvt_pk_bf16_f32 v17, v2, v3
    v_mfma_f32_16x16x32_bf16 v[40:43], a[104:107], v[120:123], v[40:43]
    v_fma_f32 v4, -v128, v226, v4
    v_fma_f32 v5, -v129, v226, v5
    v_mfma_f32_16x16x32_bf16 v[56:59], a[108:111], v[120:123], v[56:59]
    v_fma_f32 v4, v4, v227, v132
    v_fma_f32 v5, v5, v227, v133
    v_mfma_f32_16x16x32_bf16 v[44:47], a[104:107], v[124:127], v[44:47]
    v_fma_f32 v6, -v130, v226, v6
    v_fma_f32 v7, -v131, v226, v7
    v_mfma_f32_16x16x32_bf16 v[60:63], a[108:111], v[124:127], v[60:63]
    v_fma_f32 v6, v6, v227, v134
    v_fma_f32 v7, v7, v227, v135
    v_mfma_f32_16x16x32_bf16 v[32:35], a[128:131], v[176:179], v[32:35]
    v_fma_f32 v20, -v136, v226, v20
    buffer_load_dwordx4 a[184:187], v212, s[48:51], s31 offen offset:2048
    v_fma_f32 v21, -v137, v226, v21
    v_mfma_f32_16x16x32_bf16 v[48:51], a[132:135], v[176:179], v[48:51]
    v_fma_f32 v20, v20, v227, v140
    v_fma_f32 v21, v21, v227, v141
    v_mfma_f32_16x16x32_bf16 v[36:39], a[128:131], v[180:183], v[36:39]
    v_fma_f32 v22, -v138, v226, v22
    v_fma_f32 v23, -v139, v226, v23
    v_mfma_f32_16x16x32_bf16 v[52:55], a[132:135], v[180:183], v[52:55]
    v_fma_f32 v22, v22, v227, v142
    v_fma_f32 v23, v23, v227, v143
    v_mfma_f32_16x16x32_bf16 v[40:43], a[128:131], v[184:187], v[40:43]
    v_mul_f32 v4, v4, v20
    v_mul_f32 v5, v5, v21
    v_mfma_f32_16x16x32_bf16 v[56:59], a[132:135], v[184:187], v[56:59]
    v_mul_f32 v6, v6, v22
    v_mul_f32 v7, v7, v23
    v_mfma_f32_16x16x32_bf16 v[44:47], a[128:131], v[188:191], v[44:47]
    v_cvt_pk_bf16_f32 v18, v4, v5
    v_cvt_pk_bf16_f32 v19, v6, v7
    v_mfma_f32_16x16x32_bf16 v[60:63], a[132:135], v[188:191], v[60:63]
    buffer_store_dwordx4 v[16:19], v212, s[8:11], s41 offen offset:0 sc1
    v_pk_fma_f32 v[8:9], v[128:129], v[228:229], v[8:9] op_sel:[0,0,0] op_sel_hi:[1,0,1] neg_lo:[1,0,0] neg_hi:[1,0,0]
    v_pk_fma_f32 v[8:9], v[8:9], v[228:229], v[132:133] op_sel:[0,1,0] op_sel_hi:[1,1,1]
    buffer_load_dwordx4 a[188:191], v212, s[48:51], s31 offen offset:3072
    v_pk_fma_f32 v[10:11], v[130:131], v[228:229], v[10:11] op_sel:[0,0,0] op_sel_hi:[1,0,1] neg_lo:[1,0,0] neg_hi:[1,0,0]
    v_pk_fma_f32 v[10:11], v[10:11], v[228:229], v[134:135] op_sel:[0,1,0] op_sel_hi:[1,1,1]
    v_pk_fma_f32 v[24:25], v[136:137], v[228:229], v[24:25] op_sel:[0,0,0] op_sel_hi:[1,0,1] neg_lo:[1,0,0] neg_hi:[1,0,0]
    v_pk_fma_f32 v[24:25], v[24:25], v[228:229], v[140:141] op_sel:[0,1,0] op_sel_hi:[1,1,1]
    v_pk_fma_f32 v[26:27], v[138:139], v[228:229], v[26:27] op_sel:[0,0,0] op_sel_hi:[1,0,1] neg_lo:[1,0,0] neg_hi:[1,0,0]
    v_pk_fma_f32 v[26:27], v[26:27], v[228:229], v[142:143] op_sel:[0,1,0] op_sel_hi:[1,1,1]
    v_pk_mul_f32 v[8:9], v[8:9], v[24:25]
    v_pk_mul_f32 v[10:11], v[10:11], v[26:27]
    v_cvt_pk_bf16_f32 v24, v8, v9
    v_cvt_pk_bf16_f32 v25, v10, v11
    v_pk_fma_f32 v[12:13], v[128:129], v[230:231], v[12:13] op_sel:[0,0,0] op_sel_hi:[1,0,1] neg_lo:[1,0,0] neg_hi:[1,0,0]
    v_pk_fma_f32 v[12:13], v[12:13], v[230:231], v[132:133] op_sel:[0,1,0] op_sel_hi:[1,1,1]
    v_pk_fma_f32 v[14:15], v[130:131], v[230:231], v[14:15] op_sel:[0,0,0] op_sel_hi:[1,0,1] neg_lo:[1,0,0] neg_hi:[1,0,0]
    v_pk_fma_f32 v[14:15], v[14:15], v[230:231], v[134:135] op_sel:[0,1,0] op_sel_hi:[1,1,1]
    v_pk_fma_f32 v[28:29], v[136:137], v[230:231], v[28:29] op_sel:[0,0,0] op_sel_hi:[1,0,1] neg_lo:[1,0,0] neg_hi:[1,0,0]
    v_pk_fma_f32 v[28:29], v[28:29], v[230:231], v[140:141] op_sel:[0,1,0] op_sel_hi:[1,1,1]
    v_pk_fma_f32 v[30:31], v[138:139], v[230:231], v[30:31] op_sel:[0,0,0] op_sel_hi:[1,0,1] neg_lo:[1,0,0] neg_hi:[1,0,0]
    v_pk_fma_f32 v[30:31], v[30:31], v[230:231], v[142:143] op_sel:[0,1,0] op_sel_hi:[1,1,1]
    v_pk_mul_f32 v[12:13], v[12:13], v[28:29]
    v_pk_mul_f32 v[14:15], v[14:15], v[30:31]
    v_cvt_pk_bf16_f32 v26, v12, v13
    v_cvt_pk_bf16_f32 v27, v14, v15
    buffer_store_dwordx4 v[24:27], v212, s[8:11], s41 offen offset:1024 sc1
    v_mfma_f32_16x16x32_bf16 v[64:67], a[88:91], v[96:99], v[64:67]
    s_add_u32 s31, s28, s68
    buffer_load_dwordx4 a[192:195], v212, s[48:51], s31 offen offset:0
    v_mfma_f32_16x16x32_bf16 v[80:83], a[92:95], v[96:99], v[80:83]
    v_fma_f32 v32, -v144, v224, v32
    v_fma_f32 v33, -v145, v224, v33
    v_mfma_f32_16x16x32_bf16 v[68:71], a[88:91], v[100:103], v[68:71]
    v_fma_f32 v32, v32, v225, v148
    v_fma_f32 v33, v33, v225, v149
    v_mfma_f32_16x16x32_bf16 v[84:87], a[92:95], v[100:103], v[84:87]
    v_fma_f32 v34, -v146, v224, v34
    v_fma_f32 v35, -v147, v224, v35
    v_mfma_f32_16x16x32_bf16 v[72:75], a[88:91], v[104:107], v[72:75]
    v_fma_f32 v34, v34, v225, v150
    v_fma_f32 v35, v35, v225, v151
    v_mfma_f32_16x16x32_bf16 v[88:91], a[92:95], v[104:107], v[88:91]
    v_fma_f32 v48, -v152, v224, v48
    v_fma_f32 v49, -v153, v224, v49
    v_mfma_f32_16x16x32_bf16 v[76:79], a[88:91], v[108:111], v[76:79]
    v_fma_f32 v48, v48, v225, v156
    v_fma_f32 v49, v49, v225, v157
    v_mfma_f32_16x16x32_bf16 v[92:95], a[92:95], v[108:111], v[92:95]
    v_fma_f32 v50, -v154, v224, v50
    v_fma_f32 v51, -v155, v224, v51
    v_mfma_f32_16x16x32_bf16 v[64:67], a[112:115], v[112:115], v[64:67]
    v_fma_f32 v50, v50, v225, v158
    buffer_load_dwordx4 a[196:199], v212, s[48:51], s31 offen offset:1024
    v_fma_f32 v51, v51, v225, v159
    v_mfma_f32_16x16x32_bf16 v[80:83], a[116:119], v[112:115], v[80:83]
    v_mul_f32 v32, v32, v48
    v_mul_f32 v33, v33, v49
    v_mfma_f32_16x16x32_bf16 v[68:71], a[112:115], v[116:119], v[68:71]
    v_mul_f32 v34, v34, v50
    v_mul_f32 v35, v35, v51
    v_mfma_f32_16x16x32_bf16 v[84:87], a[116:119], v[116:119], v[84:87]
    v_cvt_pk_bf16_f32 v48, v32, v33
    v_cvt_pk_bf16_f32 v49, v34, v35
    v_mfma_f32_16x16x32_bf16 v[72:75], a[112:115], v[120:123], v[72:75]
    v_fma_f32 v36, -v144, v226, v36
    v_fma_f32 v37, -v145, v226, v37
    v_mfma_f32_16x16x32_bf16 v[88:91], a[116:119], v[120:123], v[88:91]
    v_fma_f32 v36, v36, v227, v148
    v_fma_f32 v37, v37, v227, v149
    v_mfma_f32_16x16x32_bf16 v[76:79], a[112:115], v[124:127], v[76:79]
    v_fma_f32 v38, -v146, v226, v38
    v_fma_f32 v39, -v147, v226, v39
    v_mfma_f32_16x16x32_bf16 v[92:95], a[116:119], v[124:127], v[92:95]
    v_fma_f32 v38, v38, v227, v150
    v_fma_f32 v39, v39, v227, v151
    v_mfma_f32_16x16x32_bf16 v[64:67], a[136:139], v[176:179], v[64:67]
    v_fma_f32 v52, -v152, v226, v52
    buffer_load_dwordx4 a[200:203], v212, s[48:51], s31 offen offset:2048
    v_fma_f32 v53, -v153, v226, v53
    v_mfma_f32_16x16x32_bf16 v[80:83], a[140:143], v[176:179], v[80:83]
    v_fma_f32 v52, v52, v227, v156
    v_fma_f32 v53, v53, v227, v157
    v_mfma_f32_16x16x32_bf16 v[68:71], a[136:139], v[180:183], v[68:71]
    v_fma_f32 v54, -v154, v226, v54
    v_fma_f32 v55, -v155, v226, v55
    v_mfma_f32_16x16x32_bf16 v[84:87], a[140:143], v[180:183], v[84:87]
    v_fma_f32 v54, v54, v227, v158
    v_fma_f32 v55, v55, v227, v159
    v_mfma_f32_16x16x32_bf16 v[72:75], a[136:139], v[184:187], v[72:75]
    v_mul_f32 v36, v36, v52
    v_mul_f32 v37, v37, v53
    v_mfma_f32_16x16x32_bf16 v[88:91], a[140:143], v[184:187], v[88:91]
    v_mul_f32 v38, v38, v54
    v_mul_f32 v39, v39, v55
    v_mfma_f32_16x16x32_bf16 v[76:79], a[136:139], v[188:191], v[76:79]
    v_cvt_pk_bf16_f32 v50, v36, v37
    v_cvt_pk_bf16_f32 v51, v38, v39
    v_mfma_f32_16x16x32_bf16 v[92:95], a[140:143], v[188:191], v[92:95]
    buffer_store_dwordx4 v[48:51], v212, s[8:11], s41 offen offset:2048 sc1
    v_pk_fma_f32 v[40:41], v[144:145], v[228:229], v[40:41] op_sel:[0,0,0] op_sel_hi:[1,0,1] neg_lo:[1,0,0] neg_hi:[1,0,0]
    v_pk_fma_f32 v[40:41], v[40:41], v[228:229], v[148:149] op_sel:[0,1,0] op_sel_hi:[1,1,1]
    buffer_load_dwordx4 a[204:207], v212, s[48:51], s31 offen offset:3072
    v_pk_fma_f32 v[42:43], v[146:147], v[228:229], v[42:43] op_sel:[0,0,0] op_sel_hi:[1,0,1] neg_lo:[1,0,0] neg_hi:[1,0,0]
    v_pk_fma_f32 v[42:43], v[42:43], v[228:229], v[150:151] op_sel:[0,1,0] op_sel_hi:[1,1,1]
    v_pk_fma_f32 v[56:57], v[152:153], v[228:229], v[56:57] op_sel:[0,0,0] op_sel_hi:[1,0,1] neg_lo:[1,0,0] neg_hi:[1,0,0]
    v_pk_fma_f32 v[56:57], v[56:57], v[228:229], v[156:157] op_sel:[0,1,0] op_sel_hi:[1,1,1]
    v_pk_fma_f32 v[58:59], v[154:155], v[228:229], v[58:59] op_sel:[0,0,0] op_sel_hi:[1,0,1] neg_lo:[1,0,0] neg_hi:[1,0,0]
    v_pk_fma_f32 v[58:59], v[58:59], v[228:229], v[158:159] op_sel:[0,1,0] op_sel_hi:[1,1,1]
    v_pk_mul_f32 v[40:41], v[40:41], v[56:57]
    v_pk_mul_f32 v[42:43], v[42:43], v[58:59]
    v_cvt_pk_bf16_f32 v56, v40, v41
    v_cvt_pk_bf16_f32 v57, v42, v43
    v_pk_fma_f32 v[44:45], v[144:145], v[230:231], v[44:45] op_sel:[0,0,0] op_sel_hi:[1,0,1] neg_lo:[1,0,0] neg_hi:[1,0,0]
    v_pk_fma_f32 v[44:45], v[44:45], v[230:231], v[148:149] op_sel:[0,1,0] op_sel_hi:[1,1,1]
    v_pk_fma_f32 v[46:47], v[146:147], v[230:231], v[46:47] op_sel:[0,0,0] op_sel_hi:[1,0,1] neg_lo:[1,0,0] neg_hi:[1,0,0]
    v_pk_fma_f32 v[46:47], v[46:47], v[230:231], v[150:151] op_sel:[0,1,0] op_sel_hi:[1,1,1]
    v_pk_fma_f32 v[60:61], v[152:153], v[230:231], v[60:61] op_sel:[0,0,0] op_sel_hi:[1,0,1] neg_lo:[1,0,0] neg_hi:[1,0,0]
    v_pk_fma_f32 v[60:61], v[60:61], v[230:231], v[156:157] op_sel:[0,1,0] op_sel_hi:[1,1,1]
    v_pk_fma_f32 v[62:63], v[154:155], v[230:231], v[62:63] op_sel:[0,0,0] op_sel_hi:[1,0,1] neg_lo:[1,0,0] neg_hi:[1,0,0]
    v_pk_fma_f32 v[62:63], v[62:63], v[230:231], v[158:159] op_sel:[0,1,0] op_sel_hi:[1,1,1]
    v_pk_mul_f32 v[44:45], v[44:45], v[60:61]
    v_pk_mul_f32 v[46:47], v[46:47], v[62:63]
    v_cvt_pk_bf16_f32 v58, v44, v45
    v_cvt_pk_bf16_f32 v59, v46, v47
    buffer_store_dwordx4 v[56:59], v212, s[8:11], s41 offen offset:3072 sc1
    v_pk_fma_f32 v[64:65], v[160:161], v[224:225], v[64:65] op_sel:[0,0,0] op_sel_hi:[1,0,1] neg_lo:[1,0,0] neg_hi:[1,0,0]
    v_pk_fma_f32 v[64:65], v[64:65], v[224:225], v[164:165] op_sel:[0,1,0] op_sel_hi:[1,1,1]
    v_pk_fma_f32 v[66:67], v[162:163], v[224:225], v[66:67] op_sel:[0,0,0] op_sel_hi:[1,0,1] neg_lo:[1,0,0] neg_hi:[1,0,0]
    v_pk_fma_f32 v[66:67], v[66:67], v[224:225], v[166:167] op_sel:[0,1,0] op_sel_hi:[1,1,1]
    v_pk_fma_f32 v[80:81], v[168:169], v[224:225], v[80:81] op_sel:[0,0,0] op_sel_hi:[1,0,1] neg_lo:[1,0,0] neg_hi:[1,0,0]
    v_pk_fma_f32 v[80:81], v[80:81], v[224:225], v[172:173] op_sel:[0,1,0] op_sel_hi:[1,1,1]
    v_pk_fma_f32 v[82:83], v[170:171], v[224:225], v[82:83] op_sel:[0,0,0] op_sel_hi:[1,0,1] neg_lo:[1,0,0] neg_hi:[1,0,0]
    v_pk_fma_f32 v[82:83], v[82:83], v[224:225], v[174:175] op_sel:[0,1,0] op_sel_hi:[1,1,1]
    v_pk_mul_f32 v[64:65], v[64:65], v[80:81]
    v_pk_mul_f32 v[66:67], v[66:67], v[82:83]
    v_cvt_pk_bf16_f32 v80, v64, v65
    v_cvt_pk_bf16_f32 v81, v66, v67
    v_pk_fma_f32 v[68:69], v[160:161], v[226:227], v[68:69] op_sel:[0,0,0] op_sel_hi:[1,0,1] neg_lo:[1,0,0] neg_hi:[1,0,0]
    v_pk_fma_f32 v[68:69], v[68:69], v[226:227], v[164:165] op_sel:[0,1,0] op_sel_hi:[1,1,1]
    v_pk_fma_f32 v[70:71], v[162:163], v[226:227], v[70:71] op_sel:[0,0,0] op_sel_hi:[1,0,1] neg_lo:[1,0,0] neg_hi:[1,0,0]
    v_pk_fma_f32 v[70:71], v[70:71], v[226:227], v[166:167] op_sel:[0,1,0] op_sel_hi:[1,1,1]
    v_pk_fma_f32 v[84:85], v[168:169], v[226:227], v[84:85] op_sel:[0,0,0] op_sel_hi:[1,0,1] neg_lo:[1,0,0] neg_hi:[1,0,0]
    v_pk_fma_f32 v[84:85], v[84:85], v[226:227], v[172:173] op_sel:[0,1,0] op_sel_hi:[1,1,1]
    v_pk_fma_f32 v[86:87], v[170:171], v[226:227], v[86:87] op_sel:[0,0,0] op_sel_hi:[1,0,1] neg_lo:[1,0,0] neg_hi:[1,0,0]
    v_pk_fma_f32 v[86:87], v[86:87], v[226:227], v[174:175] op_sel:[0,1,0] op_sel_hi:[1,1,1]
    v_pk_mul_f32 v[68:69], v[68:69], v[84:85]
    v_pk_mul_f32 v[70:71], v[70:71], v[86:87]
    v_cvt_pk_bf16_f32 v82, v68, v69
    v_cvt_pk_bf16_f32 v83, v70, v71
    buffer_store_dwordx4 v[80:83], v212, s[8:11], s83 offen offset:0 sc1
    v_pk_fma_f32 v[72:73], v[160:161], v[228:229], v[72:73] op_sel:[0,0,0] op_sel_hi:[1,0,1] neg_lo:[1,0,0] neg_hi:[1,0,0]
    v_pk_fma_f32 v[72:73], v[72:73], v[228:229], v[164:165] op_sel:[0,1,0] op_sel_hi:[1,1,1]
    v_pk_fma_f32 v[74:75], v[162:163], v[228:229], v[74:75] op_sel:[0,0,0] op_sel_hi:[1,0,1] neg_lo:[1,0,0] neg_hi:[1,0,0]
    v_pk_fma_f32 v[74:75], v[74:75], v[228:229], v[166:167] op_sel:[0,1,0] op_sel_hi:[1,1,1]
    v_pk_fma_f32 v[88:89], v[168:169], v[228:229], v[88:89] op_sel:[0,0,0] op_sel_hi:[1,0,1] neg_lo:[1,0,0] neg_hi:[1,0,0]
    v_pk_fma_f32 v[88:89], v[88:89], v[228:229], v[172:173] op_sel:[0,1,0] op_sel_hi:[1,1,1]
    v_pk_fma_f32 v[90:91], v[170:171], v[228:229], v[90:91] op_sel:[0,0,0] op_sel_hi:[1,0,1] neg_lo:[1,0,0] neg_hi:[1,0,0]
    v_pk_fma_f32 v[90:91], v[90:91], v[228:229], v[174:175] op_sel:[0,1,0] op_sel_hi:[1,1,1]
    v_pk_mul_f32 v[72:73], v[72:73], v[88:89]
    v_pk_mul_f32 v[74:75], v[74:75], v[90:91]
    v_cvt_pk_bf16_f32 v88, v72, v73
    v_cvt_pk_bf16_f32 v89, v74, v75
    v_pk_fma_f32 v[76:77], v[160:161], v[230:231], v[76:77] op_sel:[0,0,0] op_sel_hi:[1,0,1] neg_lo:[1,0,0] neg_hi:[1,0,0]
    v_pk_fma_f32 v[76:77], v[76:77], v[230:231], v[164:165] op_sel:[0,1,0] op_sel_hi:[1,1,1]
    v_pk_fma_f32 v[78:79], v[162:163], v[230:231], v[78:79] op_sel:[0,0,0] op_sel_hi:[1,0,1] neg_lo:[1,0,0] neg_hi:[1,0,0]
    v_pk_fma_f32 v[78:79], v[78:79], v[230:231], v[166:167] op_sel:[0,1,0] op_sel_hi:[1,1,1]
    v_pk_fma_f32 v[92:93], v[168:169], v[230:231], v[92:93] op_sel:[0,0,0] op_sel_hi:[1,0,1] neg_lo:[1,0,0] neg_hi:[1,0,0]
    v_pk_fma_f32 v[92:93], v[92:93], v[230:231], v[172:173] op_sel:[0,1,0] op_sel_hi:[1,1,1]
    v_pk_fma_f32 v[94:95], v[170:171], v[230:231], v[94:95] op_sel:[0,0,0] op_sel_hi:[1,0,1] neg_lo:[1,0,0] neg_hi:[1,0,0]
    v_pk_fma_f32 v[94:95], v[94:95], v[230:231], v[174:175] op_sel:[0,1,0] op_sel_hi:[1,1,1]
    v_pk_mul_f32 v[76:77], v[76:77], v[92:93]
    v_pk_mul_f32 v[78:79], v[78:79], v[94:95]
    v_cvt_pk_bf16_f32 v90, v76, v77
    v_cvt_pk_bf16_f32 v91, v78, v79
    buffer_store_dwordx4 v[88:91], v212, s[8:11], s83 offen offset:1024 sc1
    s_add_u32 s31, s28, s69
    buffer_load_dwordx4 a[208:211], v212, s[48:51], s31 offen offset:0
    buffer_load_dwordx4 a[212:215], v212, s[48:51], s31 offen offset:1024
    buffer_load_dwordx4 a[216:219], v212, s[48:51], s31 offen offset:2048
    buffer_load_dwordx4 a[220:223], v212, s[48:51], s31 offen offset:3072
    s_add_u32 s31, s28, s70
    buffer_load_dwordx4 a[224:227], v212, s[48:51], s31 offen offset:0
    buffer_load_dwordx4 a[228:231], v212, s[48:51], s31 offen offset:1024
    buffer_load_dwordx4 a[232:235], v212, s[48:51], s31 offen offset:2048
    buffer_load_dwordx4 a[236:239], v212, s[48:51], s31 offen offset:3072
    s_mov_b32 s12, s6
    s_mov_b32 s13, s7
    s_mov_b32 s14, 12288
    s_mov_b32 s15, 0x00020000
    v_lshlrev_b32 v219, 4, v209
    s_lshl_b32 s40, s22, 8
    s_add_u32 s40, s40, 10240
    buffer_load_dwordx4 v[240:243], v219, s[12:15], s40 offen
    v_mov_b64 v[64:65], v[16:17]
    v_mov_b64 v[66:67], v[48:49]
    v_mov_b64 v[68:69], v[18:19]
    v_mov_b64 v[70:71], v[50:51]
    v_mov_b64 v[72:73], v[24:25]
    v_mov_b64 v[74:75], v[56:57]
    v_mov_b64 v[76:77], v[26:27]
    v_mov_b64 v[78:79], v[58:59]
    s_waitcnt vmcnt(31)
    v_mfma_f32_16x16x32_bf16 v[0:3], v[64:67], a[240:243], 0
    v_mfma_f32_16x16x32_bf16 v[4:7], v[64:67], a[244:247], 0
    v_mfma_f32_16x16x32_bf16 v[8:11], v[64:67], a[248:251], 0
    v_mfma_f32_16x16x32_bf16 v[12:15], v[64:67], a[252:255], 0
    v_mfma_f32_16x16x32_bf16 v[16:19], v[68:71], a[240:243], 0
    v_mfma_f32_16x16x32_bf16 v[20:23], v[68:71], a[244:247], 0
    v_mfma_f32_16x16x32_bf16 v[24:27], v[68:71], a[248:251], 0
    v_mfma_f32_16x16x32_bf16 v[28:31], v[68:71], a[252:255], 0
    v_mfma_f32_16x16x32_bf16 v[32:35], v[72:75], a[240:243], 0
    v_mfma_f32_16x16x32_bf16 v[36:39], v[72:75], a[244:247], 0
    v_mfma_f32_16x16x32_bf16 v[40:43], v[72:75], a[248:251], 0
    v_mfma_f32_16x16x32_bf16 v[44:47], v[72:75], a[252:255], 0
    v_mfma_f32_16x16x32_bf16 v[48:51], v[76:79], a[240:243], 0
    v_mfma_f32_16x16x32_bf16 v[52:55], v[76:79], a[244:247], 0
    v_mfma_f32_16x16x32_bf16 v[56:59], v[76:79], a[248:251], 0
    v_mfma_f32_16x16x32_bf16 v[60:63], v[76:79], a[252:255], 0
    s_waitcnt vmcnt(9)
    s_barrier
    s_add_u32 s31, s28, s71
    buffer_load_dwordx4 a[0:3], v212, s[48:51], s31 offen offset:0
    buffer_load_dwordx4 a[4:7], v212, s[48:51], s31 offen offset:1024
    buffer_load_dwordx4 a[8:11], v212, s[48:51], s31 offen offset:2048
    buffer_load_dwordx4 a[12:15], v212, s[48:51], s31 offen offset:3072
    s_add_u32 s31, s28, s72
    buffer_load_dwordx4 a[16:19], v212, s[48:51], s31 offen offset:0
    buffer_load_dwordx4 a[20:23], v212, s[48:51], s31 offen offset:1024
    buffer_load_dwordx4 a[24:27], v212, s[48:51], s31 offen offset:2048
    buffer_load_dwordx4 a[28:31], v212, s[48:51], s31 offen offset:3072
    s_add_u32 s31, s28, s73
    buffer_load_dwordx4 a[32:35], v212, s[48:51], s31 offen offset:0
    buffer_load_dwordx4 a[36:39], v212, s[48:51], s31 offen offset:1024
    buffer_load_dwordx4 a[40:43], v212, s[48:51], s31 offen offset:2048
    buffer_load_dwordx4 a[44:47], v212, s[48:51], s31 offen offset:3072
    s_add_u32 s31, s28, s74
    buffer_load_dwordx4 a[48:51], v212, s[48:51], s31 offen offset:0
    buffer_load_dwordx4 a[52:55], v212, s[48:51], s31 offen offset:1024
    buffer_load_dwordx4 a[56:59], v212, s[48:51], s31 offen offset:2048
    buffer_load_dwordx4 a[60:63], v212, s[48:51], s31 offen offset:3072
    s_barrier
    s_add_u32 s31, s27, s65
    buffer_load_dwordx4 v[80:83], v212, s[8:11], s31 offen offset:0 sc1
    buffer_load_dwordx4 v[84:87], v212, s[8:11], s31 offen offset:2048 sc1
    buffer_load_dwordx4 v[88:91], v212, s[8:11], s31 offen offset:1024 sc1
    buffer_load_dwordx4 v[92:95], v212, s[8:11], s31 offen offset:3072 sc1
    s_add_u32 s31, s27, s66
    buffer_load_dwordx4 v[96:99], v212, s[8:11], s31 offen offset:0 sc1
    buffer_load_dwordx4 v[100:103], v212, s[8:11], s31 offen offset:2048 sc1
    buffer_load_dwordx4 v[104:107], v212, s[8:11], s31 offen offset:1024 sc1
    buffer_load_dwordx4 v[108:111], v212, s[8:11], s31 offen offset:3072 sc1
    s_add_u32 s31, s27, s67
    buffer_load_dwordx4 v[112:115], v212, s[8:11], s31 offen offset:0 sc1
    buffer_load_dwordx4 v[116:119], v212, s[8:11], s31 offen offset:2048 sc1
    buffer_load_dwordx4 v[120:123], v212, s[8:11], s31 offen offset:1024 sc1
    buffer_load_dwordx4 v[124:127], v212, s[8:11], s31 offen offset:3072 sc1
    v_lshl_add_u32 v220, v211, 14, v212
    v_add_u32 v220, 66048, v220
    v_lshl_add_u32 v221, v211, 12, v212
    v_add_u32 v221, 66048, v221
    ds_read_b64 v[244:245], v236
    ds_read_b64 v[246:247], v237
    ds_read_b64 v[248:249], v238
    ds_read_b64 v[250:251], v239
    s_mov_b32 s12, s42
    s_mov_b32 s13, s43
    s_mov_b32 s14, 2097152
    s_mov_b32 s15, 0x00020000
    s_waitcnt vmcnt(8)
    v_swap_b32 v82, v84
    v_swap_b32 v83, v85
    v_swap_b32 v90, v92
    v_swap_b32 v91, v93
    v_mfma_f32_16x16x32_bf16 v[0:3], v[80:83], a[144:147], v[0:3]
    s_add_u32 s31, s27, s68
    buffer_load_dwordx4 v[128:131], v212, s[8:11], s31 offen offset:0 sc1
    v_mfma_f32_16x16x32_bf16 v[4:7], v[80:83], a[148:151], v[4:7]
    v_mfma_f32_16x16x32_bf16 v[8:11], v[80:83], a[152:155], v[8:11]
    v_mfma_f32_16x16x32_bf16 v[12:15], v[80:83], a[156:159], v[12:15]
    v_mfma_f32_16x16x32_bf16 v[16:19], v[84:87], a[144:147], v[16:19]
    buffer_load_dwordx4 v[132:135], v212, s[8:11], s31 offen offset:2048 sc1
    v_mfma_f32_16x16x32_bf16 v[20:23], v[84:87], a[148:151], v[20:23]
    v_mfma_f32_16x16x32_bf16 v[24:27], v[84:87], a[152:155], v[24:27]
    v_mfma_f32_16x16x32_bf16 v[28:31], v[84:87], a[156:159], v[28:31]
    v_mfma_f32_16x16x32_bf16 v[32:35], v[88:91], a[144:147], v[32:35]
    buffer_load_dwordx4 v[136:139], v212, s[8:11], s31 offen offset:1024 sc1
    v_mfma_f32_16x16x32_bf16 v[36:39], v[88:91], a[148:151], v[36:39]
    v_mfma_f32_16x16x32_bf16 v[40:43], v[88:91], a[152:155], v[40:43]
    v_mfma_f32_16x16x32_bf16 v[44:47], v[88:91], a[156:159], v[44:47]
    v_mfma_f32_16x16x32_bf16 v[48:51], v[92:95], a[144:147], v[48:51]
    buffer_load_dwordx4 v[140:143], v212, s[8:11], s31 offen offset:3072 sc1
    v_mfma_f32_16x16x32_bf16 v[52:55], v[92:95], a[148:151], v[52:55]
    v_mfma_f32_16x16x32_bf16 v[56:59], v[92:95], a[152:155], v[56:59]
    v_mfma_f32_16x16x32_bf16 v[60:63], v[92:95], a[156:159], v[60:63]
    s_waitcnt vmcnt(8)
    v_swap_b32 v98, v100
    v_swap_b32 v99, v101
    v_swap_b32 v106, v108
    v_swap_b32 v107, v109
    v_mfma_f32_16x16x32_bf16 v[0:3], v[96:99], a[160:163], v[0:3]
    s_add_u32 s31, s27, s69
    buffer_load_dwordx4 v[144:147], v212, s[8:11], s31 offen offset:0 sc1
    v_mfma_f32_16x16x32_bf16 v[4:7], v[96:99], a[164:167], v[4:7]
    v_mfma_f32_16x16x32_bf16 v[8:11], v[96:99], a[168:171], v[8:11]
    v_mfma_f32_16x16x32_bf16 v[12:15], v[96:99], a[172:175], v[12:15]
    v_mfma_f32_16x16x32_bf16 v[16:19], v[100:103], a[160:163], v[16:19]
    buffer_load_dwordx4 v[148:151], v212, s[8:11], s31 offen offset:2048 sc1
    v_mfma_f32_16x16x32_bf16 v[20:23], v[100:103], a[164:167], v[20:23]
    v_mfma_f32_16x16x32_bf16 v[24:27], v[100:103], a[168:171], v[24:27]
    v_mfma_f32_16x16x32_bf16 v[28:31], v[100:103], a[172:175], v[28:31]
    v_mfma_f32_16x16x32_bf16 v[32:35], v[104:107], a[160:163], v[32:35]
    buffer_load_dwordx4 v[152:155], v212, s[8:11], s31 offen offset:1024 sc1
    v_mfma_f32_16x16x32_bf16 v[36:39], v[104:107], a[164:167], v[36:39]
    v_mfma_f32_16x16x32_bf16 v[40:43], v[104:107], a[168:171], v[40:43]
    v_mfma_f32_16x16x32_bf16 v[44:47], v[104:107], a[172:175], v[44:47]
    v_mfma_f32_16x16x32_bf16 v[48:51], v[108:111], a[160:163], v[48:51]
    buffer_load_dwordx4 v[156:159], v212, s[8:11], s31 offen offset:3072 sc1
    v_mfma_f32_16x16x32_bf16 v[52:55], v[108:111], a[164:167], v[52:55]
    v_mfma_f32_16x16x32_bf16 v[56:59], v[108:111], a[168:171], v[56:59]
    v_mfma_f32_16x16x32_bf16 v[60:63], v[108:111], a[172:175], v[60:63]
    s_waitcnt vmcnt(8)
    v_swap_b32 v114, v116
    v_swap_b32 v115, v117
    v_swap_b32 v122, v124
    v_swap_b32 v123, v125
    v_mfma_f32_16x16x32_bf16 v[0:3], v[112:115], a[176:179], v[0:3]
    s_add_u32 s31, s27, s70
    buffer_load_dwordx4 v[160:163], v212, s[8:11], s31 offen offset:0 sc1
    v_mfma_f32_16x16x32_bf16 v[4:7], v[112:115], a[180:183], v[4:7]
    v_mfma_f32_16x16x32_bf16 v[8:11], v[112:115], a[184:187], v[8:11]
    v_mfma_f32_16x16x32_bf16 v[12:15], v[112:115], a[188:191], v[12:15]
    v_mfma_f32_16x16x32_bf16 v[16:19], v[116:119], a[176:179], v[16:19]
    buffer_load_dwordx4 v[164:167], v212, s[8:11], s31 offen offset:2048 sc1
    v_mfma_f32_16x16x32_bf16 v[20:23], v[116:119], a[180:183], v[20:23]
    v_mfma_f32_16x16x32_bf16 v[24:27], v[116:119], a[184:187], v[24:27]
    v_mfma_f32_16x16x32_bf16 v[28:31], v[116:119], a[188:191], v[28:31]
    v_mfma_f32_16x16x32_bf16 v[32:35], v[120:123], a[176:179], v[32:35]
    buffer_load_dwordx4 v[168:171], v212, s[8:11], s31 offen offset:1024 sc1
    v_mfma_f32_16x16x32_bf16 v[36:39], v[120:123], a[180:183], v[36:39]
    v_mfma_f32_16x16x32_bf16 v[40:43], v[120:123], a[184:187], v[40:43]
    v_mfma_f32_16x16x32_bf16 v[44:47], v[120:123], a[188:191], v[44:47]
    v_mfma_f32_16x16x32_bf16 v[48:51], v[124:127], a[176:179], v[48:51]
    buffer_load_dwordx4 v[172:175], v212, s[8:11], s31 offen offset:3072 sc1
    v_mfma_f32_16x16x32_bf16 v[52:55], v[124:127], a[180:183], v[52:55]
    v_mfma_f32_16x16x32_bf16 v[56:59], v[124:127], a[184:187], v[56:59]
    v_mfma_f32_16x16x32_bf16 v[60:63], v[124:127], a[188:191], v[60:63]
    s_waitcnt vmcnt(8)
    v_swap_b32 v130, v132
    v_swap_b32 v131, v133
    v_swap_b32 v138, v140
    v_swap_b32 v139, v141
    v_mfma_f32_16x16x32_bf16 v[0:3], v[128:131], a[192:195], v[0:3]
    s_add_u32 s31, s27, s71
    buffer_load_dwordx4 v[176:179], v212, s[8:11], s31 offen offset:0 sc1
    v_mfma_f32_16x16x32_bf16 v[4:7], v[128:131], a[196:199], v[4:7]
    v_mfma_f32_16x16x32_bf16 v[8:11], v[128:131], a[200:203], v[8:11]
    v_mfma_f32_16x16x32_bf16 v[12:15], v[128:131], a[204:207], v[12:15]
    v_mfma_f32_16x16x32_bf16 v[16:19], v[132:135], a[192:195], v[16:19]
    buffer_load_dwordx4 v[180:183], v212, s[8:11], s31 offen offset:2048 sc1
    v_mfma_f32_16x16x32_bf16 v[20:23], v[132:135], a[196:199], v[20:23]
    v_mfma_f32_16x16x32_bf16 v[24:27], v[132:135], a[200:203], v[24:27]
    v_mfma_f32_16x16x32_bf16 v[28:31], v[132:135], a[204:207], v[28:31]
    v_mfma_f32_16x16x32_bf16 v[32:35], v[136:139], a[192:195], v[32:35]
    buffer_load_dwordx4 v[184:187], v212, s[8:11], s31 offen offset:1024 sc1
    v_mfma_f32_16x16x32_bf16 v[36:39], v[136:139], a[196:199], v[36:39]
    v_mfma_f32_16x16x32_bf16 v[40:43], v[136:139], a[200:203], v[40:43]
    v_mfma_f32_16x16x32_bf16 v[44:47], v[136:139], a[204:207], v[44:47]
    v_mfma_f32_16x16x32_bf16 v[48:51], v[140:143], a[192:195], v[48:51]
    buffer_load_dwordx4 v[188:191], v212, s[8:11], s31 offen offset:3072 sc1
    v_mfma_f32_16x16x32_bf16 v[52:55], v[140:143], a[196:199], v[52:55]
    v_mfma_f32_16x16x32_bf16 v[56:59], v[140:143], a[200:203], v[56:59]
    v_mfma_f32_16x16x32_bf16 v[60:63], v[140:143], a[204:207], v[60:63]
    s_waitcnt vmcnt(8)
    v_swap_b32 v146, v148
    v_swap_b32 v147, v149
    v_swap_b32 v154, v156
    v_swap_b32 v155, v157
    v_mfma_f32_16x16x32_bf16 v[0:3], v[144:147], a[208:211], v[0:3]
    s_add_u32 s31, s27, s72
    buffer_load_dwordx4 v[192:195], v212, s[8:11], s31 offen offset:0 sc1
    v_mfma_f32_16x16x32_bf16 v[4:7], v[144:147], a[212:215], v[4:7]
    v_mfma_f32_16x16x32_bf16 v[8:11], v[144:147], a[216:219], v[8:11]
    v_mfma_f32_16x16x32_bf16 v[12:15], v[144:147], a[220:223], v[12:15]
    v_mfma_f32_16x16x32_bf16 v[16:19], v[148:151], a[208:211], v[16:19]
    buffer_load_dwordx4 v[196:199], v212, s[8:11], s31 offen offset:2048 sc1
    v_mfma_f32_16x16x32_bf16 v[20:23], v[148:151], a[212:215], v[20:23]
    v_mfma_f32_16x16x32_bf16 v[24:27], v[148:151], a[216:219], v[24:27]
    v_mfma_f32_16x16x32_bf16 v[28:31], v[148:151], a[220:223], v[28:31]
    v_mfma_f32_16x16x32_bf16 v[32:35], v[152:155], a[208:211], v[32:35]
    buffer_load_dwordx4 v[200:203], v212, s[8:11], s31 offen offset:1024 sc1
    v_mfma_f32_16x16x32_bf16 v[36:39], v[152:155], a[212:215], v[36:39]
    v_mfma_f32_16x16x32_bf16 v[40:43], v[152:155], a[216:219], v[40:43]
    v_mfma_f32_16x16x32_bf16 v[44:47], v[152:155], a[220:223], v[44:47]
    v_mfma_f32_16x16x32_bf16 v[48:51], v[156:159], a[208:211], v[48:51]
    buffer_load_dwordx4 v[204:207], v212, s[8:11], s31 offen offset:3072 sc1
    v_mfma_f32_16x16x32_bf16 v[52:55], v[156:159], a[212:215], v[52:55]
    v_mfma_f32_16x16x32_bf16 v[56:59], v[156:159], a[216:219], v[56:59]
    v_mfma_f32_16x16x32_bf16 v[60:63], v[156:159], a[220:223], v[60:63]
    s_waitcnt vmcnt(8)
    v_swap_b32 v162, v164
    v_swap_b32 v163, v165
    v_swap_b32 v170, v172
    v_swap_b32 v171, v173
    v_mfma_f32_16x16x32_bf16 v[0:3], v[160:163], a[224:227], v[0:3]
    s_add_u32 s31, s27, s73
    buffer_load_dwordx4 v[64:67], v212, s[8:11], s31 offen offset:0 sc1
    v_mfma_f32_16x16x32_bf16 v[4:7], v[160:163], a[228:231], v[4:7]
    v_mfma_f32_16x16x32_bf16 v[8:11], v[160:163], a[232:235], v[8:11]
    v_mfma_f32_16x16x32_bf16 v[12:15], v[160:163], a[236:239], v[12:15]
    v_mfma_f32_16x16x32_bf16 v[16:19], v[164:167], a[224:227], v[16:19]
    buffer_load_dwordx4 v[68:71], v212, s[8:11], s31 offen offset:2048 sc1
    v_mfma_f32_16x16x32_bf16 v[20:23], v[164:167], a[228:231], v[20:23]
    v_mfma_f32_16x16x32_bf16 v[24:27], v[164:167], a[232:235], v[24:27]
    v_mfma_f32_16x16x32_bf16 v[28:31], v[164:167], a[236:239], v[28:31]
    v_mfma_f32_16x16x32_bf16 v[32:35], v[168:171], a[224:227], v[32:35]
    buffer_load_dwordx4 v[72:75], v212, s[8:11], s31 offen offset:1024 sc1
    v_mfma_f32_16x16x32_bf16 v[36:39], v[168:171], a[228:231], v[36:39]
    v_mfma_f32_16x16x32_bf16 v[40:43], v[168:171], a[232:235], v[40:43]
    v_mfma_f32_16x16x32_bf16 v[44:47], v[168:171], a[236:239], v[44:47]
    v_mfma_f32_16x16x32_bf16 v[48:51], v[172:175], a[224:227], v[48:51]
    buffer_load_dwordx4 v[76:79], v212, s[8:11], s31 offen offset:3072 sc1
    v_mfma_f32_16x16x32_bf16 v[52:55], v[172:175], a[228:231], v[52:55]
    v_mfma_f32_16x16x32_bf16 v[56:59], v[172:175], a[232:235], v[56:59]
    v_mfma_f32_16x16x32_bf16 v[60:63], v[172:175], a[236:239], v[60:63]
    s_waitcnt vmcnt(8)
    v_swap_b32 v178, v180
    v_swap_b32 v179, v181
    v_swap_b32 v186, v188
    v_swap_b32 v187, v189
    v_mfma_f32_16x16x32_bf16 v[0:3], v[176:179], a[0:3], v[0:3]
    s_add_u32 s31, s27, s74
    buffer_load_dwordx4 v[80:83], v212, s[8:11], s31 offen offset:0 sc1
    v_mfma_f32_16x16x32_bf16 v[4:7], v[176:179], a[4:7], v[4:7]
    v_mfma_f32_16x16x32_bf16 v[8:11], v[176:179], a[8:11], v[8:11]
    v_mfma_f32_16x16x32_bf16 v[12:15], v[176:179], a[12:15], v[12:15]
    v_mfma_f32_16x16x32_bf16 v[16:19], v[180:183], a[0:3], v[16:19]
    buffer_load_dwordx4 v[84:87], v212, s[8:11], s31 offen offset:2048 sc1
    v_mfma_f32_16x16x32_bf16 v[20:23], v[180:183], a[4:7], v[20:23]
    v_mfma_f32_16x16x32_bf16 v[24:27], v[180:183], a[8:11], v[24:27]
    v_mfma_f32_16x16x32_bf16 v[28:31], v[180:183], a[12:15], v[28:31]
    v_mfma_f32_16x16x32_bf16 v[32:35], v[184:187], a[0:3], v[32:35]
    buffer_load_dwordx4 v[88:91], v212, s[8:11], s31 offen offset:1024 sc1
    v_mfma_f32_16x16x32_bf16 v[36:39], v[184:187], a[4:7], v[36:39]
    v_mfma_f32_16x16x32_bf16 v[40:43], v[184:187], a[8:11], v[40:43]
    v_mfma_f32_16x16x32_bf16 v[44:47], v[184:187], a[12:15], v[44:47]
    v_mfma_f32_16x16x32_bf16 v[48:51], v[188:191], a[0:3], v[48:51]
    buffer_load_dwordx4 v[92:95], v212, s[8:11], s31 offen offset:3072 sc1
    v_mfma_f32_16x16x32_bf16 v[52:55], v[188:191], a[4:7], v[52:55]
    v_mfma_f32_16x16x32_bf16 v[56:59], v[188:191], a[8:11], v[56:59]
    v_mfma_f32_16x16x32_bf16 v[60:63], v[188:191], a[12:15], v[60:63]
    s_waitcnt vmcnt(8)
    v_swap_b32 v194, v196
    v_swap_b32 v195, v197
    v_swap_b32 v202, v204
    v_swap_b32 v203, v205
    v_mfma_f32_16x16x32_bf16 v[0:3], v[192:195], a[16:19], v[0:3]
    v_mfma_f32_16x16x32_bf16 v[4:7], v[192:195], a[20:23], v[4:7]
    v_mfma_f32_16x16x32_bf16 v[8:11], v[192:195], a[24:27], v[8:11]
    v_mfma_f32_16x16x32_bf16 v[12:15], v[192:195], a[28:31], v[12:15]
    v_mfma_f32_16x16x32_bf16 v[16:19], v[196:199], a[16:19], v[16:19]
    v_mfma_f32_16x16x32_bf16 v[20:23], v[196:199], a[20:23], v[20:23]
    v_mfma_f32_16x16x32_bf16 v[24:27], v[196:199], a[24:27], v[24:27]
    v_mfma_f32_16x16x32_bf16 v[28:31], v[196:199], a[28:31], v[28:31]
    v_mfma_f32_16x16x32_bf16 v[32:35], v[200:203], a[16:19], v[32:35]
    v_mfma_f32_16x16x32_bf16 v[36:39], v[200:203], a[20:23], v[36:39]
    v_mfma_f32_16x16x32_bf16 v[40:43], v[200:203], a[24:27], v[40:43]
    v_mfma_f32_16x16x32_bf16 v[44:47], v[200:203], a[28:31], v[44:47]
    v_mfma_f32_16x16x32_bf16 v[48:51], v[204:207], a[16:19], v[48:51]
    v_mfma_f32_16x16x32_bf16 v[52:55], v[204:207], a[20:23], v[52:55]
    v_mfma_f32_16x16x32_bf16 v[56:59], v[204:207], a[24:27], v[56:59]
    v_mfma_f32_16x16x32_bf16 v[60:63], v[204:207], a[28:31], v[60:63]
    s_waitcnt vmcnt(4)
    v_swap_b32 v66, v68
    v_swap_b32 v67, v69
    v_swap_b32 v74, v76
    v_swap_b32 v75, v77
    v_mfma_f32_16x16x32_bf16 v[0:3], v[64:67], a[32:35], v[0:3]
    s_waitcnt lgkmcnt(0)
    v_lshlrev_b32 v128, 16, v244
    v_mfma_f32_16x16x32_bf16 v[4:7], v[64:67], a[36:39], v[4:7]
    v_and_b32 v129, s33, v244
    v_mfma_f32_16x16x32_bf16 v[8:11], v[64:67], a[40:43], v[8:11]
    v_lshlrev_b32 v130, 16, v245
    v_mfma_f32_16x16x32_bf16 v[12:15], v[64:67], a[44:47], v[12:15]
    v_and_b32 v131, s33, v245
    v_mfma_f32_16x16x32_bf16 v[16:19], v[68:71], a[32:35], v[16:19]
    v_lshlrev_b32 v132, 16, v246
    v_mfma_f32_16x16x32_bf16 v[20:23], v[68:71], a[36:39], v[20:23]
    v_and_b32 v133, s33, v246
    v_mfma_f32_16x16x32_bf16 v[24:27], v[68:71], a[40:43], v[24:27]
    v_lshlrev_b32 v134, 16, v247
    v_mfma_f32_16x16x32_bf16 v[28:31], v[68:71], a[44:47], v[28:31]
    v_and_b32 v135, s33, v247
    v_mfma_f32_16x16x32_bf16 v[32:35], v[72:75], a[32:35], v[32:35]
    v_lshlrev_b32 v136, 16, v248
    v_mfma_f32_16x16x32_bf16 v[36:39], v[72:75], a[36:39], v[36:39]
    v_and_b32 v137, s33, v248
    v_mfma_f32_16x16x32_bf16 v[40:43], v[72:75], a[40:43], v[40:43]
    v_lshlrev_b32 v138, 16, v249
    v_mfma_f32_16x16x32_bf16 v[44:47], v[72:75], a[44:47], v[44:47]
    v_and_b32 v139, s33, v249
    v_mfma_f32_16x16x32_bf16 v[48:51], v[76:79], a[32:35], v[48:51]
    v_lshlrev_b32 v140, 16, v250
    v_mfma_f32_16x16x32_bf16 v[52:55], v[76:79], a[36:39], v[52:55]
    v_and_b32 v141, s33, v250
    v_mfma_f32_16x16x32_bf16 v[56:59], v[76:79], a[40:43], v[56:59]
    v_lshlrev_b32 v142, 16, v251
    v_mfma_f32_16x16x32_bf16 v[60:63], v[76:79], a[44:47], v[60:63]
    v_and_b32 v143, s33, v251
    s_waitcnt vmcnt(0)
    v_swap_b32 v82, v84
    v_swap_b32 v83, v85
    v_swap_b32 v90, v92
    v_swap_b32 v91, v93
    v_mfma_f32_16x16x32_bf16 v[0:3], v[80:83], a[48:51], v[0:3]
    v_mfma_f32_16x16x32_bf16 v[4:7], v[80:83], a[52:55], v[4:7]
    v_mfma_f32_16x16x32_bf16 v[8:11], v[80:83], a[56:59], v[8:11]
    s_nop 5
    ds_write_b128 v220, v[0:3] offset:0
    v_mfma_f32_16x16x32_bf16 v[12:15], v[80:83], a[60:63], v[12:15]
    ds_write_b128 v220, v[4:7] offset:1024
    v_mfma_f32_16x16x32_bf16 v[16:19], v[84:87], a[48:51], v[16:19]
    ds_write_b128 v220, v[8:11] offset:2048
    v_mfma_f32_16x16x32_bf16 v[20:23], v[84:87], a[52:55], v[20:23]
    s_nop 3
    ds_write_b128 v220, v[12:15] offset:3072
    v_mfma_f32_16x16x32_bf16 v[24:27], v[84:87], a[56:59], v[24:27]
    ds_write_b128 v220, v[16:19] offset:4096
    v_mfma_f32_16x16x32_bf16 v[28:31], v[84:87], a[60:63], v[28:31]
    ds_write_b128 v220, v[20:23] offset:5120
    v_mfma_f32_16x16x32_bf16 v[32:35], v[88:91], a[48:51], v[32:35]
    s_nop 3
    ds_write_b128 v220, v[24:27] offset:6144
    v_mfma_f32_16x16x32_bf16 v[36:39], v[88:91], a[52:55], v[36:39]
    ds_write_b128 v220, v[28:31] offset:7168
    v_mfma_f32_16x16x32_bf16 v[40:43], v[88:91], a[56:59], v[40:43]
    ds_write_b128 v220, v[32:35] offset:8192
    v_mfma_f32_16x16x32_bf16 v[44:47], v[88:91], a[60:63], v[44:47]
    s_nop 3
    ds_write_b128 v220, v[36:39] offset:9216
    v_mfma_f32_16x16x32_bf16 v[48:51], v[92:95], a[48:51], v[48:51]
    ds_write_b128 v220, v[40:43] offset:10240
    v_mfma_f32_16x16x32_bf16 v[52:55], v[92:95], a[52:55], v[52:55]
    ds_write_b128 v220, v[44:47] offset:11264
    v_mfma_f32_16x16x32_bf16 v[56:59], v[92:95], a[56:59], v[56:59]
    s_nop 3
    ds_write_b128 v220, v[48:51] offset:12288
    v_mfma_f32_16x16x32_bf16 v[60:63], v[92:95], a[60:63], v[60:63]
    ds_write_b128 v220, v[52:55] offset:13312
    s_nop 0
    ds_write_b128 v220, v[56:59] offset:14336
    s_waitcnt lgkmcnt(14)
    s_nop 3
    ds_write_b128 v220, v[60:63] offset:15360
    s_waitcnt lgkmcnt(0)
    s_barrier
    ds_read_b128 v[64:67], v221 offset:0
    ds_read_b128 v[68:71], v221 offset:16384
    ds_read_b128 v[72:75], v221 offset:32768
    ds_read_b128 v[76:79], v221 offset:49152
    ds_read_b128 v[80:83], v221 offset:1024
    ds_read_b128 v[84:87], v221 offset:17408
    ds_read_b128 v[88:91], v221 offset:33792
    ds_read_b128 v[92:95], v221 offset:50176
    ds_read_b128 v[96:99], v221 offset:2048
    ds_read_b128 v[100:103], v221 offset:18432
    ds_read_b128 v[104:107], v221 offset:34816
    ds_read_b128 v[108:111], v221 offset:51200
    ds_read_b128 v[112:115], v221 offset:3072
    ds_read_b128 v[116:119], v221 offset:19456
    ds_read_b128 v[120:123], v221 offset:35840
    s_waitcnt lgkmcnt(14)
    ds_read_b128 v[124:127], v221 offset:52224
    s_waitcnt lgkmcnt(12)
    v_pk_add_f32 v[64:65], v[64:65], v[68:69]
    v_pk_add_f32 v[72:73], v[72:73], v[76:77]
    v_pk_add_f32 v[64:65], v[64:65], v[72:73]
    v_pk_add_f32 v[66:67], v[66:67], v[70:71]
    v_pk_add_f32 v[74:75], v[74:75], v[78:79]
    v_pk_add_f32 v[66:67], v[66:67], v[74:75]
    v_fmac_f32 v128, v64, v240
    v_fmac_f32 v132, v65, v240
    v_fmac_f32 v136, v66, v240
    v_fmac_f32 v140, v67, v240
    s_waitcnt lgkmcnt(8)
    v_pk_add_f32 v[80:81], v[80:81], v[84:85]
    v_pk_add_f32 v[88:89], v[88:89], v[92:93]
    v_pk_add_f32 v[80:81], v[80:81], v[88:89]
    v_pk_add_f32 v[82:83], v[82:83], v[86:87]
    v_pk_add_f32 v[90:91], v[90:91], v[94:95]
    v_pk_add_f32 v[82:83], v[82:83], v[90:91]
    v_fmac_f32 v129, v80, v241
    v_fmac_f32 v133, v81, v241
    v_fmac_f32 v137, v82, v241
    v_fmac_f32 v141, v83, v241
    s_waitcnt lgkmcnt(4)
    v_pk_add_f32 v[96:97], v[96:97], v[100:101]
    v_pk_add_f32 v[104:105], v[104:105], v[108:109]
    v_pk_add_f32 v[96:97], v[96:97], v[104:105]
    v_pk_add_f32 v[98:99], v[98:99], v[102:103]
    v_pk_add_f32 v[106:107], v[106:107], v[110:111]
    v_pk_add_f32 v[98:99], v[98:99], v[106:107]
    v_fmac_f32 v130, v96, v242
    v_fmac_f32 v134, v97, v242
    v_fmac_f32 v138, v98, v242
    v_fmac_f32 v142, v99, v242
    s_waitcnt lgkmcnt(0)
    v_pk_add_f32 v[112:113], v[112:113], v[116:117]
    v_pk_add_f32 v[120:121], v[120:121], v[124:125]
    v_pk_add_f32 v[112:113], v[112:113], v[120:121]
    v_pk_add_f32 v[114:115], v[114:115], v[118:119]
    v_pk_add_f32 v[122:123], v[122:123], v[126:127]
    v_pk_add_f32 v[114:115], v[114:115], v[122:123]
    v_fmac_f32 v131, v112, v243
    v_fmac_f32 v135, v113, v243
    v_fmac_f32 v139, v114, v243
    v_fmac_f32 v143, v115, v243
    v_cvt_pk_bf16_f32 v144, v128, v129
    v_cvt_pk_bf16_f32 v145, v130, v131
    s_add_u32 s38, s26, 0
    buffer_store_dwordx2 v[144:145], v223, s[12:15], s38 offen sc1
    v_cvt_pk_bf16_f32 v146, v132, v133
    v_cvt_pk_bf16_f32 v147, v134, v135
    s_add_u32 s38, s26, 8192
    buffer_store_dwordx2 v[146:147], v223, s[12:15], s38 offen sc1
    v_cvt_pk_bf16_f32 v148, v136, v137
    v_cvt_pk_bf16_f32 v149, v138, v139
    s_add_u32 s38, s26, 16384
    buffer_store_dwordx2 v[148:149], v223, s[12:15], s38 offen sc1
    v_cvt_pk_bf16_f32 v150, v140, v141
    v_cvt_pk_bf16_f32 v151, v142, v143
    s_add_u32 s38, s26, 24576
    buffer_store_dwordx2 v[150:151], v223, s[12:15], s38 offen sc1
    s_endpgm
L_k3_role1:
    s_nop 7
    s_add_u32 s76, s30, 0
    buffer_load_dwordx4 a[0:3], v212, s[16:19], s76 offen offset:0
    s_add_u32 s77, s30, 16384
    buffer_load_dwordx4 a[4:7], v212, s[16:19], s77 offen offset:0
    s_add_u32 s78, s30, 32768
    buffer_load_dwordx4 a[8:11], v212, s[16:19], s78 offen offset:0
    s_add_u32 s79, s30, 49152
    buffer_load_dwordx4 a[12:15], v212, s[16:19], s79 offen offset:0
    buffer_load_dwordx4 a[24:27], v212, s[16:19], s76 offen offset:1024
    buffer_load_dwordx4 a[28:31], v212, s[16:19], s77 offen offset:1024
    buffer_load_dwordx4 a[32:35], v212, s[16:19], s78 offen offset:1024
    buffer_load_dwordx4 a[36:39], v212, s[16:19], s79 offen offset:1024
    buffer_load_dwordx4 a[48:51], v212, s[16:19], s76 offen offset:2048
    buffer_load_dwordx4 a[52:55], v212, s[16:19], s77 offen offset:2048
    buffer_load_dwordx4 a[56:59], v212, s[16:19], s78 offen offset:2048
    buffer_load_dwordx4 a[60:63], v212, s[16:19], s79 offen offset:2048
    s_waitcnt vmcnt(12)
    s_barrier
    s_setprio 3
    v_mov_b32 v217, 1
    s_lshl_b32 s57, s22, 2
    s_add_u32 s57, s57, s56
    v_mov_b32 v218, 0
    s_mov_b64 exec, 1
    buffer_store_dword v217, v218, s[52:55], s57 offen sc1
    s_mov_b64 exec, -1
    ds_read_b128 v[96:99], v214 offset:0
    ds_read_b128 v[100:103], v214 offset:1024
    ds_read_b128 v[104:107], v214 offset:2048
    ds_read_b128 v[108:111], v214 offset:3072
    ds_read_b128 v[112:115], v215 offset:4096
    ds_read_b128 v[116:119], v215 offset:5120
    ds_read_b128 v[120:123], v215 offset:6144
    ds_read_b128 v[124:127], v215 offset:7168
    v_mov_b32 v176, 0x3f803f80
    v_mov_b32 v177, 0x3f803f80
    v_mov_b32 v178, 0x3f803f80
    v_mov_b32 v179, 0x3f803f80
    s_waitcnt lgkmcnt(4)
    s_nop 0
    v_mfma_f32_16x16x32_bf16 v[64:67], v[176:179], v[96:99], 0
    buffer_load_dwordx4 a[72:75], v212, s[16:19], s76 offen offset:3072
    v_mfma_f32_16x16x32_bf16 v[80:83], v[96:99], v[96:99], 0
    v_mfma_f32_16x16x32_bf16 v[68:71], v[176:179], v[100:103], 0
    v_mfma_f32_16x16x32_bf16 v[84:87], v[100:103], v[100:103], 0
    v_mfma_f32_16x16x32_bf16 v[72:75], v[176:179], v[104:107], 0
    v_mfma_f32_16x16x32_bf16 v[88:91], v[104:107], v[104:107], 0
    v_mfma_f32_16x16x32_bf16 v[76:79], v[176:179], v[108:111], 0
    buffer_load_dwordx4 a[76:79], v212, s[16:19], s77 offen offset:3072
    v_mfma_f32_16x16x32_bf16 v[92:95], v[108:111], v[108:111], 0
    s_waitcnt vmcnt(11)
    v_mfma_f32_16x16x32_bf16 v[0:3], a[0:3], v[96:99], 0
    v_mfma_f32_16x16x32_bf16 v[4:7], a[0:3], v[100:103], 0
    v_mfma_f32_16x16x32_bf16 v[8:11], a[0:3], v[104:107], 0
    v_mfma_f32_16x16x32_bf16 v[12:15], a[0:3], v[108:111], 0
    v_mfma_f32_16x16x32_bf16 v[16:19], a[4:7], v[96:99], 0
    buffer_load_dwordx4 a[80:83], v212, s[16:19], s78 offen offset:3072
    v_mfma_f32_16x16x32_bf16 v[20:23], a[4:7], v[100:103], 0
    v_mfma_f32_16x16x32_bf16 v[24:27], a[4:7], v[104:107], 0
    v_mfma_f32_16x16x32_bf16 v[28:31], a[4:7], v[108:111], 0
    v_mfma_f32_16x16x32_bf16 v[32:35], a[8:11], v[96:99], 0
    v_mfma_f32_16x16x32_bf16 v[36:39], a[8:11], v[100:103], 0
    v_mfma_f32_16x16x32_bf16 v[40:43], a[8:11], v[104:107], 0
    buffer_load_dwordx4 a[84:87], v212, s[16:19], s79 offen offset:3072
    v_mfma_f32_16x16x32_bf16 v[44:47], a[8:11], v[108:111], 0
    v_mfma_f32_16x16x32_bf16 v[48:51], a[12:15], v[96:99], 0
    v_mfma_f32_16x16x32_bf16 v[52:55], a[12:15], v[100:103], 0
    v_mfma_f32_16x16x32_bf16 v[56:59], a[12:15], v[104:107], 0
    v_mfma_f32_16x16x32_bf16 v[60:63], a[12:15], v[108:111], 0
    s_waitcnt lgkmcnt(0)
    v_mfma_f32_16x16x32_bf16 v[64:67], v[176:179], v[112:115], v[64:67]
    s_add_u32 s76, s30, 4096
    buffer_load_dwordx4 a[96:99], v212, s[16:19], s76 offen offset:0
    v_mfma_f32_16x16x32_bf16 v[80:83], v[112:115], v[112:115], v[80:83]
    v_mfma_f32_16x16x32_bf16 v[68:71], v[176:179], v[116:119], v[68:71]
    v_mfma_f32_16x16x32_bf16 v[84:87], v[116:119], v[116:119], v[84:87]
    v_mfma_f32_16x16x32_bf16 v[72:75], v[176:179], v[120:123], v[72:75]
    v_mfma_f32_16x16x32_bf16 v[88:91], v[120:123], v[120:123], v[88:91]
    v_mfma_f32_16x16x32_bf16 v[76:79], v[176:179], v[124:127], v[76:79]
    s_add_u32 s77, s30, 20480
    buffer_load_dwordx4 a[100:103], v212, s[16:19], s77 offen offset:0
    v_mfma_f32_16x16x32_bf16 v[92:95], v[124:127], v[124:127], v[92:95]
    s_waitcnt vmcnt(11)
    v_mfma_f32_16x16x32_bf16 v[0:3], a[24:27], v[112:115], v[0:3]
    v_mfma_f32_16x16x32_bf16 v[4:7], a[24:27], v[116:119], v[4:7]
    v_mfma_f32_16x16x32_bf16 v[8:11], a[24:27], v[120:123], v[8:11]
    v_mfma_f32_16x16x32_bf16 v[12:15], a[24:27], v[124:127], v[12:15]
    v_mfma_f32_16x16x32_bf16 v[16:19], a[28:31], v[112:115], v[16:19]
    s_add_u32 s78, s30, 36864
    buffer_load_dwordx4 a[104:107], v212, s[16:19], s78 offen offset:0
    v_mfma_f32_16x16x32_bf16 v[20:23], a[28:31], v[116:119], v[20:23]
    v_mfma_f32_16x16x32_bf16 v[24:27], a[28:31], v[120:123], v[24:27]
    v_mfma_f32_16x16x32_bf16 v[28:31], a[28:31], v[124:127], v[28:31]
    v_mfma_f32_16x16x32_bf16 v[32:35], a[32:35], v[112:115], v[32:35]
    v_mfma_f32_16x16x32_bf16 v[36:39], a[32:35], v[116:119], v[36:39]
    v_mfma_f32_16x16x32_bf16 v[40:43], a[32:35], v[120:123], v[40:43]
    s_add_u32 s79, s30, 53248
    buffer_load_dwordx4 a[108:111], v212, s[16:19], s79 offen offset:0
    v_mfma_f32_16x16x32_bf16 v[44:47], a[32:35], v[124:127], v[44:47]
    v_mfma_f32_16x16x32_bf16 v[48:51], a[36:39], v[112:115], v[48:51]
    v_mfma_f32_16x16x32_bf16 v[52:55], a[36:39], v[116:119], v[52:55]
    v_mfma_f32_16x16x32_bf16 v[56:59], a[36:39], v[120:123], v[56:59]
    v_mfma_f32_16x16x32_bf16 v[60:63], a[36:39], v[124:127], v[60:63]
    s_mov_b32 s58, 40000
L_k3_p1:
    buffer_load_dword v217, v216, s[52:55], s56 offen offset:0 sc1
    s_waitcnt vmcnt(0)
    v_cmp_ne_u32 vcc, 1, v217
    s_nop 4
    s_sub_u32 s58, s58, 1
    s_cbranch_scc1 L_k3_p1_done
    s_cbranch_vccnz L_k3_p1
L_k3_p1_done:
    s_barrier
    s_lshl_b32 s38, s25, 10
    s_add_u32 s39, s37, s38
    s_add_u32 m0, s38, 8192
    s_add_u32 s40, s59, 8192
    s_and_b32 s40, s40, 0xffff
    s_add_u32 s40, s40, s39
    buffer_load_dwordx4 v212, s[44:47], s40 offen sc1 lds
    s_add_u32 m0, s38, 12288
    s_add_u32 s40, s59, 12288
    s_and_b32 s40, s40, 0xffff
    s_add_u32 s40, s40, s39
    buffer_load_dwordx4 v212, s[44:47], s40 offen sc1 lds
    s_add_u32 m0, s38, 16384
    s_add_u32 s40, s59, 16384
    s_and_b32 s40, s40, 0xffff
    s_add_u32 s40, s40, s39
    buffer_load_dwordx4 v212, s[44:47], s40 offen sc1 lds
    s_add_u32 m0, s38, 20480
    s_add_u32 s40, s59, 20480
    s_and_b32 s40, s40, 0xffff
    s_add_u32 s40, s40, s39
    buffer_load_dwordx4 v212, s[44:47], s40 offen sc1 lds
    s_add_u32 m0, s38, 24576
    s_add_u32 s40, s59, 24576
    s_and_b32 s40, s40, 0xffff
    s_add_u32 s40, s40, s39
    buffer_load_dwordx4 v212, s[44:47], s40 offen sc1 lds
    s_add_u32 m0, s38, 28672
    s_add_u32 s40, s59, 28672
    s_and_b32 s40, s40, 0xffff
    s_add_u32 s40, s40, s39
    buffer_load_dwordx4 v212, s[44:47], s40 offen sc1 lds
    s_add_u32 m0, s38, 32768
    s_add_u32 s40, s59, 32768
    s_and_b32 s40, s40, 0xffff
    s_add_u32 s40, s40, s39
    buffer_load_dwordx4 v212, s[44:47], s40 offen sc1 lds
    s_add_u32 m0, s38, 36864
    s_add_u32 s40, s59, 36864
    s_and_b32 s40, s40, 0xffff
    s_add_u32 s40, s40, s39
    buffer_load_dwordx4 v212, s[44:47], s40 offen sc1 lds
    s_add_u32 m0, s38, 40960
    s_add_u32 s40, s59, 40960
    s_and_b32 s40, s40, 0xffff
    s_add_u32 s40, s40, s39
    buffer_load_dwordx4 v212, s[44:47], s40 offen sc1 lds
    s_add_u32 m0, s38, 45056
    s_add_u32 s40, s59, 45056
    s_and_b32 s40, s40, 0xffff
    s_add_u32 s40, s40, s39
    buffer_load_dwordx4 v212, s[44:47], s40 offen sc1 lds
    s_add_u32 m0, s38, 49152
    s_add_u32 s40, s59, 49152
    s_and_b32 s40, s40, 0xffff
    s_add_u32 s40, s40, s39
    buffer_load_dwordx4 v212, s[44:47], s40 offen sc1 lds
    s_add_u32 m0, s38, 53248
    s_add_u32 s40, s59, 53248
    s_and_b32 s40, s40, 0xffff
    s_add_u32 s40, s40, s39
    buffer_load_dwordx4 v212, s[44:47], s40 offen sc1 lds
    s_add_u32 m0, s38, 57344
    s_add_u32 s40, s59, 57344
    s_and_b32 s40, s40, 0xffff
    s_add_u32 s40, s40, s39
    buffer_load_dwordx4 v212, s[44:47], s40 offen sc1 lds
    s_add_u32 m0, s38, 61440
    s_add_u32 s40, s59, 61440
    s_and_b32 s40, s40, 0xffff
    s_add_u32 s40, s40, s39
    buffer_load_dwordx4 v212, s[44:47], s40 offen sc1 lds
    s_waitcnt vmcnt(10)
    s_barrier
    ds_read_b128 v[96:99], v214 offset:8192
    ds_read_b128 v[100:103], v214 offset:9216
    ds_read_b128 v[104:107], v214 offset:10240
    ds_read_b128 v[108:111], v214 offset:11264
    ds_read_b128 v[112:115], v215 offset:12288
    ds_read_b128 v[116:119], v215 offset:13312
    ds_read_b128 v[120:123], v215 offset:14336
    ds_read_b128 v[124:127], v215 offset:15360
    s_waitcnt lgkmcnt(4)
    v_mfma_f32_16x16x32_bf16 v[64:67], v[176:179], v[96:99], v[64:67]
    buffer_load_dwordx4 a[120:123], v212, s[16:19], s76 offen offset:1024
    v_mfma_f32_16x16x32_bf16 v[80:83], v[96:99], v[96:99], v[80:83]
    v_mfma_f32_16x16x32_bf16 v[68:71], v[176:179], v[100:103], v[68:71]
    v_mfma_f32_16x16x32_bf16 v[84:87], v[100:103], v[100:103], v[84:87]
    v_mfma_f32_16x16x32_bf16 v[72:75], v[176:179], v[104:107], v[72:75]
    v_mfma_f32_16x16x32_bf16 v[88:91], v[104:107], v[104:107], v[88:91]
    v_mfma_f32_16x16x32_bf16 v[76:79], v[176:179], v[108:111], v[76:79]
    v_mfma_f32_16x16x32_bf16 v[92:95], v[108:111], v[108:111], v[92:95]
    ds_read_b128 v[96:99], v214 offset:16384
    ds_read_b128 v[100:103], v214 offset:17408
    ds_read_b128 v[104:107], v214 offset:18432
    ds_read_b128 v[108:111], v214 offset:19456
    s_waitcnt lgkmcnt(4)
    v_mfma_f32_16x16x32_bf16 v[64:67], v[176:179], v[112:115], v[64:67]
    buffer_load_dwordx4 a[124:127], v212, s[16:19], s77 offen offset:1024
    v_mfma_f32_16x16x32_bf16 v[80:83], v[112:115], v[112:115], v[80:83]
    v_mfma_f32_16x16x32_bf16 v[68:71], v[176:179], v[116:119], v[68:71]
    v_mfma_f32_16x16x32_bf16 v[84:87], v[116:119], v[116:119], v[84:87]
    v_mfma_f32_16x16x32_bf16 v[72:75], v[176:179], v[120:123], v[72:75]
    v_mfma_f32_16x16x32_bf16 v[88:91], v[120:123], v[120:123], v[88:91]
    v_mfma_f32_16x16x32_bf16 v[76:79], v[176:179], v[124:127], v[76:79]
    v_mfma_f32_16x16x32_bf16 v[92:95], v[124:127], v[124:127], v[92:95]
    ds_read_b128 v[112:115], v215 offset:20480
    ds_read_b128 v[116:119], v215 offset:21504
    ds_read_b128 v[120:123], v215 offset:22528
    ds_read_b128 v[124:127], v215 offset:23552
    s_waitcnt lgkmcnt(4)
    v_mfma_f32_16x16x32_bf16 v[64:67], v[176:179], v[96:99], v[64:67]
    buffer_load_dwordx4 a[128:131], v212, s[16:19], s78 offen offset:1024
    v_mfma_f32_16x16x32_bf16 v[80:83], v[96:99], v[96:99], v[80:83]
    v_mfma_f32_16x16x32_bf16 v[68:71], v[176:179], v[100:103], v[68:71]
    v_mfma_f32_16x16x32_bf16 v[84:87], v[100:103], v[100:103], v[84:87]
    v_mfma_f32_16x16x32_bf16 v[72:75], v[176:179], v[104:107], v[72:75]
    v_mfma_f32_16x16x32_bf16 v[88:91], v[104:107], v[104:107], v[88:91]
    v_mfma_f32_16x16x32_bf16 v[76:79], v[176:179], v[108:111], v[76:79]
    v_mfma_f32_16x16x32_bf16 v[92:95], v[108:111], v[108:111], v[92:95]
    s_waitcnt vmcnt(9)
    s_barrier
    ds_read_b128 v[96:99], v214 offset:24576
    ds_read_b128 v[100:103], v214 offset:25600
    ds_read_b128 v[104:107], v214 offset:26624
    ds_read_b128 v[108:111], v214 offset:27648
    s_waitcnt lgkmcnt(4)
    v_mfma_f32_16x16x32_bf16 v[64:67], v[176:179], v[112:115], v[64:67]
    buffer_load_dwordx4 a[132:135], v212, s[16:19], s79 offen offset:1024
    v_mfma_f32_16x16x32_bf16 v[80:83], v[112:115], v[112:115], v[80:83]
    v_mfma_f32_16x16x32_bf16 v[68:71], v[176:179], v[116:119], v[68:71]
    v_mfma_f32_16x16x32_bf16 v[84:87], v[116:119], v[116:119], v[84:87]
    v_mfma_f32_16x16x32_bf16 v[72:75], v[176:179], v[120:123], v[72:75]
    v_mfma_f32_16x16x32_bf16 v[88:91], v[120:123], v[120:123], v[88:91]
    v_mfma_f32_16x16x32_bf16 v[76:79], v[176:179], v[124:127], v[76:79]
    v_mfma_f32_16x16x32_bf16 v[92:95], v[124:127], v[124:127], v[92:95]
    ds_read_b128 v[112:115], v215 offset:28672
    ds_read_b128 v[116:119], v215 offset:29696
    ds_read_b128 v[120:123], v215 offset:30720
    ds_read_b128 v[124:127], v215 offset:31744
    s_waitcnt lgkmcnt(4)
    v_mfma_f32_16x16x32_bf16 v[64:67], v[176:179], v[96:99], v[64:67]
    buffer_load_dwordx4 a[144:147], v212, s[16:19], s76 offen offset:2048
    v_mfma_f32_16x16x32_bf16 v[80:83], v[96:99], v[96:99], v[80:83]
    v_mfma_f32_16x16x32_bf16 v[68:71], v[176:179], v[100:103], v[68:71]
    v_mfma_f32_16x16x32_bf16 v[84:87], v[100:103], v[100:103], v[84:87]
    v_mfma_f32_16x16x32_bf16 v[72:75], v[176:179], v[104:107], v[72:75]
    v_mfma_f32_16x16x32_bf16 v[88:91], v[104:107], v[104:107], v[88:91]
    v_mfma_f32_16x16x32_bf16 v[76:79], v[176:179], v[108:111], v[76:79]
    v_mfma_f32_16x16x32_bf16 v[92:95], v[108:111], v[108:111], v[92:95]
    ds_read_b128 v[96:99], v214 offset:32768
    ds_read_b128 v[100:103], v214 offset:33792
    ds_read_b128 v[104:107], v214 offset:34816
    ds_read_b128 v[108:111], v214 offset:35840
    s_waitcnt lgkmcnt(4)
    v_mfma_f32_16x16x32_bf16 v[64:67], v[176:179], v[112:115], v[64:67]
    buffer_load_dwordx4 a[148:151], v212, s[16:19], s77 offen offset:2048
    v_mfma_f32_16x16x32_bf16 v[80:83], v[112:115], v[112:115], v[80:83]
    v_mfma_f32_16x16x32_bf16 v[68:71], v[176:179], v[116:119], v[68:71]
    v_mfma_f32_16x16x32_bf16 v[84:87], v[116:119], v[116:119], v[84:87]
    v_mfma_f32_16x16x32_bf16 v[72:75], v[176:179], v[120:123], v[72:75]
    v_mfma_f32_16x16x32_bf16 v[88:91], v[120:123], v[120:123], v[88:91]
    v_mfma_f32_16x16x32_bf16 v[76:79], v[176:179], v[124:127], v[76:79]
    v_mfma_f32_16x16x32_bf16 v[92:95], v[124:127], v[124:127], v[92:95]
    ds_read_b128 v[112:115], v215 offset:36864
    ds_read_b128 v[116:119], v215 offset:37888
    ds_read_b128 v[120:123], v215 offset:38912
    ds_read_b128 v[124:127], v215 offset:39936
    s_waitcnt lgkmcnt(4)
    v_mfma_f32_16x16x32_bf16 v[64:67], v[176:179], v[96:99], v[64:67]
    buffer_load_dwordx4 a[152:155], v212, s[16:19], s78 offen offset:2048
    v_mfma_f32_16x16x32_bf16 v[80:83], v[96:99], v[96:99], v[80:83]
    v_mfma_f32_16x16x32_bf16 v[68:71], v[176:179], v[100:103], v[68:71]
    v_mfma_f32_16x16x32_bf16 v[84:87], v[100:103], v[100:103], v[84:87]
    v_mfma_f32_16x16x32_bf16 v[72:75], v[176:179], v[104:107], v[72:75]
    v_mfma_f32_16x16x32_bf16 v[88:91], v[104:107], v[104:107], v[88:91]
    v_mfma_f32_16x16x32_bf16 v[76:79], v[176:179], v[108:111], v[76:79]
    v_mfma_f32_16x16x32_bf16 v[92:95], v[108:111], v[108:111], v[92:95]
    s_waitcnt vmcnt(9)
    s_barrier
    ds_read_b128 v[96:99], v214 offset:40960
    ds_read_b128 v[100:103], v214 offset:41984
    ds_read_b128 v[104:107], v214 offset:43008
    ds_read_b128 v[108:111], v214 offset:44032
    s_waitcnt lgkmcnt(4)
    v_mfma_f32_16x16x32_bf16 v[64:67], v[176:179], v[112:115], v[64:67]
    buffer_load_dwordx4 a[156:159], v212, s[16:19], s79 offen offset:2048
    v_mfma_f32_16x16x32_bf16 v[80:83], v[112:115], v[112:115], v[80:83]
    v_mfma_f32_16x16x32_bf16 v[68:71], v[176:179], v[116:119], v[68:71]
    v_mfma_f32_16x16x32_bf16 v[84:87], v[116:119], v[116:119], v[84:87]
    v_mfma_f32_16x16x32_bf16 v[72:75], v[176:179], v[120:123], v[72:75]
    v_mfma_f32_16x16x32_bf16 v[88:91], v[120:123], v[120:123], v[88:91]
    v_mfma_f32_16x16x32_bf16 v[76:79], v[176:179], v[124:127], v[76:79]
    v_mfma_f32_16x16x32_bf16 v[92:95], v[124:127], v[124:127], v[92:95]
    ds_read_b128 v[112:115], v215 offset:45056
    ds_read_b128 v[116:119], v215 offset:46080
    ds_read_b128 v[120:123], v215 offset:47104
    ds_read_b128 v[124:127], v215 offset:48128
    s_waitcnt lgkmcnt(4)
    v_mfma_f32_16x16x32_bf16 v[64:67], v[176:179], v[96:99], v[64:67]
    buffer_load_dwordx4 a[168:171], v212, s[16:19], s76 offen offset:3072
    v_mfma_f32_16x16x32_bf16 v[80:83], v[96:99], v[96:99], v[80:83]
    v_mfma_f32_16x16x32_bf16 v[68:71], v[176:179], v[100:103], v[68:71]
    v_mfma_f32_16x16x32_bf16 v[84:87], v[100:103], v[100:103], v[84:87]
    v_mfma_f32_16x16x32_bf16 v[72:75], v[176:179], v[104:107], v[72:75]
    v_mfma_f32_16x16x32_bf16 v[88:91], v[104:107], v[104:107], v[88:91]
    v_mfma_f32_16x16x32_bf16 v[76:79], v[176:179], v[108:111], v[76:79]
    v_mfma_f32_16x16x32_bf16 v[92:95], v[108:111], v[108:111], v[92:95]
    ds_read_b128 v[96:99], v214 offset:49152
    ds_read_b128 v[100:103], v214 offset:50176
    ds_read_b128 v[104:107], v214 offset:51200
    ds_read_b128 v[108:111], v214 offset:52224
    s_waitcnt lgkmcnt(4)
    v_mfma_f32_16x16x32_bf16 v[64:67], v[176:179], v[112:115], v[64:67]
    buffer_load_dwordx4 a[172:175], v212, s[16:19], s77 offen offset:3072
    v_mfma_f32_16x16x32_bf16 v[80:83], v[112:115], v[112:115], v[80:83]
    v_mfma_f32_16x16x32_bf16 v[68:71], v[176:179], v[116:119], v[68:71]
    v_mfma_f32_16x16x32_bf16 v[84:87], v[116:119], v[116:119], v[84:87]
    v_mfma_f32_16x16x32_bf16 v[72:75], v[176:179], v[120:123], v[72:75]
    v_mfma_f32_16x16x32_bf16 v[88:91], v[120:123], v[120:123], v[88:91]
    v_mfma_f32_16x16x32_bf16 v[76:79], v[176:179], v[124:127], v[76:79]
    v_mfma_f32_16x16x32_bf16 v[92:95], v[124:127], v[124:127], v[92:95]
    ds_read_b128 v[112:115], v215 offset:53248
    ds_read_b128 v[116:119], v215 offset:54272
    ds_read_b128 v[120:123], v215 offset:55296
    ds_read_b128 v[124:127], v215 offset:56320
    s_waitcnt lgkmcnt(4)
    v_mfma_f32_16x16x32_bf16 v[64:67], v[176:179], v[96:99], v[64:67]
    buffer_load_dwordx4 a[176:179], v212, s[16:19], s78 offen offset:3072
    v_mfma_f32_16x16x32_bf16 v[80:83], v[96:99], v[96:99], v[80:83]
    v_mfma_f32_16x16x32_bf16 v[68:71], v[176:179], v[100:103], v[68:71]
    v_mfma_f32_16x16x32_bf16 v[84:87], v[100:103], v[100:103], v[84:87]
    v_mfma_f32_16x16x32_bf16 v[72:75], v[176:179], v[104:107], v[72:75]
    v_mfma_f32_16x16x32_bf16 v[88:91], v[104:107], v[104:107], v[88:91]
    v_mfma_f32_16x16x32_bf16 v[76:79], v[176:179], v[108:111], v[76:79]
    v_mfma_f32_16x16x32_bf16 v[92:95], v[108:111], v[108:111], v[92:95]
    s_waitcnt vmcnt(11)
    s_barrier
    ds_read_b128 v[96:99], v214 offset:57344
    ds_read_b128 v[100:103], v214 offset:58368
    ds_read_b128 v[104:107], v214 offset:59392
    ds_read_b128 v[108:111], v214 offset:60416
    s_waitcnt lgkmcnt(4)
    v_mfma_f32_16x16x32_bf16 v[64:67], v[176:179], v[112:115], v[64:67]
    buffer_load_dwordx4 a[180:183], v212, s[16:19], s79 offen offset:3072
    v_mfma_f32_16x16x32_bf16 v[80:83], v[112:115], v[112:115], v[80:83]
    v_mfma_f32_16x16x32_bf16 v[68:71], v[176:179], v[116:119], v[68:71]
    v_mfma_f32_16x16x32_bf16 v[84:87], v[116:119], v[116:119], v[84:87]
    v_mfma_f32_16x16x32_bf16 v[72:75], v[176:179], v[120:123], v[72:75]
    v_mfma_f32_16x16x32_bf16 v[88:91], v[120:123], v[120:123], v[88:91]
    v_mfma_f32_16x16x32_bf16 v[76:79], v[176:179], v[124:127], v[76:79]
    v_mfma_f32_16x16x32_bf16 v[92:95], v[124:127], v[124:127], v[92:95]
    ds_read_b128 v[112:115], v215 offset:61440
    ds_read_b128 v[116:119], v215 offset:62464
    ds_read_b128 v[120:123], v215 offset:63488
    ds_read_b128 v[124:127], v215 offset:64512
    s_waitcnt lgkmcnt(4)
    v_mfma_f32_16x16x32_bf16 v[64:67], v[176:179], v[96:99], v[64:67]
    s_add_u32 s76, s30, 8192
    buffer_load_dwordx4 a[192:195], v212, s[16:19], s76 offen offset:0
    v_mfma_f32_16x16x32_bf16 v[80:83], v[96:99], v[96:99], v[80:83]
    v_mfma_f32_16x16x32_bf16 v[68:71], v[176:179], v[100:103], v[68:71]
    v_mfma_f32_16x16x32_bf16 v[84:87], v[100:103], v[100:103], v[84:87]
    v_mfma_f32_16x16x32_bf16 v[72:75], v[176:179], v[104:107], v[72:75]
    v_mfma_f32_16x16x32_bf16 v[88:91], v[104:107], v[104:107], v[88:91]
    v_mfma_f32_16x16x32_bf16 v[76:79], v[176:179], v[108:111], v[76:79]
    v_mfma_f32_16x16x32_bf16 v[92:95], v[108:111], v[108:111], v[92:95]
    ds_read_b128 v[96:99], v214 offset:8192
    ds_read_b128 v[100:103], v214 offset:9216
    ds_read_b128 v[104:107], v214 offset:10240
    ds_read_b128 v[108:111], v214 offset:11264
    s_waitcnt lgkmcnt(4)
    v_mfma_f32_16x16x32_bf16 v[64:67], v[176:179], v[112:115], v[64:67]
    s_add_u32 s77, s30, 24576
    buffer_load_dwordx4 a[196:199], v212, s[16:19], s77 offen offset:0
    v_mfma_f32_16x16x32_bf16 v[80:83], v[112:115], v[112:115], v[80:83]
    v_mfma_f32_16x16x32_bf16 v[68:71], v[176:179], v[116:119], v[68:71]
    v_mfma_f32_16x16x32_bf16 v[84:87], v[116:119], v[116:119], v[84:87]
    v_mfma_f32_16x16x32_bf16 v[72:75], v[176:179], v[120:123], v[72:75]
    v_mfma_f32_16x16x32_bf16 v[88:91], v[120:123], v[120:123], v[88:91]
    v_mfma_f32_16x16x32_bf16 v[76:79], v[176:179], v[124:127], v[76:79]
    v_mfma_f32_16x16x32_bf16 v[92:95], v[124:127], v[124:127], v[92:95]
    s_add_u32 s78, s30, 40960
    buffer_load_dwordx4 a[200:203], v212, s[16:19], s78 offen offset:0
    s_add_u32 s79, s30, 57344
    buffer_load_dwordx4 a[204:207], v212, s[16:19], s79 offen offset:0
    buffer_load_dwordx4 a[216:219], v212, s[16:19], s76 offen offset:1024
    buffer_load_dwordx4 a[220:223], v212, s[16:19], s77 offen offset:1024
    buffer_load_dwordx4 a[224:227], v212, s[16:19], s78 offen offset:1024
    buffer_load_dwordx4 a[228:231], v212, s[16:19], s79 offen offset:1024
    buffer_load_dwordx4 a[0:3], v212, s[16:19], s76 offen offset:2048
    buffer_load_dwordx4 a[4:7], v212, s[16:19], s77 offen offset:2048
    buffer_load_dwordx4 a[8:11], v212, s[16:19], s78 offen offset:2048
    buffer_load_dwordx4 a[12:15], v212, s[16:19], s79 offen offset:2048
    buffer_load_dwordx4 a[24:27], v212, s[16:19], s76 offen offset:3072
    buffer_load_dwordx4 a[28:31], v212, s[16:19], s77 offen offset:3072
    buffer_load_dwordx4 a[32:35], v212, s[16:19], s78 offen offset:3072
    buffer_load_dwordx4 a[36:39], v212, s[16:19], s79 offen offset:3072
    v_and_b32 v180, 3, v209
    v_lshrrev_b32 v181, 2, v209
    v_cmp_eq_u32 s[4:5], v181, v210
    v_cmp_eq_u32 s[38:39], 1, v180
    v_cmp_eq_u32 s[34:35], 2, v180
    v_cmp_eq_u32 vcc, 3, v180
    v_lshlrev_b32 v182, 2, v209
    v_add_u32 v182, 65536, v182
    v_cndmask_b32 v183, v80, v81, s[38:39]
    v_cndmask_b32 v183, v183, v82, s[34:35]
    v_cndmask_b32 v183, v183, v83, vcc
    v_mul_f32 v184, 0x3b000000, v64
    v_mul_f32 v183, 0x3b000000, v183
    v_fma_f32 v183, -v184, v184, v183
    v_max_f32 v183, 0, v183
    v_add_f32 v183, 0x3727c5ac, v183
    v_rsq_f32 v185, v183
    v_cndmask_b32 v183, v84, v85, s[38:39]
    v_cndmask_b32 v183, v183, v86, s[34:35]
    v_cndmask_b32 v183, v183, v87, vcc
    v_mul_f32 v186, 0x3b000000, v68
    v_mul_f32 v183, 0x3b000000, v183
    v_fma_f32 v183, -v186, v186, v183
    v_max_f32 v183, 0, v183
    v_add_f32 v183, 0x3727c5ac, v183
    v_rsq_f32 v187, v183
    v_cndmask_b32 v183, v88, v89, s[38:39]
    v_cndmask_b32 v183, v183, v90, s[34:35]
    v_cndmask_b32 v183, v183, v91, vcc
    v_mul_f32 v188, 0x3b000000, v72
    v_mul_f32 v183, 0x3b000000, v183
    v_fma_f32 v183, -v188, v188, v183
    v_max_f32 v183, 0, v183
    v_add_f32 v183, 0x3727c5ac, v183
    v_rsq_f32 v189, v183
    v_cndmask_b32 v183, v92, v93, s[38:39]
    v_cndmask_b32 v183, v183, v94, s[34:35]
    v_cndmask_b32 v183, v183, v95, vcc
    v_mul_f32 v190, 0x3b000000, v76
    v_mul_f32 v183, 0x3b000000, v183
    v_fma_f32 v183, -v190, v190, v183
    v_max_f32 v183, 0, v183
    v_add_f32 v183, 0x3727c5ac, v183
    v_rsq_f32 v191, v183
    s_mov_b64 exec, s[4:5]
    ds_write2_b32 v182, v184, v185 offset0:0 offset1:64
    ds_write2_b32 v182, v186, v187 offset0:16 offset1:80
    ds_write2_b32 v182, v188, v189 offset0:32 offset1:96
    ds_write2_b32 v182, v190, v191 offset0:48 offset1:112
    s_mov_b64 exec, -1
    s_waitcnt lgkmcnt(0)
    s_barrier
    v_mfma_f32_16x16x32_bf16 v[0:3], a[48:51], v[96:99], v[0:3]
    ds_read_b128 v[112:115], v215 offset:12288
    ds_read_b128 v[116:119], v215 offset:13312
    ds_read_b128 v[120:123], v215 offset:14336
    ds_read_b128 v[124:127], v215 offset:15360
    v_mfma_f32_16x16x32_bf16 v[4:7], a[48:51], v[100:103], v[4:7]
    s_add_u32 s12, s6, 16384
    s_addc_u32 s13, s7, 0
    s_mov_b32 s14, 22528
    s_mov_b32 s15, 0x00020000
    s_add_u32 s8, s6, 13238272
    s_addc_u32 s9, s7, 0
    v_mfma_f32_16x16x32_bf16 v[8:11], a[48:51], v[104:107], v[8:11]
    s_mov_b32 s10, 5767168
    s_mov_b32 s11, 0x00020000
    s_add_u32 s48, s6, 9568256
    s_addc_u32 s49, s7, 0
    s_mov_b32 s50, 1441792
    v_mfma_f32_16x16x32_bf16 v[12:15], a[48:51], v[108:111], v[12:15]
    s_mov_b32 s51, 0x00020000
    s_lshl_b32 s40, s29, 8
    v_lshrrev_b32 v219, 2, v212
    s_mul_i32 s41, s21, 88
    v_mfma_f32_16x16x32_bf16 v[16:19], a[52:55], v[96:99], v[16:19]
    s_mul_i32 s82, s22, 3
    s_add_u32 s82, s82, s25
    s_lshr_b32 s83, s82, 1
    s_and_b32 s82, s82, 1
    v_mfma_f32_16x16x32_bf16 v[20:23], a[52:55], v[100:103], v[20:23]
    s_add_u32 s82, s82, s41
    s_mul_i32 s32, s83, 43
    s_lshr_b32 s32, s32, 7
    v_mfma_f32_16x16x32_bf16 v[24:27], a[52:55], v[104:107], v[24:27]
    s_lshl_b32 s32, s32, 3
    s_add_u32 s83, s83, s32
    s_add_u32 s83, s83, 8
    s_lshl_b32 s83, s83, 1
    v_mfma_f32_16x16x32_bf16 v[28:31], a[52:55], v[108:111], v[28:31]
    s_add_u32 s83, s83, s82
    s_lshl_b32 s83, s83, 11
    s_mul_i32 s82, s25, 22
    s_add_u32 s41, s41, s82
    v_mfma_f32_16x16x32_bf16 v[32:35], a[56:59], v[96:99], v[32:35]
    s_lshl_b32 s82, s22, 1
    s_add_u32 s41, s41, s82
    s_lshl_b32 s41, s41, 11
    s_mul_i32 s27, s25, 11
    v_mfma_f32_16x16x32_bf16 v[36:39], a[56:59], v[100:103], v[36:39]
    s_mul_i32 s28, s22, 44
    s_add_u32 s28, s28, s27
    s_lshl_b32 s28, s28, 12
    s_mul_i32 s32, s21, 44
    v_mfma_f32_16x16x32_bf16 v[40:43], a[56:59], v[104:107], v[40:43]
    s_add_u32 s27, s27, s32
    s_lshl_b32 s27, s27, 12
    s_lshl_b32 s64, s22, 12
    v_mfma_f32_16x16x32_bf16 v[44:47], a[56:59], v[108:111], v[44:47]
    s_movk_i32 s65, 4096
    s_cmp_gt_u32 s22, 0
    s_cselect_b32 s65, 0, s65
    s_movk_i32 s66, 8192
    s_cmp_gt_u32 s22, 1
    s_cselect_b32 s66, 4096, s66
    v_mfma_f32_16x16x32_bf16 v[48:51], a[60:63], v[96:99], v[48:51]
    s_movk_i32 s67, 12288
    s_cmp_gt_u32 s22, 2
    s_cselect_b32 s67, 8192, s67
    s_movk_i32 s68, 16384
    s_cmp_gt_u32 s22, 3
    s_cselect_b32 s68, 12288, s68
    v_mfma_f32_16x16x32_bf16 v[52:55], a[60:63], v[100:103], v[52:55]
    s_movk_i32 s69, 20480
    s_cmp_gt_u32 s22, 4
    s_cselect_b32 s69, 16384, s69
    s_movk_i32 s70, 24576
    s_cmp_gt_u32 s22, 5
    s_cselect_b32 s70, 20480, s70
    v_mfma_f32_16x16x32_bf16 v[56:59], a[60:63], v[104:107], v[56:59]
    s_movk_i32 s71, 28672
    s_cmp_gt_u32 s22, 6
    s_cselect_b32 s71, 24576, s71
    s_mov_b32 s72, 32768
    s_mov_b32 s73, 36864
    v_mfma_f32_16x16x32_bf16 v[60:63], a[60:63], v[108:111], v[60:63]
    s_mov_b32 s74, 40960
    buffer_load_dword v232, v219, s[12:15], s40 offen offset:0
    buffer_load_dword v233, v219, s[12:15], s40 offen offset:256
    s_waitcnt lgkmcnt(0)
    v_mfma_f32_16x16x32_bf16 v[0:3], a[72:75], v[112:115], v[0:3]
    ds_read_b128 v[96:99], v214 offset:16384
    v_mfma_f32_16x16x32_bf16 v[4:7], a[72:75], v[116:119], v[4:7]
    v_mfma_f32_16x16x32_bf16 v[8:11], a[72:75], v[120:123], v[8:11]
    s_add_u32 s76, s30, 12288
    buffer_load_dwordx4 a[48:51], v212, s[16:19], s76 offen offset:0
    v_mfma_f32_16x16x32_bf16 v[12:15], a[72:75], v[124:127], v[12:15]
    v_mfma_f32_16x16x32_bf16 v[16:19], a[76:79], v[112:115], v[16:19]
    ds_read_b128 v[100:103], v214 offset:17408
    v_mfma_f32_16x16x32_bf16 v[20:23], a[76:79], v[116:119], v[20:23]
    v_mfma_f32_16x16x32_bf16 v[24:27], a[76:79], v[120:123], v[24:27]
    s_add_u32 s77, s30, 28672
    buffer_load_dwordx4 a[52:55], v212, s[16:19], s77 offen offset:0
    v_mfma_f32_16x16x32_bf16 v[28:31], a[76:79], v[124:127], v[28:31]
    v_mfma_f32_16x16x32_bf16 v[32:35], a[80:83], v[112:115], v[32:35]
    ds_read_b128 v[104:107], v214 offset:18432
    v_mfma_f32_16x16x32_bf16 v[36:39], a[80:83], v[116:119], v[36:39]
    v_mfma_f32_16x16x32_bf16 v[40:43], a[80:83], v[120:123], v[40:43]
    s_add_u32 s78, s30, 45056
    buffer_load_dwordx4 a[56:59], v212, s[16:19], s78 offen offset:0
    v_mfma_f32_16x16x32_bf16 v[44:47], a[80:83], v[124:127], v[44:47]
    v_mfma_f32_16x16x32_bf16 v[48:51], a[84:87], v[112:115], v[48:51]
    ds_read_b128 v[108:111], v214 offset:19456
    v_mfma_f32_16x16x32_bf16 v[52:55], a[84:87], v[116:119], v[52:55]
    v_mfma_f32_16x16x32_bf16 v[56:59], a[84:87], v[120:123], v[56:59]
    s_add_u32 s79, s30, 61440
    buffer_load_dwordx4 a[60:63], v212, s[16:19], s79 offen offset:0
    v_mfma_f32_16x16x32_bf16 v[60:63], a[84:87], v[124:127], v[60:63]
    s_waitcnt lgkmcnt(0)
    v_mfma_f32_16x16x32_bf16 v[0:3], a[96:99], v[96:99], v[0:3]
    ds_read_b128 v[112:115], v215 offset:20480
    v_mfma_f32_16x16x32_bf16 v[4:7], a[96:99], v[100:103], v[4:7]
    v_mfma_f32_16x16x32_bf16 v[8:11], a[96:99], v[104:107], v[8:11]
    buffer_load_dwordx4 a[72:75], v212, s[16:19], s76 offen offset:1024
    v_mfma_f32_16x16x32_bf16 v[12:15], a[96:99], v[108:111], v[12:15]
    v_mfma_f32_16x16x32_bf16 v[16:19], a[100:103], v[96:99], v[16:19]
    ds_read_b128 v[116:119], v215 offset:21504
    v_mfma_f32_16x16x32_bf16 v[20:23], a[100:103], v[100:103], v[20:23]
    v_mfma_f32_16x16x32_bf16 v[24:27], a[100:103], v[104:107], v[24:27]
    buffer_load_dwordx4 a[76:79], v212, s[16:19], s77 offen offset:1024
    v_mfma_f32_16x16x32_bf16 v[28:31], a[100:103], v[108:111], v[28:31]
    v_mfma_f32_16x16x32_bf16 v[32:35], a[104:107], v[96:99], v[32:35]
    ds_read_b128 v[120:123], v215 offset:22528
    v_mfma_f32_16x16x32_bf16 v[36:39], a[104:107], v[100:103], v[36:39]
    v_mfma_f32_16x16x32_bf16 v[40:43], a[104:107], v[104:107], v[40:43]
    buffer_load_dwordx4 a[80:83], v212, s[16:19], s78 offen offset:1024
    v_mfma_f32_16x16x32_bf16 v[44:47], a[104:107], v[108:111], v[44:47]
    v_mfma_f32_16x16x32_bf16 v[48:51], a[108:111], v[96:99], v[48:51]
    ds_read_b128 v[124:127], v215 offset:23552
    v_mfma_f32_16x16x32_bf16 v[52:55], a[108:111], v[100:103], v[52:55]
    v_mfma_f32_16x16x32_bf16 v[56:59], a[108:111], v[104:107], v[56:59]
    buffer_load_dwordx4 a[84:87], v212, s[16:19], s79 offen offset:1024
    v_mfma_f32_16x16x32_bf16 v[60:63], a[108:111], v[108:111], v[60:63]
    s_waitcnt vmcnt(34)
    s_waitcnt lgkmcnt(0)
    v_mfma_f32_16x16x32_bf16 v[0:3], a[120:123], v[112:115], v[0:3]
    ds_read_b128 v[96:99], v214 offset:24576
    v_mfma_f32_16x16x32_bf16 v[4:7], a[120:123], v[116:119], v[4:7]
    v_mfma_f32_16x16x32_bf16 v[8:11], a[120:123], v[120:123], v[8:11]
    buffer_load_dwordx4 a[96:99], v212, s[16:19], s76 offen offset:2048
    v_mfma_f32_16x16x32_bf16 v[12:15], a[120:123], v[124:127], v[12:15]
    v_mfma_f32_16x16x32_bf16 v[16:19], a[124:127], v[112:115], v[16:19]
    ds_read_b128 v[100:103], v214 offset:25600
    v_mfma_f32_16x16x32_bf16 v[20:23], a[124:127], v[116:119], v[20:23]
    v_mfma_f32_16x16x32_bf16 v[24:27], a[124:127], v[120:123], v[24:27]
    buffer_load_dwordx4 a[100:103], v212, s[16:19], s77 offen offset:2048
    v_mfma_f32_16x16x32_bf16 v[28:31], a[124:127], v[124:127], v[28:31]
    v_mfma_f32_16x16x32_bf16 v[32:35], a[128:131], v[112:115], v[32:35]
    ds_read_b128 v[104:107], v214 offset:26624
    v_mfma_f32_16x16x32_bf16 v[36:39], a[128:131], v[116:119], v[36:39]
    v_mfma_f32_16x16x32_bf16 v[40:43], a[128:131], v[120:123], v[40:43]
    buffer_load_dwordx4 a[104:107], v212, s[16:19], s78 offen offset:2048
    v_mfma_f32_16x16x32_bf16 v[44:47], a[128:131], v[124:127], v[44:47]
    v_mfma_f32_16x16x32_bf16 v[48:51], a[132:135], v[112:115], v[48:51]
    ds_read_b128 v[108:111], v214 offset:27648
    v_mfma_f32_16x16x32_bf16 v[52:55], a[132:135], v[116:119], v[52:55]
    v_mfma_f32_16x16x32_bf16 v[56:59], a[132:135], v[120:123], v[56:59]
    buffer_load_dwordx4 a[108:111], v212, s[16:19], s79 offen offset:2048
    v_mfma_f32_16x16x32_bf16 v[60:63], a[132:135], v[124:127], v[60:63]
    s_waitcnt vmcnt(34)
    s_waitcnt lgkmcnt(0)
    v_mfma_f32_16x16x32_bf16 v[0:3], a[144:147], v[96:99], v[0:3]
    ds_read_b128 v[112:115], v215 offset:28672
    v_mfma_f32_16x16x32_bf16 v[4:7], a[144:147], v[100:103], v[4:7]
    buffer_load_dwordx4 a[120:123], v212, s[16:19], s76 offen offset:3072
    v_mfma_f32_16x16x32_bf16 v[8:11], a[144:147], v[104:107], v[8:11]
    v_mfma_f32_16x16x32_bf16 v[12:15], a[144:147], v[108:111], v[12:15]
    buffer_load_dwordx4 a[124:127], v212, s[16:19], s77 offen offset:3072
    v_mfma_f32_16x16x32_bf16 v[16:19], a[148:151], v[96:99], v[16:19]
    ds_read_b128 v[116:119], v215 offset:29696
    v_mfma_f32_16x16x32_bf16 v[20:23], a[148:151], v[100:103], v[20:23]
    v_mfma_f32_16x16x32_bf16 v[24:27], a[148:151], v[104:107], v[24:27]
    buffer_load_dwordx4 a[128:131], v212, s[16:19], s78 offen offset:3072
    v_mfma_f32_16x16x32_bf16 v[28:31], a[148:151], v[108:111], v[28:31]
    v_mfma_f32_16x16x32_bf16 v[32:35], a[152:155], v[96:99], v[32:35]
    ds_read_b128 v[120:123], v215 offset:30720
    v_mfma_f32_16x16x32_bf16 v[36:39], a[152:155], v[100:103], v[36:39]
    buffer_load_dwordx4 a[132:135], v212, s[16:19], s79 offen offset:3072
    v_mfma_f32_16x16x32_bf16 v[40:43], a[152:155], v[104:107], v[40:43]
    v_mfma_f32_16x16x32_bf16 v[44:47], a[152:155], v[108:111], v[44:47]
    s_add_u32 s31, s28, s64
    buffer_load_dwordx4 a[240:243], v212, s[48:51], s31 offen offset:0
    v_mfma_f32_16x16x32_bf16 v[48:51], a[156:159], v[96:99], v[48:51]
    ds_read_b128 v[124:127], v215 offset:31744
    v_mfma_f32_16x16x32_bf16 v[52:55], a[156:159], v[100:103], v[52:55]
    v_mfma_f32_16x16x32_bf16 v[56:59], a[156:159], v[104:107], v[56:59]
    buffer_load_dwordx4 a[244:247], v212, s[48:51], s31 offen offset:1024
    v_mfma_f32_16x16x32_bf16 v[60:63], a[156:159], v[108:111], v[60:63]
    s_waitcnt vmcnt(36)
    s_waitcnt lgkmcnt(0)
    v_mfma_f32_16x16x32_bf16 v[0:3], a[168:171], v[112:115], v[0:3]
    ds_read_b128 v[96:99], v214 offset:32768
    v_mfma_f32_16x16x32_bf16 v[4:7], a[168:171], v[116:119], v[4:7]
    buffer_load_dwordx4 a[248:251], v212, s[48:51], s31 offen offset:2048
    v_mfma_f32_16x16x32_bf16 v[8:11], a[168:171], v[120:123], v[8:11]
    v_mfma_f32_16x16x32_bf16 v[12:15], a[168:171], v[124:127], v[12:15]
    buffer_load_dwordx4 a[252:255], v212, s[48:51], s31 offen offset:3072
    v_mfma_f32_16x16x32_bf16 v[16:19], a[172:175], v[112:115], v[16:19]
    ds_read_b128 v[100:103], v214 offset:33792
    v_mfma_f32_16x16x32_bf16 v[20:23], a[172:175], v[116:119], v[20:23]
    v_mfma_f32_16x16x32_bf16 v[24:27], a[172:175], v[120:123], v[24:27]
    s_add_u32 s31, s28, s65
    buffer_load_dwordx4 a[16:19], v212, s[48:51], s31 offen offset:0
    v_mfma_f32_16x16x32_bf16 v[28:31], a[172:175], v[124:127], v[28:31]
    v_mfma_f32_16x16x32_bf16 v[32:35], a[176:179], v[112:115], v[32:35]
    ds_read_b128 v[104:107], v214 offset:34816
    v_mfma_f32_16x16x32_bf16 v[36:39], a[176:179], v[116:119], v[36:39]
    buffer_load_dwordx4 a[20:23], v212, s[48:51], s31 offen offset:1024
    v_mfma_f32_16x16x32_bf16 v[40:43], a[176:179], v[120:123], v[40:43]
    v_mfma_f32_16x16x32_bf16 v[44:47], a[176:179], v[124:127], v[44:47]
    buffer_load_dwordx4 a[40:43], v212, s[48:51], s31 offen offset:2048
    v_mfma_f32_16x16x32_bf16 v[48:51], a[180:183], v[112:115], v[48:51]
    ds_read_b128 v[108:111], v214 offset:35840
    v_mfma_f32_16x16x32_bf16 v[52:55], a[180:183], v[116:119], v[52:55]
    v_mfma_f32_16x16x32_bf16 v[56:59], a[180:183], v[120:123], v[56:59]
    buffer_load_dwordx4 a[44:47], v212, s[48:51], s31 offen offset:3072
    v_mfma_f32_16x16x32_bf16 v[60:63], a[180:183], v[124:127], v[60:63]
    s_waitcnt vmcnt(38)
    s_waitcnt lgkmcnt(0)
    v_mfma_f32_16x16x32_bf16 v[0:3], a[192:195], v[96:99], v[0:3]
    ds_read_b128 v[112:115], v215 offset:36864
    v_mfma_f32_16x16x32_bf16 v[4:7], a[192:195], v[100:103], v[4:7]
    s_add_u32 s31, s28, s66
    buffer_load_dwordx4 a[64:67], v212, s[48:51], s31 offen offset:0
    v_mfma_f32_16x16x32_bf16 v[8:11], a[192:195], v[104:107], v[8:11]
    v_mfma_f32_16x16x32_bf16 v[12:15], a[192:195], v[108:111], v[12:15]
    buffer_load_dwordx4 a[68:71], v212, s[48:51], s31 offen offset:1024
    v_mfma_f32_16x16x32_bf16 v[16:19], a[196:199], v[96:99], v[16:19]
    ds_read_b128 v[116:119], v215 offset:37888
    v_mfma_f32_16x16x32_bf16 v[20:23], a[196:199], v[100:103], v[20:23]
    v_mfma_f32_16x16x32_bf16 v[24:27], a[196:199], v[104:107], v[24:27]
    buffer_load_dwordx4 a[88:91], v212, s[48:51], s31 offen offset:2048
    v_mfma_f32_16x16x32_bf16 v[28:31], a[196:199], v[108:111], v[28:31]
    v_mfma_f32_16x16x32_bf16 v[32:35], a[200:203], v[96:99], v[32:35]
    ds_read_b128 v[120:123], v215 offset:38912
    v_mfma_f32_16x16x32_bf16 v[36:39], a[200:203], v[100:103], v[36:39]
    buffer_load_dwordx4 a[92:95], v212, s[48:51], s31 offen offset:3072
    v_mfma_f32_16x16x32_bf16 v[40:43], a[200:203], v[104:107], v[40:43]
    v_mfma_f32_16x16x32_bf16 v[44:47], a[200:203], v[108:111], v[44:47]
    s_add_u32 s31, s28, s67
    buffer_load_dwordx4 a[112:115], v212, s[48:51], s31 offen offset:0
    v_mfma_f32_16x16x32_bf16 v[48:51], a[204:207], v[96:99], v[48:51]
    ds_read_b128 v[124:127], v215 offset:39936
    v_mfma_f32_16x16x32_bf16 v[52:55], a[204:207], v[100:103], v[52:55]
    v_mfma_f32_16x16x32_bf16 v[56:59], a[204:207], v[104:107], v[56:59]
    buffer_load_dwordx4 a[116:119], v212, s[48:51], s31 offen offset:1024
    v_mfma_f32_16x16x32_bf16 v[60:63], a[204:207], v[108:111], v[60:63]
    s_waitcnt vmcnt(40)
    s_waitcnt lgkmcnt(0)
    v_mfma_f32_16x16x32_bf16 v[0:3], a[216:219], v[112:115], v[0:3]
    ds_read_b128 v[96:99], v214 offset:40960
    buffer_load_dwordx4 a[136:139], v212, s[48:51], s31 offen offset:2048
    ds_read_b128 v[100:103], v214 offset:41984
    v_mfma_f32_16x16x32_bf16 v[4:7], a[216:219], v[116:119], v[4:7]
    ds_read_b128 v[104:107], v214 offset:43008
    ds_read_b128 v[108:111], v214 offset:44032
    v_mfma_f32_16x16x32_bf16 v[8:11], a[216:219], v[120:123], v[8:11]
    s_waitcnt vmcnt(31)
    v_mov_b32_dpp v128, v232 row_newbcast:0 row_mask:0xf bank_mask:0xf
    buffer_load_dwordx4 a[140:143], v212, s[48:51], s31 offen offset:3072
    v_mfma_f32_16x16x32_bf16 v[12:15], a[216:219], v[124:127], v[12:15]
    v_mov_b32_dpp v129, v232 row_newbcast:1 row_mask:0xf bank_mask:0xf
    v_mov_b32_dpp v130, v232 row_newbcast:2 row_mask:0xf bank_mask:0xf
    v_mfma_f32_16x16x32_bf16 v[16:19], a[220:223], v[112:115], v[16:19]
    v_mov_b32_dpp v131, v232 row_newbcast:3 row_mask:0xf bank_mask:0xf
    v_mov_b32_dpp v132, v232 row_newbcast:4 row_mask:0xf bank_mask:0xf
    v_mfma_f32_16x16x32_bf16 v[20:23], a[220:223], v[116:119], v[20:23]
    v_mov_b32_dpp v133, v232 row_newbcast:5 row_mask:0xf bank_mask:0xf
    s_add_u32 s31, s28, s68
    buffer_load_dwordx4 a[160:163], v212, s[48:51], s31 offen offset:0
    v_mfma_f32_16x16x32_bf16 v[24:27], a[220:223], v[120:123], v[24:27]
    v_mov_b32_dpp v134, v232 row_newbcast:6 row_mask:0xf bank_mask:0xf
    v_mov_b32_dpp v135, v232 row_newbcast:7 row_mask:0xf bank_mask:0xf
    v_mfma_f32_16x16x32_bf16 v[28:31], a[220:223], v[124:127], v[28:31]
    v_mov_b32_dpp v136, v232 row_newbcast:8 row_mask:0xf bank_mask:0xf
    v_mov_b32_dpp v137, v232 row_newbcast:9 row_mask:0xf bank_mask:0xf
    v_mfma_f32_16x16x32_bf16 v[32:35], a[224:227], v[112:115], v[32:35]
    v_mov_b32_dpp v138, v232 row_newbcast:10 row_mask:0xf bank_mask:0xf
    buffer_load_dwordx4 a[164:167], v212, s[48:51], s31 offen offset:1024
    v_mov_b32_dpp v139, v232 row_newbcast:11 row_mask:0xf bank_mask:0xf
    v_mfma_f32_16x16x32_bf16 v[36:39], a[224:227], v[116:119], v[36:39]
    v_mov_b32_dpp v140, v232 row_newbcast:12 row_mask:0xf bank_mask:0xf
    v_mov_b32_dpp v141, v232 row_newbcast:13 row_mask:0xf bank_mask:0xf
    v_mfma_f32_16x16x32_bf16 v[40:43], a[224:227], v[120:123], v[40:43]
    v_mov_b32_dpp v142, v232 row_newbcast:14 row_mask:0xf bank_mask:0xf
    buffer_load_dwordx4 a[184:187], v212, s[48:51], s31 offen offset:2048
    v_mfma_f32_16x16x32_bf16 v[44:47], a[224:227], v[124:127], v[44:47]
    v_mov_b32_dpp v143, v232 row_newbcast:15 row_mask:0xf bank_mask:0xf
    v_mov_b32_dpp v144, v233 row_newbcast:0 row_mask:0xf bank_mask:0xf
    v_mfma_f32_16x16x32_bf16 v[48:51], a[228:231], v[112:115], v[48:51]
    v_mov_b32_dpp v145, v233 row_newbcast:1 row_mask:0xf bank_mask:0xf
    v_mov_b32_dpp v146, v233 row_newbcast:2 row_mask:0xf bank_mask:0xf
    v_mfma_f32_16x16x32_bf16 v[52:55], a[228:231], v[116:119], v[52:55]
    v_mov_b32_dpp v147, v233 row_newbcast:3 row_mask:0xf bank_mask:0xf
    buffer_load_dwordx4 a[188:191], v212, s[48:51], s31 offen offset:3072
    v_mfma_f32_16x16x32_bf16 v[56:59], a[228:231], v[120:123], v[56:59]
    v_mov_b32_dpp v148, v233 row_newbcast:4 row_mask:0xf bank_mask:0xf
    v_mov_b32_dpp v149, v233 row_newbcast:5 row_mask:0xf bank_mask:0xf
    v_mfma_f32_16x16x32_bf16 v[60:63], a[228:231], v[124:127], v[60:63]
    v_mov_b32_dpp v150, v233 row_newbcast:6 row_mask:0xf bank_mask:0xf
    v_mov_b32_dpp v151, v233 row_newbcast:7 row_mask:0xf bank_mask:0xf
    s_waitcnt lgkmcnt(0)
    v_mfma_f32_16x16x32_bf16 v[0:3], a[0:3], v[96:99], v[0:3]
    ds_read_b128 v[112:115], v215 offset:45056
    s_add_u32 s31, s28, s69
    buffer_load_dwordx4 a[208:211], v212, s[48:51], s31 offen offset:0
    v_mfma_f32_16x16x32_bf16 v[4:7], a[0:3], v[100:103], v[4:7]
    ds_read_b128 v[116:119], v215 offset:46080
    v_mfma_f32_16x16x32_bf16 v[8:11], a[0:3], v[104:107], v[8:11]
    ds_read_b128 v[120:123], v215 offset:47104
    v_mfma_f32_16x16x32_bf16 v[12:15], a[0:3], v[108:111], v[12:15]
    buffer_load_dwordx4 a[212:215], v212, s[48:51], s31 offen offset:1024
    v_mfma_f32_16x16x32_bf16 v[16:19], a[4:7], v[96:99], v[16:19]
    ds_read_b128 v[124:127], v215 offset:48128
    v_mfma_f32_16x16x32_bf16 v[20:23], a[4:7], v[100:103], v[20:23]
    v_mov_b32_dpp v152, v233 row_newbcast:8 row_mask:0xf bank_mask:0xf
    v_mfma_f32_16x16x32_bf16 v[24:27], a[4:7], v[104:107], v[24:27]
    buffer_load_dwordx4 a[232:235], v212, s[48:51], s31 offen offset:2048
    v_mfma_f32_16x16x32_bf16 v[28:31], a[4:7], v[108:111], v[28:31]
    v_mov_b32_dpp v153, v233 row_newbcast:9 row_mask:0xf bank_mask:0xf
    v_mfma_f32_16x16x32_bf16 v[32:35], a[8:11], v[96:99], v[32:35]
    v_mov_b32_dpp v154, v233 row_newbcast:10 row_mask:0xf bank_mask:0xf
    buffer_load_dwordx4 a[236:239], v212, s[48:51], s31 offen offset:3072
    v_mfma_f32_16x16x32_bf16 v[36:39], a[8:11], v[100:103], v[36:39]
    v_mov_b32_dpp v155, v233 row_newbcast:11 row_mask:0xf bank_mask:0xf
    v_mfma_f32_16x16x32_bf16 v[40:43], a[8:11], v[104:107], v[40:43]
    v_mov_b32_dpp v156, v233 row_newbcast:12 row_mask:0xf bank_mask:0xf
    v_mfma_f32_16x16x32_bf16 v[44:47], a[8:11], v[108:111], v[44:47]
    s_add_u32 s31, s28, s70
    buffer_load_dwordx4 a[144:147], v212, s[48:51], s31 offen offset:0
    v_mfma_f32_16x16x32_bf16 v[48:51], a[12:15], v[96:99], v[48:51]
    v_mov_b32_dpp v157, v233 row_newbcast:13 row_mask:0xf bank_mask:0xf
    v_mfma_f32_16x16x32_bf16 v[52:55], a[12:15], v[100:103], v[52:55]
    v_mov_b32_dpp v158, v233 row_newbcast:14 row_mask:0xf bank_mask:0xf
    v_mfma_f32_16x16x32_bf16 v[56:59], a[12:15], v[104:107], v[56:59]
    buffer_load_dwordx4 a[148:151], v212, s[48:51], s31 offen offset:1024
    v_mfma_f32_16x16x32_bf16 v[60:63], a[12:15], v[108:111], v[60:63]
    v_mov_b32_dpp v159, v233 row_newbcast:15 row_mask:0xf bank_mask:0xf
    s_waitcnt lgkmcnt(0)
    v_mfma_f32_16x16x32_bf16 v[0:3], a[24:27], v[112:115], v[0:3]
    ds_read_b128 v[96:99], v214 offset:49152
    v_mfma_f32_16x16x32_bf16 v[4:7], a[24:27], v[116:119], v[4:7]
    buffer_load_dwordx4 a[152:155], v212, s[48:51], s31 offen offset:2048
    v_mfma_f32_16x16x32_bf16 v[8:11], a[24:27], v[120:123], v[8:11]
    ds_read_b128 v[100:103], v214 offset:50176
    v_mfma_f32_16x16x32_bf16 v[12:15], a[24:27], v[124:127], v[12:15]
    buffer_load_dwordx4 a[156:159], v212, s[48:51], s31 offen offset:3072
    v_mfma_f32_16x16x32_bf16 v[16:19], a[28:31], v[112:115], v[16:19]
    ds_read_b128 v[104:107], v214 offset:51200
    v_mfma_f32_16x16x32_bf16 v[20:23], a[28:31], v[116:119], v[20:23]
    ds_read_b128 v[108:111], v214 offset:52224
    v_mfma_f32_16x16x32_bf16 v[24:27], a[28:31], v[120:123], v[24:27]
    s_add_u32 s31, s28, s71
    buffer_load_dwordx4 a[168:171], v212, s[48:51], s31 offen offset:0
    v_mfma_f32_16x16x32_bf16 v[28:31], a[28:31], v[124:127], v[28:31]
    v_lshlrev_b32 v218, 2, v209
    v_mfma_f32_16x16x32_bf16 v[32:35], a[32:35], v[112:115], v[32:35]
    v_add_u32 v218, 65536, v218
    v_mfma_f32_16x16x32_bf16 v[36:39], a[32:35], v[116:119], v[36:39]
    buffer_load_dwordx4 a[172:175], v212, s[48:51], s31 offen offset:1024
    v_mfma_f32_16x16x32_bf16 v[40:43], a[32:35], v[120:123], v[40:43]
    ds_read2_b32 v[224:225], v218 offset0:0 offset1:64
    v_mfma_f32_16x16x32_bf16 v[44:47], a[32:35], v[124:127], v[44:47]
    buffer_load_dwordx4 a[176:179], v212, s[48:51], s31 offen offset:2048
    v_mfma_f32_16x16x32_bf16 v[48:51], a[36:39], v[112:115], v[48:51]
    ds_read2_b32 v[226:227], v218 offset0:16 offset1:80
    v_mfma_f32_16x16x32_bf16 v[52:55], a[36:39], v[116:119], v[52:55]
    ds_read2_b32 v[228:229], v218 offset0:32 offset1:96
    v_mfma_f32_16x16x32_bf16 v[56:59], a[36:39], v[120:123], v[56:59]
    buffer_load_dwordx4 a[180:183], v212, s[48:51], s31 offen offset:3072
    v_mfma_f32_16x16x32_bf16 v[60:63], a[36:39], v[124:127], v[60:63]
    ds_read2_b32 v[230:231], v218 offset0:48 offset1:112
    s_waitcnt vmcnt(44)
    s_waitcnt lgkmcnt(4)
    v_mfma_f32_16x16x32_bf16 v[0:3], a[48:51], v[96:99], v[0:3]
    s_add_u32 s31, s28, s72
    buffer_load_dwordx4 a[192:195], v212, s[48:51], s31 offen offset:0
    v_mfma_f32_16x16x32_bf16 v[4:7], a[48:51], v[100:103], v[4:7]
    v_mfma_f32_16x16x32_bf16 v[8:11], a[48:51], v[104:107], v[8:11]
    buffer_load_dwordx4 a[196:199], v212, s[48:51], s31 offen offset:1024
    v_mfma_f32_16x16x32_bf16 v[12:15], a[48:51], v[108:111], v[12:15]
    v_mfma_f32_16x16x32_bf16 v[16:19], a[52:55], v[96:99], v[16:19]
    v_mfma_f32_16x16x32_bf16 v[20:23], a[52:55], v[100:103], v[20:23]
    buffer_load_dwordx4 a[200:203], v212, s[48:51], s31 offen offset:2048
    v_mfma_f32_16x16x32_bf16 v[24:27], a[52:55], v[104:107], v[24:27]
    v_mfma_f32_16x16x32_bf16 v[28:31], a[52:55], v[108:111], v[28:31]
    v_mfma_f32_16x16x32_bf16 v[32:35], a[56:59], v[96:99], v[32:35]
    buffer_load_dwordx4 a[204:207], v212, s[48:51], s31 offen offset:3072
    v_mfma_f32_16x16x32_bf16 v[36:39], a[56:59], v[100:103], v[36:39]
    v_mfma_f32_16x16x32_bf16 v[40:43], a[56:59], v[104:107], v[40:43]
    s_add_u32 s31, s28, s73
    buffer_load_dwordx4 a[216:219], v212, s[48:51], s31 offen offset:0
    v_mfma_f32_16x16x32_bf16 v[44:47], a[56:59], v[108:111], v[44:47]
    v_mfma_f32_16x16x32_bf16 v[48:51], a[60:63], v[96:99], v[48:51]
    v_mfma_f32_16x16x32_bf16 v[52:55], a[60:63], v[100:103], v[52:55]
    buffer_load_dwordx4 a[220:223], v212, s[48:51], s31 offen offset:1024
    v_mfma_f32_16x16x32_bf16 v[56:59], a[60:63], v[104:107], v[56:59]
    v_mfma_f32_16x16x32_bf16 v[60:63], a[60:63], v[108:111], v[60:63]
    ds_read_b128 v[96:99], v215 offset:53248
    ds_read_b128 v[100:103], v215 offset:54272
    ds_read_b128 v[104:107], v215 offset:55296
    ds_read_b128 v[108:111], v215 offset:56320
    ds_read_b128 v[112:115], v214 offset:57344
    ds_read_b128 v[116:119], v214 offset:58368
    ds_read_b128 v[120:123], v214 offset:59392
    ds_read_b128 v[124:127], v214 offset:60416
    ds_read_b128 v[176:179], v215 offset:61440
    ds_read_b128 v[180:183], v215 offset:62464
    ds_read_b128 v[184:187], v215 offset:63488
    s_waitcnt lgkmcnt(14)
    ds_read_b128 v[188:191], v215 offset:64512
    s_waitcnt vmcnt(38)
    s_waitcnt lgkmcnt(12)
    s_waitcnt lgkmcnt(8)
    v_mfma_f32_16x16x32_bf16 v[0:3], a[72:75], v[96:99], v[0:3]
    buffer_load_dwordx4 a[224:227], v212, s[48:51], s31 offen offset:2048
    v_mfma_f32_16x16x32_bf16 v[16:19], a[76:79], v[96:99], v[16:19]
    v_mfma_f32_16x16x32_bf16 v[4:7], a[72:75], v[100:103], v[4:7]
    v_mfma_f32_16x16x32_bf16 v[20:23], a[76:79], v[100:103], v[20:23]
    v_mfma_f32_16x16x32_bf16 v[8:11], a[72:75], v[104:107], v[8:11]
    v_mfma_f32_16x16x32_bf16 v[24:27], a[76:79], v[104:107], v[24:27]
    v_mfma_f32_16x16x32_bf16 v[12:15], a[72:75], v[108:111], v[12:15]
    buffer_load_dwordx4 a[228:231], v212, s[48:51], s31 offen offset:3072
    v_mfma_f32_16x16x32_bf16 v[28:31], a[76:79], v[108:111], v[28:31]
    s_waitcnt lgkmcnt(4)
    v_mfma_f32_16x16x32_bf16 v[0:3], a[96:99], v[112:115], v[0:3]
    v_mfma_f32_16x16x32_bf16 v[16:19], a[100:103], v[112:115], v[16:19]
    v_mfma_f32_16x16x32_bf16 v[4:7], a[96:99], v[116:119], v[4:7]
    v_mfma_f32_16x16x32_bf16 v[20:23], a[100:103], v[116:119], v[20:23]
    v_mfma_f32_16x16x32_bf16 v[8:11], a[96:99], v[120:123], v[8:11]
    s_add_u32 s31, s28, s74
    buffer_load_dwordx4 a[0:3], v212, s[48:51], s31 offen offset:0
    v_mfma_f32_16x16x32_bf16 v[24:27], a[100:103], v[120:123], v[24:27]
    v_mfma_f32_16x16x32_bf16 v[12:15], a[96:99], v[124:127], v[12:15]
    v_mfma_f32_16x16x32_bf16 v[28:31], a[100:103], v[124:127], v[28:31]
    s_waitcnt lgkmcnt(0)
    v_mfma_f32_16x16x32_bf16 v[0:3], a[120:123], v[176:179], v[0:3]
    v_mfma_f32_16x16x32_bf16 v[16:19], a[124:127], v[176:179], v[16:19]
    v_mfma_f32_16x16x32_bf16 v[4:7], a[120:123], v[180:183], v[4:7]
    buffer_load_dwordx4 a[4:7], v212, s[48:51], s31 offen offset:1024
    v_mfma_f32_16x16x32_bf16 v[20:23], a[124:127], v[180:183], v[20:23]
    v_mfma_f32_16x16x32_bf16 v[8:11], a[120:123], v[184:187], v[8:11]
    v_mfma_f32_16x16x32_bf16 v[24:27], a[124:127], v[184:187], v[24:27]
    v_mfma_f32_16x16x32_bf16 v[12:15], a[120:123], v[188:191], v[12:15]
    v_mfma_f32_16x16x32_bf16 v[28:31], a[124:127], v[188:191], v[28:31]
    v_mfma_f32_16x16x32_bf16 v[32:35], a[80:83], v[96:99], v[32:35]
    buffer_load_dwordx4 a[8:11], v212, s[48:51], s31 offen offset:2048
    v_mfma_f32_16x16x32_bf16 v[48:51], a[84:87], v[96:99], v[48:51]
    v_fma_f32 v0, -v128, v224, v0
    v_fma_f32 v1, -v129, v224, v1
    v_mfma_f32_16x16x32_bf16 v[36:39], a[80:83], v[100:103], v[36:39]
    v_fma_f32 v0, v0, v225, v132
    v_fma_f32 v1, v1, v225, v133
    v_mfma_f32_16x16x32_bf16 v[52:55], a[84:87], v[100:103], v[52:55]
    v_fma_f32 v2, -v130, v224, v2
    v_fma_f32 v3, -v131, v224, v3
    v_mfma_f32_16x16x32_bf16 v[40:43], a[80:83], v[104:107], v[40:43]
    v_fma_f32 v2, v2, v225, v134
    v_fma_f32 v3, v3, v225, v135
    v_mfma_f32_16x16x32_bf16 v[56:59], a[84:87], v[104:107], v[56:59]
    v_fma_f32 v16, -v136, v224, v16
    v_fma_f32 v17, -v137, v224, v17
    v_mfma_f32_16x16x32_bf16 v[44:47], a[80:83], v[108:111], v[44:47]
    v_fma_f32 v16, v16, v225, v140
    v_fma_f32 v17, v17, v225, v141
    v_mfma_f32_16x16x32_bf16 v[60:63], a[84:87], v[108:111], v[60:63]
    v_fma_f32 v18, -v138, v224, v18
    v_fma_f32 v19, -v139, v224, v19
    v_mfma_f32_16x16x32_bf16 v[32:35], a[104:107], v[112:115], v[32:35]
    v_fma_f32 v18, v18, v225, v142
    v_fma_f32 v19, v19, v225, v143
    v_mfma_f32_16x16x32_bf16 v[48:51], a[108:111], v[112:115], v[48:51]
    v_mul_f32 v0, v0, v16
    v_mul_f32 v1, v1, v17
    v_mfma_f32_16x16x32_bf16 v[36:39], a[104:107], v[116:119], v[36:39]
    v_mul_f32 v2, v2, v18
    v_mul_f32 v3, v3, v19
    v_mfma_f32_16x16x32_bf16 v[52:55], a[108:111], v[116:119], v[52:55]
    v_cvt_pk_bf16_f32 v16, v0, v1
    v_cvt_pk_bf16_f32 v17, v2, v3
    v_mfma_f32_16x16x32_bf16 v[40:43], a[104:107], v[120:123], v[40:43]
    v_fma_f32 v4, -v128, v226, v4
    v_fma_f32 v5, -v129, v226, v5
    v_mfma_f32_16x16x32_bf16 v[56:59], a[108:111], v[120:123], v[56:59]
    v_fma_f32 v4, v4, v227, v132
    v_fma_f32 v5, v5, v227, v133
    v_mfma_f32_16x16x32_bf16 v[44:47], a[104:107], v[124:127], v[44:47]
    v_fma_f32 v6, -v130, v226, v6
    v_fma_f32 v7, -v131, v226, v7
    v_mfma_f32_16x16x32_bf16 v[60:63], a[108:111], v[124:127], v[60:63]
    v_fma_f32 v6, v6, v227, v134
    v_fma_f32 v7, v7, v227, v135
    v_mfma_f32_16x16x32_bf16 v[32:35], a[128:131], v[176:179], v[32:35]
    v_fma_f32 v20, -v136, v226, v20
    buffer_load_dwordx4 a[12:15], v212, s[48:51], s31 offen offset:3072
    v_fma_f32 v21, -v137, v226, v21
    v_mfma_f32_16x16x32_bf16 v[48:51], a[132:135], v[176:179], v[48:51]
    v_fma_f32 v20, v20, v227, v140
    v_fma_f32 v21, v21, v227, v141
    v_mfma_f32_16x16x32_bf16 v[36:39], a[128:131], v[180:183], v[36:39]
    v_fma_f32 v22, -v138, v226, v22
    v_fma_f32 v23, -v139, v226, v23
    v_mfma_f32_16x16x32_bf16 v[52:55], a[132:135], v[180:183], v[52:55]
    v_fma_f32 v22, v22, v227, v142
    v_fma_f32 v23, v23, v227, v143
    v_mfma_f32_16x16x32_bf16 v[40:43], a[128:131], v[184:187], v[40:43]
    v_mul_f32 v4, v4, v20
    v_mul_f32 v5, v5, v21
    v_mfma_f32_16x16x32_bf16 v[56:59], a[132:135], v[184:187], v[56:59]
    v_mul_f32 v6, v6, v22
    v_mul_f32 v7, v7, v23
    v_mfma_f32_16x16x32_bf16 v[44:47], a[128:131], v[188:191], v[44:47]
    v_cvt_pk_bf16_f32 v18, v4, v5
    v_cvt_pk_bf16_f32 v19, v6, v7
    v_mfma_f32_16x16x32_bf16 v[60:63], a[132:135], v[188:191], v[60:63]
    buffer_store_dwordx4 v[16:19], v212, s[8:11], s41 offen offset:0 sc1
    v_pk_fma_f32 v[8:9], v[128:129], v[228:229], v[8:9] op_sel:[0,0,0] op_sel_hi:[1,0,1] neg_lo:[1,0,0] neg_hi:[1,0,0]
    v_pk_fma_f32 v[8:9], v[8:9], v[228:229], v[132:133] op_sel:[0,1,0] op_sel_hi:[1,1,1]
    v_pk_fma_f32 v[10:11], v[130:131], v[228:229], v[10:11] op_sel:[0,0,0] op_sel_hi:[1,0,1] neg_lo:[1,0,0] neg_hi:[1,0,0]
    v_pk_fma_f32 v[10:11], v[10:11], v[228:229], v[134:135] op_sel:[0,1,0] op_sel_hi:[1,1,1]
    v_pk_fma_f32 v[24:25], v[136:137], v[228:229], v[24:25] op_sel:[0,0,0] op_sel_hi:[1,0,1] neg_lo:[1,0,0] neg_hi:[1,0,0]
    v_pk_fma_f32 v[24:25], v[24:25], v[228:229], v[140:141] op_sel:[0,1,0] op_sel_hi:[1,1,1]
    v_pk_fma_f32 v[26:27], v[138:139], v[228:229], v[26:27] op_sel:[0,0,0] op_sel_hi:[1,0,1] neg_lo:[1,0,0] neg_hi:[1,0,0]
    v_pk_fma_f32 v[26:27], v[26:27], v[228:229], v[142:143] op_sel:[0,1,0] op_sel_hi:[1,1,1]
    v_pk_mul_f32 v[8:9], v[8:9], v[24:25]
    v_pk_mul_f32 v[10:11], v[10:11], v[26:27]
    v_cvt_pk_bf16_f32 v24, v8, v9
    v_cvt_pk_bf16_f32 v25, v10, v11
    v_pk_fma_f32 v[12:13], v[128:129], v[230:231], v[12:13] op_sel:[0,0,0] op_sel_hi:[1,0,1] neg_lo:[1,0,0] neg_hi:[1,0,0]
    v_pk_fma_f32 v[12:13], v[12:13], v[230:231], v[132:133] op_sel:[0,1,0] op_sel_hi:[1,1,1]
    v_pk_fma_f32 v[14:15], v[130:131], v[230:231], v[14:15] op_sel:[0,0,0] op_sel_hi:[1,0,1] neg_lo:[1,0,0] neg_hi:[1,0,0]
    v_pk_fma_f32 v[14:15], v[14:15], v[230:231], v[134:135] op_sel:[0,1,0] op_sel_hi:[1,1,1]
    v_pk_fma_f32 v[28:29], v[136:137], v[230:231], v[28:29] op_sel:[0,0,0] op_sel_hi:[1,0,1] neg_lo:[1,0,0] neg_hi:[1,0,0]
    v_pk_fma_f32 v[28:29], v[28:29], v[230:231], v[140:141] op_sel:[0,1,0] op_sel_hi:[1,1,1]
    v_pk_fma_f32 v[30:31], v[138:139], v[230:231], v[30:31] op_sel:[0,0,0] op_sel_hi:[1,0,1] neg_lo:[1,0,0] neg_hi:[1,0,0]
    v_pk_fma_f32 v[30:31], v[30:31], v[230:231], v[142:143] op_sel:[0,1,0] op_sel_hi:[1,1,1]
    v_pk_mul_f32 v[12:13], v[12:13], v[28:29]
    v_pk_mul_f32 v[14:15], v[14:15], v[30:31]
    v_cvt_pk_bf16_f32 v26, v12, v13
    v_cvt_pk_bf16_f32 v27, v14, v15
    buffer_store_dwordx4 v[24:27], v212, s[8:11], s41 offen offset:1024 sc1
    v_pk_fma_f32 v[32:33], v[144:145], v[224:225], v[32:33] op_sel:[0,0,0] op_sel_hi:[1,0,1] neg_lo:[1,0,0] neg_hi:[1,0,0]
    v_pk_fma_f32 v[32:33], v[32:33], v[224:225], v[148:149] op_sel:[0,1,0] op_sel_hi:[1,1,1]
    v_pk_fma_f32 v[34:35], v[146:147], v[224:225], v[34:35] op_sel:[0,0,0] op_sel_hi:[1,0,1] neg_lo:[1,0,0] neg_hi:[1,0,0]
    v_pk_fma_f32 v[34:35], v[34:35], v[224:225], v[150:151] op_sel:[0,1,0] op_sel_hi:[1,1,1]
    v_pk_fma_f32 v[48:49], v[152:153], v[224:225], v[48:49] op_sel:[0,0,0] op_sel_hi:[1,0,1] neg_lo:[1,0,0] neg_hi:[1,0,0]
    v_pk_fma_f32 v[48:49], v[48:49], v[224:225], v[156:157] op_sel:[0,1,0] op_sel_hi:[1,1,1]
    v_pk_fma_f32 v[50:51], v[154:155], v[224:225], v[50:51] op_sel:[0,0,0] op_sel_hi:[1,0,1] neg_lo:[1,0,0] neg_hi:[1,0,0]
    v_pk_fma_f32 v[50:51], v[50:51], v[224:225], v[158:159] op_sel:[0,1,0] op_sel_hi:[1,1,1]
    v_pk_mul_f32 v[32:33], v[32:33], v[48:49]
    v_pk_mul_f32 v[34:35], v[34:35], v[50:51]
    v_cvt_pk_bf16_f32 v48, v32, v33
    v_cvt_pk_bf16_f32 v49, v34, v35
    v_pk_fma_f32 v[36:37], v[144:145], v[226:227], v[36:37] op_sel:[0,0,0] op_sel_hi:[1,0,1] neg_lo:[1,0,0] neg_hi:[1,0,0]
    v_pk_fma_f32 v[36:37], v[36:37], v[226:227], v[148:149] op_sel:[0,1,0] op_sel_hi:[1,1,1]
    v_pk_fma_f32 v[38:39], v[146:147], v[226:227], v[38:39] op_sel:[0,0,0] op_sel_hi:[1,0,1] neg_lo:[1,0,0] neg_hi:[1,0,0]
    v_pk_fma_f32 v[38:39], v[38:39], v[226:227], v[150:151] op_sel:[0,1,0] op_sel_hi:[1,1,1]
    v_pk_fma_f32 v[52:53], v[152:153], v[226:227], v[52:53] op_sel:[0,0,0] op_sel_hi:[1,0,1] neg_lo:[1,0,0] neg_hi:[1,0,0]
    v_pk_fma_f32 v[52:53], v[52:53], v[226:227], v[156:157] op_sel:[0,1,0] op_sel_hi:[1,1,1]
    v_pk_fma_f32 v[54:55], v[154:155], v[226:227], v[54:55] op_sel:[0,0,0] op_sel_hi:[1,0,1] neg_lo:[1,0,0] neg_hi:[1,0,0]
    v_pk_fma_f32 v[54:55], v[54:55], v[226:227], v[158:159] op_sel:[0,1,0] op_sel_hi:[1,1,1]
    v_pk_mul_f32 v[36:37], v[36:37], v[52:53]
    v_pk_mul_f32 v[38:39], v[38:39], v[54:55]
    v_cvt_pk_bf16_f32 v50, v36, v37
    v_cvt_pk_bf16_f32 v51, v38, v39
    buffer_store_dwordx4 v[48:51], v212, s[8:11], s41 offen offset:2048 sc1
    v_pk_fma_f32 v[40:41], v[144:145], v[228:229], v[40:41] op_sel:[0,0,0] op_sel_hi:[1,0,1] neg_lo:[1,0,0] neg_hi:[1,0,0]
    v_pk_fma_f32 v[40:41], v[40:41], v[228:229], v[148:149] op_sel:[0,1,0] op_sel_hi:[1,1,1]
    v_pk_fma_f32 v[42:43], v[146:147], v[228:229], v[42:43] op_sel:[0,0,0] op_sel_hi:[1,0,1] neg_lo:[1,0,0] neg_hi:[1,0,0]
    v_pk_fma_f32 v[42:43], v[42:43], v[228:229], v[150:151] op_sel:[0,1,0] op_sel_hi:[1,1,1]
    v_pk_fma_f32 v[56:57], v[152:153], v[228:229], v[56:57] op_sel:[0,0,0] op_sel_hi:[1,0,1] neg_lo:[1,0,0] neg_hi:[1,0,0]
    v_pk_fma_f32 v[56:57], v[56:57], v[228:229], v[156:157] op_sel:[0,1,0] op_sel_hi:[1,1,1]
    v_pk_fma_f32 v[58:59], v[154:155], v[228:229], v[58:59] op_sel:[0,0,0] op_sel_hi:[1,0,1] neg_lo:[1,0,0] neg_hi:[1,0,0]
    v_pk_fma_f32 v[58:59], v[58:59], v[228:229], v[158:159] op_sel:[0,1,0] op_sel_hi:[1,1,1]
    v_pk_mul_f32 v[40:41], v[40:41], v[56:57]
    v_pk_mul_f32 v[42:43], v[42:43], v[58:59]
    v_cvt_pk_bf16_f32 v56, v40, v41
    v_cvt_pk_bf16_f32 v57, v42, v43
    v_pk_fma_f32 v[44:45], v[144:145], v[230:231], v[44:45] op_sel:[0,0,0] op_sel_hi:[1,0,1] neg_lo:[1,0,0] neg_hi:[1,0,0]
    v_pk_fma_f32 v[44:45], v[44:45], v[230:231], v[148:149] op_sel:[0,1,0] op_sel_hi:[1,1,1]
    v_pk_fma_f32 v[46:47], v[146:147], v[230:231], v[46:47] op_sel:[0,0,0] op_sel_hi:[1,0,1] neg_lo:[1,0,0] neg_hi:[1,0,0]
    v_pk_fma_f32 v[46:47], v[46:47], v[230:231], v[150:151] op_sel:[0,1,0] op_sel_hi:[1,1,1]
    v_pk_fma_f32 v[60:61], v[152:153], v[230:231], v[60:61] op_sel:[0,0,0] op_sel_hi:[1,0,1] neg_lo:[1,0,0] neg_hi:[1,0,0]
    v_pk_fma_f32 v[60:61], v[60:61], v[230:231], v[156:157] op_sel:[0,1,0] op_sel_hi:[1,1,1]
    v_pk_fma_f32 v[62:63], v[154:155], v[230:231], v[62:63] op_sel:[0,0,0] op_sel_hi:[1,0,1] neg_lo:[1,0,0] neg_hi:[1,0,0]
    v_pk_fma_f32 v[62:63], v[62:63], v[230:231], v[158:159] op_sel:[0,1,0] op_sel_hi:[1,1,1]
    v_pk_mul_f32 v[44:45], v[44:45], v[60:61]
    v_pk_mul_f32 v[46:47], v[46:47], v[62:63]
    v_cvt_pk_bf16_f32 v58, v44, v45
    v_cvt_pk_bf16_f32 v59, v46, v47
    buffer_store_dwordx4 v[56:59], v212, s[8:11], s41 offen offset:3072 sc1
    s_mov_b32 s12, s6
    s_mov_b32 s13, s7
    s_mov_b32 s14, 12288
    s_mov_b32 s15, 0x00020000
    v_lshlrev_b32 v219, 4, v209
    s_lshl_b32 s40, s22, 8
    s_add_u32 s40, s40, 10240
    buffer_load_dwordx4 v[240:243], v219, s[12:15], s40 offen
    v_mov_b64 v[64:65], v[16:17]
    v_mov_b64 v[66:67], v[48:49]
    v_mov_b64 v[68:69], v[18:19]
    v_mov_b64 v[70:71], v[50:51]
    v_mov_b64 v[72:73], v[24:25]
    v_mov_b64 v[74:75], v[56:57]
    v_mov_b64 v[76:77], v[26:27]
    v_mov_b64 v[78:79], v[58:59]
    s_waitcnt vmcnt(45)
    v_mfma_f32_16x16x32_bf16 v[0:3], v[64:67], a[240:243], 0
    v_mfma_f32_16x16x32_bf16 v[4:7], v[64:67], a[244:247], 0
    v_mfma_f32_16x16x32_bf16 v[8:11], v[64:67], a[248:251], 0
    v_mfma_f32_16x16x32_bf16 v[12:15], v[64:67], a[252:255], 0
    v_mfma_f32_16x16x32_bf16 v[16:19], v[68:71], a[240:243], 0
    v_mfma_f32_16x16x32_bf16 v[20:23], v[68:71], a[244:247], 0
    v_mfma_f32_16x16x32_bf16 v[24:27], v[68:71], a[248:251], 0
    v_mfma_f32_16x16x32_bf16 v[28:31], v[68:71], a[252:255], 0
    v_mfma_f32_16x16x32_bf16 v[32:35], v[72:75], a[240:243], 0
    v_mfma_f32_16x16x32_bf16 v[36:39], v[72:75], a[244:247], 0
    v_mfma_f32_16x16x32_bf16 v[40:43], v[72:75], a[248:251], 0
    v_mfma_f32_16x16x32_bf16 v[44:47], v[72:75], a[252:255], 0
    v_mfma_f32_16x16x32_bf16 v[48:51], v[76:79], a[240:243], 0
    v_mfma_f32_16x16x32_bf16 v[52:55], v[76:79], a[244:247], 0
    v_mfma_f32_16x16x32_bf16 v[56:59], v[76:79], a[248:251], 0
    v_mfma_f32_16x16x32_bf16 v[60:63], v[76:79], a[252:255], 0
    s_waitcnt vmcnt(1)
    s_barrier
    v_mov_b32 v217, 1
    v_mov_b32 v218, 0
    s_mov_b64 exec, 1
    s_add_u32 s57, s57, 4096
    buffer_store_dword v217, v218, s[52:55], s57 offen sc1
    s_mov_b64 exec, -1
    s_add_u32 s56, s56, 4096
    s_mov_b32 s58, 40000
L_k3_p2:
    buffer_load_dword v217, v216, s[52:55], s56 offen offset:0 sc1
    s_waitcnt vmcnt(0)
    v_cmp_ne_u32 vcc, 1, v217
    s_nop 4
    s_sub_u32 s58, s58, 1
    s_cbranch_scc1 L_k3_p2_done
    s_cbranch_vccnz L_k3_p2
L_k3_p2_done:
    s_barrier
    s_add_u32 s31, s27, s65
    buffer_load_dwordx4 v[80:83], v212, s[8:11], s31 offen offset:0 sc1
    buffer_load_dwordx4 v[84:87], v212, s[8:11], s31 offen offset:2048 sc1
    buffer_load_dwordx4 v[88:91], v212, s[8:11], s31 offen offset:1024 sc1
    buffer_load_dwordx4 v[92:95], v212, s[8:11], s31 offen offset:3072 sc1
    s_add_u32 s31, s27, s66
    buffer_load_dwordx4 v[96:99], v212, s[8:11], s31 offen offset:0 sc1
    buffer_load_dwordx4 v[100:103], v212, s[8:11], s31 offen offset:2048 sc1
    buffer_load_dwordx4 v[104:107], v212, s[8:11], s31 offen offset:1024 sc1
    buffer_load_dwordx4 v[108:111], v212, s[8:11], s31 offen offset:3072 sc1
    s_add_u32 s31, s27, s67
    buffer_load_dwordx4 v[112:115], v212, s[8:11], s31 offen offset:0 sc1
    buffer_load_dwordx4 v[116:119], v212, s[8:11], s31 offen offset:2048 sc1
    buffer_load_dwordx4 v[120:123], v212, s[8:11], s31 offen offset:1024 sc1
    buffer_load_dwordx4 v[124:127], v212, s[8:11], s31 offen offset:3072 sc1
    v_lshl_add_u32 v220, v211, 14, v212
    v_add_u32 v220, 66048, v220
    v_lshl_add_u32 v221, v211, 12, v212
    v_add_u32 v221, 66048, v221
    ds_read_b64 v[244:245], v236
    ds_read_b64 v[246:247], v237
    ds_read_b64 v[248:249], v238
    ds_read_b64 v[250:251], v239
    s_mov_b32 s12, s42
    s_mov_b32 s13, s43
    s_mov_b32 s14, 2097152
    s_mov_b32 s15, 0x00020000
    s_waitcnt vmcnt(8)
    v_swap_b32 v82, v84
    v_swap_b32 v83, v85
    v_swap_b32 v90, v92
    v_swap_b32 v91, v93
    v_mfma_f32_16x16x32_bf16 v[0:3], v[80:83], a[16:19], v[0:3]
    s_add_u32 s31, s27, s68
    buffer_load_dwordx4 v[128:131], v212, s[8:11], s31 offen offset:0 sc1
    v_mfma_f32_16x16x32_bf16 v[4:7], v[80:83], a[20:23], v[4:7]
    v_mfma_f32_16x16x32_bf16 v[8:11], v[80:83], a[40:43], v[8:11]
    v_mfma_f32_16x16x32_bf16 v[12:15], v[80:83], a[44:47], v[12:15]
    v_mfma_f32_16x16x32_bf16 v[16:19], v[84:87], a[16:19], v[16:19]
    buffer_load_dwordx4 v[132:135], v212, s[8:11], s31 offen offset:2048 sc1
    v_mfma_f32_16x16x32_bf16 v[20:23], v[84:87], a[20:23], v[20:23]
    v_mfma_f32_16x16x32_bf16 v[24:27], v[84:87], a[40:43], v[24:27]
    v_mfma_f32_16x16x32_bf16 v[28:31], v[84:87], a[44:47], v[28:31]
    v_mfma_f32_16x16x32_bf16 v[32:35], v[88:91], a[16:19], v[32:35]
    buffer_load_dwordx4 v[136:139], v212, s[8:11], s31 offen offset:1024 sc1
    v_mfma_f32_16x16x32_bf16 v[36:39], v[88:91], a[20:23], v[36:39]
    v_mfma_f32_16x16x32_bf16 v[40:43], v[88:91], a[40:43], v[40:43]
    v_mfma_f32_16x16x32_bf16 v[44:47], v[88:91], a[44:47], v[44:47]
    v_mfma_f32_16x16x32_bf16 v[48:51], v[92:95], a[16:19], v[48:51]
    buffer_load_dwordx4 v[140:143], v212, s[8:11], s31 offen offset:3072 sc1
    v_mfma_f32_16x16x32_bf16 v[52:55], v[92:95], a[20:23], v[52:55]
    v_mfma_f32_16x16x32_bf16 v[56:59], v[92:95], a[40:43], v[56:59]
    v_mfma_f32_16x16x32_bf16 v[60:63], v[92:95], a[44:47], v[60:63]
    s_waitcnt vmcnt(8)
    v_swap_b32 v98, v100
    v_swap_b32 v99, v101
    v_swap_b32 v106, v108
    v_swap_b32 v107, v109
    v_mfma_f32_16x16x32_bf16 v[0:3], v[96:99], a[64:67], v[0:3]
    s_add_u32 s31, s27, s69
    buffer_load_dwordx4 v[144:147], v212, s[8:11], s31 offen offset:0 sc1
    v_mfma_f32_16x16x32_bf16 v[4:7], v[96:99], a[68:71], v[4:7]
    v_mfma_f32_16x16x32_bf16 v[8:11], v[96:99], a[88:91], v[8:11]
    v_mfma_f32_16x16x32_bf16 v[12:15], v[96:99], a[92:95], v[12:15]
    v_mfma_f32_16x16x32_bf16 v[16:19], v[100:103], a[64:67], v[16:19]
    buffer_load_dwordx4 v[148:151], v212, s[8:11], s31 offen offset:2048 sc1
    v_mfma_f32_16x16x32_bf16 v[20:23], v[100:103], a[68:71], v[20:23]
    v_mfma_f32_16x16x32_bf16 v[24:27], v[100:103], a[88:91], v[24:27]
    v_mfma_f32_16x16x32_bf16 v[28:31], v[100:103], a[92:95], v[28:31]
    v_mfma_f32_16x16x32_bf16 v[32:35], v[104:107], a[64:67], v[32:35]
    buffer_load_dwordx4 v[152:155], v212, s[8:11], s31 offen offset:1024 sc1
    v_mfma_f32_16x16x32_bf16 v[36:39], v[104:107], a[68:71], v[36:39]
    v_mfma_f32_16x16x32_bf16 v[40:43], v[104:107], a[88:91], v[40:43]
    v_mfma_f32_16x16x32_bf16 v[44:47], v[104:107], a[92:95], v[44:47]
    v_mfma_f32_16x16x32_bf16 v[48:51], v[108:111], a[64:67], v[48:51]
    buffer_load_dwordx4 v[156:159], v212, s[8:11], s31 offen offset:3072 sc1
    v_mfma_f32_16x16x32_bf16 v[52:55], v[108:111], a[68:71], v[52:55]
    v_mfma_f32_16x16x32_bf16 v[56:59], v[108:111], a[88:91], v[56:59]
    v_mfma_f32_16x16x32_bf16 v[60:63], v[108:111], a[92:95], v[60:63]
    s_waitcnt vmcnt(8)
    v_swap_b32 v114, v116
    v_swap_b32 v115, v117
    v_swap_b32 v122, v124
    v_swap_b32 v123, v125
    v_mfma_f32_16x16x32_bf16 v[0:3], v[112:115], a[112:115], v[0:3]
    s_add_u32 s31, s27, s70
    buffer_load_dwordx4 v[160:163], v212, s[8:11], s31 offen offset:0 sc1
    v_mfma_f32_16x16x32_bf16 v[4:7], v[112:115], a[116:119], v[4:7]
    v_mfma_f32_16x16x32_bf16 v[8:11], v[112:115], a[136:139], v[8:11]
    v_mfma_f32_16x16x32_bf16 v[12:15], v[112:115], a[140:143], v[12:15]
    v_mfma_f32_16x16x32_bf16 v[16:19], v[116:119], a[112:115], v[16:19]
    buffer_load_dwordx4 v[164:167], v212, s[8:11], s31 offen offset:2048 sc1
    v_mfma_f32_16x16x32_bf16 v[20:23], v[116:119], a[116:119], v[20:23]
    v_mfma_f32_16x16x32_bf16 v[24:27], v[116:119], a[136:139], v[24:27]
    v_mfma_f32_16x16x32_bf16 v[28:31], v[116:119], a[140:143], v[28:31]
    v_mfma_f32_16x16x32_bf16 v[32:35], v[120:123], a[112:115], v[32:35]
    buffer_load_dwordx4 v[168:171], v212, s[8:11], s31 offen offset:1024 sc1
    v_mfma_f32_16x16x32_bf16 v[36:39], v[120:123], a[116:119], v[36:39]
    v_mfma_f32_16x16x32_bf16 v[40:43], v[120:123], a[136:139], v[40:43]
    v_mfma_f32_16x16x32_bf16 v[44:47], v[120:123], a[140:143], v[44:47]
    v_mfma_f32_16x16x32_bf16 v[48:51], v[124:127], a[112:115], v[48:51]
    buffer_load_dwordx4 v[172:175], v212, s[8:11], s31 offen offset:3072 sc1
    v_mfma_f32_16x16x32_bf16 v[52:55], v[124:127], a[116:119], v[52:55]
    v_mfma_f32_16x16x32_bf16 v[56:59], v[124:127], a[136:139], v[56:59]
    v_mfma_f32_16x16x32_bf16 v[60:63], v[124:127], a[140:143], v[60:63]
    s_waitcnt vmcnt(8)
    v_swap_b32 v130, v132
    v_swap_b32 v131, v133
    v_swap_b32 v138, v140
    v_swap_b32 v139, v141
    v_mfma_f32_16x16x32_bf16 v[0:3], v[128:131], a[160:163], v[0:3]
    s_add_u32 s31, s27, s71
    buffer_load_dwordx4 v[176:179], v212, s[8:11], s31 offen offset:0 sc1
    v_mfma_f32_16x16x32_bf16 v[4:7], v[128:131], a[164:167], v[4:7]
    v_mfma_f32_16x16x32_bf16 v[8:11], v[128:131], a[184:187], v[8:11]
    v_mfma_f32_16x16x32_bf16 v[12:15], v[128:131], a[188:191], v[12:15]
    v_mfma_f32_16x16x32_bf16 v[16:19], v[132:135], a[160:163], v[16:19]
    buffer_load_dwordx4 v[180:183], v212, s[8:11], s31 offen offset:2048 sc1
    v_mfma_f32_16x16x32_bf16 v[20:23], v[132:135], a[164:167], v[20:23]
    v_mfma_f32_16x16x32_bf16 v[24:27], v[132:135], a[184:187], v[24:27]
    v_mfma_f32_16x16x32_bf16 v[28:31], v[132:135], a[188:191], v[28:31]
    v_mfma_f32_16x16x32_bf16 v[32:35], v[136:139], a[160:163], v[32:35]
    buffer_load_dwordx4 v[184:187], v212, s[8:11], s31 offen offset:1024 sc1
    v_mfma_f32_16x16x32_bf16 v[36:39], v[136:139], a[164:167], v[36:39]
    v_mfma_f32_16x16x32_bf16 v[40:43], v[136:139], a[184:187], v[40:43]
    v_mfma_f32_16x16x32_bf16 v[44:47], v[136:139], a[188:191], v[44:47]
    v_mfma_f32_16x16x32_bf16 v[48:51], v[140:143], a[160:163], v[48:51]
    buffer_load_dwordx4 v[188:191], v212, s[8:11], s31 offen offset:3072 sc1
    v_mfma_f32_16x16x32_bf16 v[52:55], v[140:143], a[164:167], v[52:55]
    v_mfma_f32_16x16x32_bf16 v[56:59], v[140:143], a[184:187], v[56:59]
    v_mfma_f32_16x16x32_bf16 v[60:63], v[140:143], a[188:191], v[60:63]
    s_waitcnt vmcnt(8)
    v_swap_b32 v146, v148
    v_swap_b32 v147, v149
    v_swap_b32 v154, v156
    v_swap_b32 v155, v157
    v_mfma_f32_16x16x32_bf16 v[0:3], v[144:147], a[208:211], v[0:3]
    s_add_u32 s31, s27, s72
    buffer_load_dwordx4 v[192:195], v212, s[8:11], s31 offen offset:0 sc1
    v_mfma_f32_16x16x32_bf16 v[4:7], v[144:147], a[212:215], v[4:7]
    v_mfma_f32_16x16x32_bf16 v[8:11], v[144:147], a[232:235], v[8:11]
    v_mfma_f32_16x16x32_bf16 v[12:15], v[144:147], a[236:239], v[12:15]
    v_mfma_f32_16x16x32_bf16 v[16:19], v[148:151], a[208:211], v[16:19]
    buffer_load_dwordx4 v[196:199], v212, s[8:11], s31 offen offset:2048 sc1
    v_mfma_f32_16x16x32_bf16 v[20:23], v[148:151], a[212:215], v[20:23]
    v_mfma_f32_16x16x32_bf16 v[24:27], v[148:151], a[232:235], v[24:27]
    v_mfma_f32_16x16x32_bf16 v[28:31], v[148:151], a[236:239], v[28:31]
    v_mfma_f32_16x16x32_bf16 v[32:35], v[152:155], a[208:211], v[32:35]
    buffer_load_dwordx4 v[200:203], v212, s[8:11], s31 offen offset:1024 sc1
    v_mfma_f32_16x16x32_bf16 v[36:39], v[152:155], a[212:215], v[36:39]
    v_mfma_f32_16x16x32_bf16 v[40:43], v[152:155], a[232:235], v[40:43]
    v_mfma_f32_16x16x32_bf16 v[44:47], v[152:155], a[236:239], v[44:47]
    v_mfma_f32_16x16x32_bf16 v[48:51], v[156:159], a[208:211], v[48:51]
    buffer_load_dwordx4 v[204:207], v212, s[8:11], s31 offen offset:3072 sc1
    v_mfma_f32_16x16x32_bf16 v[52:55], v[156:159], a[212:215], v[52:55]
    v_mfma_f32_16x16x32_bf16 v[56:59], v[156:159], a[232:235], v[56:59]
    v_mfma_f32_16x16x32_bf16 v[60:63], v[156:159], a[236:239], v[60:63]
    s_waitcnt vmcnt(8)
    v_swap_b32 v162, v164
    v_swap_b32 v163, v165
    v_swap_b32 v170, v172
    v_swap_b32 v171, v173
    v_mfma_f32_16x16x32_bf16 v[0:3], v[160:163], a[144:147], v[0:3]
    s_add_u32 s31, s27, s73
    buffer_load_dwordx4 v[64:67], v212, s[8:11], s31 offen offset:0 sc1
    v_mfma_f32_16x16x32_bf16 v[4:7], v[160:163], a[148:151], v[4:7]
    v_mfma_f32_16x16x32_bf16 v[8:11], v[160:163], a[152:155], v[8:11]
    v_mfma_f32_16x16x32_bf16 v[12:15], v[160:163], a[156:159], v[12:15]
    v_mfma_f32_16x16x32_bf16 v[16:19], v[164:167], a[144:147], v[16:19]
    buffer_load_dwordx4 v[68:71], v212, s[8:11], s31 offen offset:2048 sc1
    v_mfma_f32_16x16x32_bf16 v[20:23], v[164:167], a[148:151], v[20:23]
    v_mfma_f32_16x16x32_bf16 v[24:27], v[164:167], a[152:155], v[24:27]
    v_mfma_f32_16x16x32_bf16 v[28:31], v[164:167], a[156:159], v[28:31]
    v_mfma_f32_16x16x32_bf16 v[32:35], v[168:171], a[144:147], v[32:35]
    buffer_load_dwordx4 v[72:75], v212, s[8:11], s31 offen offset:1024 sc1
    v_mfma_f32_16x16x32_bf16 v[36:39], v[168:171], a[148:151], v[36:39]
    v_mfma_f32_16x16x32_bf16 v[40:43], v[168:171], a[152:155], v[40:43]
    v_mfma_f32_16x16x32_bf16 v[44:47], v[168:171], a[156:159], v[44:47]
    v_mfma_f32_16x16x32_bf16 v[48:51], v[172:175], a[144:147], v[48:51]
    buffer_load_dwordx4 v[76:79], v212, s[8:11], s31 offen offset:3072 sc1
    v_mfma_f32_16x16x32_bf16 v[52:55], v[172:175], a[148:151], v[52:55]
    v_mfma_f32_16x16x32_bf16 v[56:59], v[172:175], a[152:155], v[56:59]
    v_mfma_f32_16x16x32_bf16 v[60:63], v[172:175], a[156:159], v[60:63]
    s_waitcnt vmcnt(8)
    v_swap_b32 v178, v180
    v_swap_b32 v179, v181
    v_swap_b32 v186, v188
    v_swap_b32 v187, v189
    v_mfma_f32_16x16x32_bf16 v[0:3], v[176:179], a[168:171], v[0:3]
    s_add_u32 s31, s27, s74
    buffer_load_dwordx4 v[80:83], v212, s[8:11], s31 offen offset:0 sc1
    v_mfma_f32_16x16x32_bf16 v[4:7], v[176:179], a[172:175], v[4:7]
    v_mfma_f32_16x16x32_bf16 v[8:11], v[176:179], a[176:179], v[8:11]
    v_mfma_f32_16x16x32_bf16 v[12:15], v[176:179], a[180:183], v[12:15]
    v_mfma_f32_16x16x32_bf16 v[16:19], v[180:183], a[168:171], v[16:19]
    buffer_load_dwordx4 v[84:87], v212, s[8:11], s31 offen offset:2048 sc1
    v_mfma_f32_16x16x32_bf16 v[20:23], v[180:183], a[172:175], v[20:23]
    v_mfma_f32_16x16x32_bf16 v[24:27], v[180:183], a[176:179], v[24:27]
    v_mfma_f32_16x16x32_bf16 v[28:31], v[180:183], a[180:183], v[28:31]
    v_mfma_f32_16x16x32_bf16 v[32:35], v[184:187], a[168:171], v[32:35]
    buffer_load_dwordx4 v[88:91], v212, s[8:11], s31 offen offset:1024 sc1
    v_mfma_f32_16x16x32_bf16 v[36:39], v[184:187], a[172:175], v[36:39]
    v_mfma_f32_16x16x32_bf16 v[40:43], v[184:187], a[176:179], v[40:43]
    v_mfma_f32_16x16x32_bf16 v[44:47], v[184:187], a[180:183], v[44:47]
    v_mfma_f32_16x16x32_bf16 v[48:51], v[188:191], a[168:171], v[48:51]
    buffer_load_dwordx4 v[92:95], v212, s[8:11], s31 offen offset:3072 sc1
    v_mfma_f32_16x16x32_bf16 v[52:55], v[188:191], a[172:175], v[52:55]
    v_mfma_f32_16x16x32_bf16 v[56:59], v[188:191], a[176:179], v[56:59]
    v_mfma_f32_16x16x32_bf16 v[60:63], v[188:191], a[180:183], v[60:63]
    s_waitcnt vmcnt(8)
    v_swap_b32 v194, v196
    v_swap_b32 v195, v197
    v_swap_b32 v202, v204
    v_swap_b32 v203, v205
    v_mfma_f32_16x16x32_bf16 v[0:3], v[192:195], a[192:195], v[0:3]
    v_mfma_f32_16x16x32_bf16 v[4:7], v[192:195], a[196:199], v[4:7]
    v_mfma_f32_16x16x32_bf16 v[8:11], v[192:195], a[200:203], v[8:11]
    v_mfma_f32_16x16x32_bf16 v[12:15], v[192:195], a[204:207], v[12:15]
    v_mfma_f32_16x16x32_bf16 v[16:19], v[196:199], a[192:195], v[16:19]
    v_mfma_f32_16x16x32_bf16 v[20:23], v[196:199], a[196:199], v[20:23]
    v_mfma_f32_16x16x32_bf16 v[24:27], v[196:199], a[200:203], v[24:27]
    v_mfma_f32_16x16x32_bf16 v[28:31], v[196:199], a[204:207], v[28:31]
    v_mfma_f32_16x16x32_bf16 v[32:35], v[200:203], a[192:195], v[32:35]
    v_mfma_f32_16x16x32_bf16 v[36:39], v[200:203], a[196:199], v[36:39]
    v_mfma_f32_16x16x32_bf16 v[40:43], v[200:203], a[200:203], v[40:43]
    v_mfma_f32_16x16x32_bf16 v[44:47], v[200:203], a[204:207], v[44:47]
    v_mfma_f32_16x16x32_bf16 v[48:51], v[204:207], a[192:195], v[48:51]
    v_mfma_f32_16x16x32_bf16 v[52:55], v[204:207], a[196:199], v[52:55]
    v_mfma_f32_16x16x32_bf16 v[56:59], v[204:207], a[200:203], v[56:59]
    v_mfma_f32_16x16x32_bf16 v[60:63], v[204:207], a[204:207], v[60:63]
    s_waitcnt vmcnt(4)
    v_swap_b32 v66, v68
    v_swap_b32 v67, v69
    v_swap_b32 v74, v76
    v_swap_b32 v75, v77
    v_mfma_f32_16x16x32_bf16 v[0:3], v[64:67], a[216:219], v[0:3]
    s_waitcnt lgkmcnt(0)
    v_lshlrev_b32 v128, 16, v244
    v_mfma_f32_16x16x32_bf16 v[4:7], v[64:67], a[220:223], v[4:7]
    v_and_b32 v129, s33, v244
    v_mfma_f32_16x16x32_bf16 v[8:11], v[64:67], a[224:227], v[8:11]
    v_lshlrev_b32 v130, 16, v245
    v_mfma_f32_16x16x32_bf16 v[12:15], v[64:67], a[228:231], v[12:15]
    v_and_b32 v131, s33, v245
    v_mfma_f32_16x16x32_bf16 v[16:19], v[68:71], a[216:219], v[16:19]
    v_lshlrev_b32 v132, 16, v246
    v_mfma_f32_16x16x32_bf16 v[20:23], v[68:71], a[220:223], v[20:23]
    v_and_b32 v133, s33, v246
    v_mfma_f32_16x16x32_bf16 v[24:27], v[68:71], a[224:227], v[24:27]
    v_lshlrev_b32 v134, 16, v247
    v_mfma_f32_16x16x32_bf16 v[28:31], v[68:71], a[228:231], v[28:31]
    v_and_b32 v135, s33, v247
    v_mfma_f32_16x16x32_bf16 v[32:35], v[72:75], a[216:219], v[32:35]
    v_lshlrev_b32 v136, 16, v248
    v_mfma_f32_16x16x32_bf16 v[36:39], v[72:75], a[220:223], v[36:39]
    v_and_b32 v137, s33, v248
    v_mfma_f32_16x16x32_bf16 v[40:43], v[72:75], a[224:227], v[40:43]
    v_lshlrev_b32 v138, 16, v249
    v_mfma_f32_16x16x32_bf16 v[44:47], v[72:75], a[228:231], v[44:47]
    v_and_b32 v139, s33, v249
    v_mfma_f32_16x16x32_bf16 v[48:51], v[76:79], a[216:219], v[48:51]
    v_lshlrev_b32 v140, 16, v250
    v_mfma_f32_16x16x32_bf16 v[52:55], v[76:79], a[220:223], v[52:55]
    v_and_b32 v141, s33, v250
    v_mfma_f32_16x16x32_bf16 v[56:59], v[76:79], a[224:227], v[56:59]
    v_lshlrev_b32 v142, 16, v251
    v_mfma_f32_16x16x32_bf16 v[60:63], v[76:79], a[228:231], v[60:63]
    v_and_b32 v143, s33, v251
    s_waitcnt vmcnt(0)
    v_swap_b32 v82, v84
    v_swap_b32 v83, v85
    v_swap_b32 v90, v92
    v_swap_b32 v91, v93
    v_mfma_f32_16x16x32_bf16 v[0:3], v[80:83], a[0:3], v[0:3]
    v_mfma_f32_16x16x32_bf16 v[4:7], v[80:83], a[4:7], v[4:7]
    v_mfma_f32_16x16x32_bf16 v[8:11], v[80:83], a[8:11], v[8:11]
    s_nop 5
    ds_write_b128 v220, v[0:3] offset:0
    v_mfma_f32_16x16x32_bf16 v[12:15], v[80:83], a[12:15], v[12:15]
    ds_write_b128 v220, v[4:7] offset:1024
    v_mfma_f32_16x16x32_bf16 v[16:19], v[84:87], a[0:3], v[16:19]
    ds_write_b128 v220, v[8:11] offset:2048
    v_mfma_f32_16x16x32_bf16 v[20:23], v[84:87], a[4:7], v[20:23]
    s_nop 3
    ds_write_b128 v220, v[12:15] offset:3072
    v_mfma_f32_16x16x32_bf16 v[24:27], v[84:87], a[8:11], v[24:27]
    ds_write_b128 v220, v[16:19] offset:4096
    v_mfma_f32_16x16x32_bf16 v[28:31], v[84:87], a[12:15], v[28:31]
    ds_write_b128 v220, v[20:23] offset:5120
    v_mfma_f32_16x16x32_bf16 v[32:35], v[88:91], a[0:3], v[32:35]
    s_nop 3
    ds_write_b128 v220, v[24:27] offset:6144
    v_mfma_f32_16x16x32_bf16 v[36:39], v[88:91], a[4:7], v[36:39]
    ds_write_b128 v220, v[28:31] offset:7168
    v_mfma_f32_16x16x32_bf16 v[40:43], v[88:91], a[8:11], v[40:43]
    ds_write_b128 v220, v[32:35] offset:8192
    v_mfma_f32_16x16x32_bf16 v[44:47], v[88:91], a[12:15], v[44:47]
    s_nop 3
    ds_write_b128 v220, v[36:39] offset:9216
    v_mfma_f32_16x16x32_bf16 v[48:51], v[92:95], a[0:3], v[48:51]
    ds_write_b128 v220, v[40:43] offset:10240
    v_mfma_f32_16x16x32_bf16 v[52:55], v[92:95], a[4:7], v[52:55]
    ds_write_b128 v220, v[44:47] offset:11264
    v_mfma_f32_16x16x32_bf16 v[56:59], v[92:95], a[8:11], v[56:59]
    s_nop 3
    ds_write_b128 v220, v[48:51] offset:12288
    v_mfma_f32_16x16x32_bf16 v[60:63], v[92:95], a[12:15], v[60:63]
    ds_write_b128 v220, v[52:55] offset:13312
    s_nop 0
    ds_write_b128 v220, v[56:59] offset:14336
    s_waitcnt lgkmcnt(14)
    s_nop 3
    ds_write_b128 v220, v[60:63] offset:15360
    s_waitcnt lgkmcnt(0)
    s_barrier
    ds_read_b128 v[64:67], v221 offset:0
    ds_read_b128 v[68:71], v221 offset:16384
    ds_read_b128 v[72:75], v221 offset:32768
    ds_read_b128 v[76:79], v221 offset:49152
    ds_read_b128 v[80:83], v221 offset:1024
    ds_read_b128 v[84:87], v221 offset:17408
    ds_read_b128 v[88:91], v221 offset:33792
    ds_read_b128 v[92:95], v221 offset:50176
    ds_read_b128 v[96:99], v221 offset:2048
    ds_read_b128 v[100:103], v221 offset:18432
    ds_read_b128 v[104:107], v221 offset:34816
    ds_read_b128 v[108:111], v221 offset:51200
    ds_read_b128 v[112:115], v221 offset:3072
    ds_read_b128 v[116:119], v221 offset:19456
    ds_read_b128 v[120:123], v221 offset:35840
    s_waitcnt lgkmcnt(14)
    ds_read_b128 v[124:127], v221 offset:52224
    s_waitcnt lgkmcnt(12)
    v_pk_add_f32 v[64:65], v[64:65], v[68:69]
    v_pk_add_f32 v[72:73], v[72:73], v[76:77]
    v_pk_add_f32 v[64:65], v[64:65], v[72:73]
    v_pk_add_f32 v[66:67], v[66:67], v[70:71]
    v_pk_add_f32 v[74:75], v[74:75], v[78:79]
    v_pk_add_f32 v[66:67], v[66:67], v[74:75]
    v_fmac_f32 v128, v64, v240
    v_fmac_f32 v132, v65, v240
    v_fmac_f32 v136, v66, v240
    v_fmac_f32 v140, v67, v240
    s_waitcnt lgkmcnt(8)
    v_pk_add_f32 v[80:81], v[80:81], v[84:85]
    v_pk_add_f32 v[88:89], v[88:89], v[92:93]
    v_pk_add_f32 v[80:81], v[80:81], v[88:89]
    v_pk_add_f32 v[82:83], v[82:83], v[86:87]
    v_pk_add_f32 v[90:91], v[90:91], v[94:95]
    v_pk_add_f32 v[82:83], v[82:83], v[90:91]
    v_fmac_f32 v129, v80, v241
    v_fmac_f32 v133, v81, v241
    v_fmac_f32 v137, v82, v241
    v_fmac_f32 v141, v83, v241
    s_waitcnt lgkmcnt(4)
    v_pk_add_f32 v[96:97], v[96:97], v[100:101]
    v_pk_add_f32 v[104:105], v[104:105], v[108:109]
    v_pk_add_f32 v[96:97], v[96:97], v[104:105]
    v_pk_add_f32 v[98:99], v[98:99], v[102:103]
    v_pk_add_f32 v[106:107], v[106:107], v[110:111]
    v_pk_add_f32 v[98:99], v[98:99], v[106:107]
    v_fmac_f32 v130, v96, v242
    v_fmac_f32 v134, v97, v242
    v_fmac_f32 v138, v98, v242
    v_fmac_f32 v142, v99, v242
    s_waitcnt lgkmcnt(0)
    v_pk_add_f32 v[112:113], v[112:113], v[116:117]
    v_pk_add_f32 v[120:121], v[120:121], v[124:125]
    v_pk_add_f32 v[112:113], v[112:113], v[120:121]
    v_pk_add_f32 v[114:115], v[114:115], v[118:119]
    v_pk_add_f32 v[122:123], v[122:123], v[126:127]
    v_pk_add_f32 v[114:115], v[114:115], v[122:123]
    v_fmac_f32 v131, v112, v243
    v_fmac_f32 v135, v113, v243
    v_fmac_f32 v139, v114, v243
    v_fmac_f32 v143, v115, v243
    v_cvt_pk_bf16_f32 v144, v128, v129
    v_cvt_pk_bf16_f32 v145, v130, v131
    s_add_u32 s38, s26, 0
    buffer_store_dwordx2 v[144:145], v223, s[12:15], s38 offen sc1
    v_cvt_pk_bf16_f32 v146, v132, v133
    v_cvt_pk_bf16_f32 v147, v134, v135
    s_add_u32 s38, s26, 8192
    buffer_store_dwordx2 v[146:147], v223, s[12:15], s38 offen sc1
    v_cvt_pk_bf16_f32 v148, v136, v137
    v_cvt_pk_bf16_f32 v149, v138, v139
    s_add_u32 s38, s26, 16384
    buffer_store_dwordx2 v[148:149], v223, s[12:15], s38 offen sc1
    v_cvt_pk_bf16_f32 v150, v140, v141
    v_cvt_pk_bf16_f32 v151, v142, v143
    s_add_u32 s38, s26, 24576
    buffer_store_dwordx2 v[150:151], v223, s[12:15], s38 offen sc1
    s_endpgm
L_k3_end:
    s_endpgm
L_code_end:
    s_endpgm
.fill 1024, 4, 0xbf800000
.section .rodata,"a"
.p2align 6
.amdhsa_kernel k1_kernel
  .amdhsa_next_free_vgpr 208
  .amdhsa_next_free_sgpr 100
  .amdhsa_accum_offset 208
  .amdhsa_group_segment_fixed_size 0
  .amdhsa_kernarg_size 96
  .amdhsa_user_sgpr_count 2
  .amdhsa_user_sgpr_kernarg_segment_ptr 1
  .amdhsa_system_sgpr_workgroup_id_x 1
.end_amdhsa_kernel
.p2align 6
.amdhsa_kernel k2_kernel
  .amdhsa_next_free_vgpr 256
  .amdhsa_next_free_sgpr 100
  .amdhsa_accum_offset 256
  .amdhsa_group_segment_fixed_size 0
  .amdhsa_kernarg_size 96
  .amdhsa_user_sgpr_count 2
  .amdhsa_user_sgpr_kernarg_segment_ptr 1
  .amdhsa_system_sgpr_workgroup_id_x 1
.end_amdhsa_kernel
.p2align 6
.amdhsa_kernel k34_kernel
  .amdhsa_next_free_vgpr 512
  .amdhsa_next_free_sgpr 102
  .amdhsa_accum_offset 256
  .amdhsa_group_segment_fixed_size 0
  .amdhsa_kernarg_size 96
  .amdhsa_user_sgpr_count 2
  .amdhsa_user_sgpr_kernarg_segment_ptr 1
  .amdhsa_system_sgpr_workgroup_id_x 1
.end_amdhsa_kernel
```
